```python
import torch

def _softmax(x, axis=-1):
    return torch.softmax(x, dim=axis)
def _gelu(x):
    return torch.nn.functional.gelu(x, approximate="tanh")
def _silu(x):
    return torch.nn.functional.silu(x)
def _sigmoid(x):
    return torch.sigmoid(x)
def _layernorm(x, axis=-1, eps=1e-5):
    m = x.mean(dim=axis, keepdim=True)
    v = x.var(dim=axis, keepdim=True, unbiased=False)
    return (x - m) / torch.sqrt(v + eps)
def _scatter_add(tgt, idx, src, axis=0):
    return tgt.clone().index_add_(axis, idx, src)
def _segment_sum(src, seg, n):
    out = torch.zeros((n,) + src.shape[1:], dtype=src.dtype)
    return out.index_add_(0, seg, src)
def _pad(x, pw):
    flat = tuple(v for pair in reversed(pw) for v in pair)
    return torch.nn.functional.pad(x, flat)

kernel_name = 'interleave_layers__mha_block_cached__dense_activation_gelu__decode'

def setup_inputs():

    _w = (lambda a: (lambda t: t.to(torch.bfloat16) if t.is_floating_point() else t)(torch.as_tensor(a)))
    def _A_setup():
        B, Sq, D = 2, 1, 576
        H, Sk, Dh = 32, 8192, 128
        return {
            "x": _w((lambda *s: torch.randn(*s, dtype=torch.bfloat16) * 0.1)(B, Sq, D)),
            "k_cache": _w((lambda *s: torch.randn(*s, dtype=torch.bfloat16) * 0.8)(B, H, Sk, Dh)),
            "v_cache": _w((lambda *s: torch.randn(*s, dtype=torch.bfloat16) * 3.2)(B, H, Sk, Dh)),
            "wq": _w((lambda *s: torch.randn(*s, dtype=torch.bfloat16) * 0.8)(D, H * Dh) * (D ** -0.5)),
            "wo": _w((lambda *s: torch.randn(*s, dtype=torch.bfloat16) * 3.2)(H * Dh, D) * ((H * Dh) ** -0.5)),
        }
    _A_in = _A_setup()

    def _B_setup():
        B, S, D, F = 2, 1, 576, 4608
        return {
            "x": _w((lambda *s: torch.randn(*s, dtype=torch.bfloat16) * 0.1)(B, S, D)),
            "w1": _w((lambda *s: torch.randn(*s, dtype=torch.bfloat16) * 1.6)(D, F) * (D ** -0.5)),
            "b1": _w((lambda *s: torch.randn(*s, dtype=torch.bfloat16) * 1.6)(F) * 0.01),
            "w2": _w((lambda *s: torch.randn(*s, dtype=torch.bfloat16) * 0.4)(F, D) * (F ** -0.5)),
            "b2": _w((lambda *s: torch.randn(*s, dtype=torch.bfloat16) * 0.4)(D) * 0.01),
        }
    _B_in = _B_setup()

    return {
        "A_x": _A_in["x"],
        "A_k_cache": _A_in["k_cache"],
        "A_v_cache": _A_in["v_cache"],
        "A_wq": _A_in["wq"],
        "A_wo": _A_in["wo"],
        "B_x": _B_in["x"],
        "B_w1": _B_in["w1"],
        "B_b1": _B_in["b1"],
        "B_w2": _B_in["w2"],
        "B_b2": _B_in["b2"],
    }

def reference(A_x, A_k_cache, A_v_cache, A_wq, A_wo, B_x, B_w1, B_b1, B_w2, B_b2):
    def _A_ref(x, k_cache, v_cache, wq, wo):
        B, Sq, D = x.shape
        H, Dh = 32, 128
        q = (lambda x, *d: x.permute(*d))((x @ wq).reshape(B, Sq, H, Dh), 0, 2, 1, 3)
        scores = torch.einsum("bhqd,bhkd->bhqk", q, k_cache) * (Dh ** -0.5)
        p = _softmax(scores, axis=-1)
        o = torch.einsum("bhqk,bhkd->bhqd", p, v_cache)
        return (lambda x, *d: x.permute(*d))(o, 0, 2, 1, 3).reshape(B, Sq, H * Dh) @ wo

    def _B_ref(x, w1, b1, w2, b2):
        h = torch.einsum("bsd,df->bsf", x, w1) + b1
        h = _gelu(h)
        return torch.einsum("bsf,fd->bsd", h, w2) + b2

    x = A_x
    x = x + _A_ref(_layernorm(x, axis=-1), A_k_cache, A_v_cache, A_wq, A_wo)
    x = x + _B_ref(_layernorm(x, axis=-1), B_w1, B_b1, B_w2, B_b2)
    x = x + _A_ref(_layernorm(x, axis=-1), A_k_cache, A_v_cache, A_wq, A_wo)
    x = x + _B_ref(_layernorm(x, axis=-1), B_w1, B_b1, B_w2, B_b2)
    return x
```

```asm
; @launch grid=(256,1,1) block=(256,1,1) lds=163840
.amdgcn_target "amdgcn-amd-amdhsa--gfx950"
.text
.globl interleave_layers__mha_block_cached__dense_activation_gelu__decode_kernel
.p2align 8
.type interleave_layers__mha_block_cached__dense_activation_gelu__decode_kernel,@function
interleave_layers__mha_block_cached__dense_activation_gelu__decode_kernel:
  s_cmp_ge_u32 s2, 256
  s_cbranch_scc1 L_end
  s_load_dwordx4 s[8:11], s[0:1], 8
  s_load_dwordx2 s[4:5], s[0:1], 96
  v_lshrrev_b32 v1, 6, v0
  v_and_b32 v0, 63, v0
  v_readfirstlane_b32 s17, v1
  s_waitcnt lgkmcnt(0)
  s_and_b32 s5, s5, 0xffff
  s_load_dword s16, s[4:5], 0
  s_mov_b32 s12, s10
  s_and_b32 s13, s11, 0xffff
  s_mov_b32 s14, 0x08000000
  s_mov_b32 s15, 0x00020000
  s_and_b32 s9, s9, 0xffff
  s_mov_b32 s10, 0x08000000
  s_mov_b32 s11, 0x00020000
  s_mov_b32 s6, 0x800000
  s_mov_b32 s7, 0x00020000
  s_and_b32 s3, s2, 7
  s_cmp_eq_u32 s3, 0
  s_cbranch_scc1 L_chain
L_attn:
  s_lshr_b32 s18, s2, 3
  s_and_b32 s19, s2, 7
  s_sub_u32 s19, s19, 1
  s_add_u32 s19, s19, s18
  s_mul_i32 s48, s19, 37
  s_lshr_b32 s48, s48, 8
  s_mul_i32 s48, s48, 7
  s_sub_u32 s19, s19, s48
  s_mul_i32 s48, s17, 7
  s_add_u32 s48, s48, s19
  s_lshl_b32 s48, s48, 12
  s_lshl_b32 s49, s18, 21
  s_add_u32 s20, s48, s49
  s_add_u32 s21, s20, 0x4000000
  s_mul_i32 s52, s17, 38912
  s_add_u32 s52, s52, 8192
  v_bfe_u32 v32, v0, 2, 2
  v_lshlrev_b32 v1, 8, v32
  v_lshrrev_b32 v33, 4, v0
  v_lshl_add_u32 v1, v33, 6, v1
  v_and_b32 v34, 3, v0
  v_lshl_add_u32 v1, v34, 4, v1
  s_add_u32 m0, s52, 0x0
  s_nop 0
  buffer_load_dwordx4 v1, s[8:11], s21 offen nt lds
  s_add_u32 m0, s52, 0x400
  s_add_u32 s24, s21, 0x400
  buffer_load_dwordx4 v1, s[8:11], s24 offen nt lds
  s_add_u32 m0, s52, 0x800
  s_add_u32 s25, s21, 0x800
  buffer_load_dwordx4 v1, s[8:11], s25 offen nt lds
  s_add_u32 m0, s52, 0xc00
  s_add_u32 s26, s21, 0xc00
  buffer_load_dwordx4 v1, s[8:11], s26 offen nt lds
  s_add_u32 m0, s52, 0x1000
  s_add_u32 s27, s21, 0x1c000
  buffer_load_dwordx4 v1, s[8:11], s27 offen nt lds
  s_add_u32 m0, s52, 0x1400
  s_add_u32 s24, s21, 0x1c400
  buffer_load_dwordx4 v1, s[8:11], s24 offen nt lds
  v_mov_b32 v54, 0
  buffer_load_dword v55, v54, s[12:15], s21 offen nt
  buffer_load_dword v55, v54, s[8:11], s20 offen nt
  buffer_load_dword v55, v54, s[12:15], s20 offen nt
  s_getpc_b64 s[92:93]
L_pc_L_attn:
  v_lshlrev_b32 v50, 4, v0
  s_lshl_b32 s94, s17, 10
  v_add_u32 v50, s94, v50
  v_min_u32 v51, L_chain-L_pc_L_attn-16, v50
  global_load_dwordx4 v[46:49], v51, s[92:93]
  v_add_u32 v50, 0x1000, v50
  v_min_u32 v51, L_chain-L_pc_L_attn-16, v50
  global_load_dwordx4 v[46:49], v51, s[92:93]
  v_add_u32 v50, 0x1000, v50
  v_min_u32 v51, L_chain-L_pc_L_attn-16, v50
  global_load_dwordx4 v[46:49], v51, s[92:93]
  v_add_u32 v50, 0x1000, v50
  v_min_u32 v51, L_chain-L_pc_L_attn-16, v50
  global_load_dwordx4 v[46:49], v51, s[92:93]
  v_add_u32 v50, 0x1000, v50
  v_min_u32 v51, L_chain-L_pc_L_attn-16, v50
  global_load_dwordx4 v[46:49], v51, s[92:93]
  v_add_u32 v50, 0x1000, v50
  v_min_u32 v51, L_chain-L_pc_L_attn-16, v50
  global_load_dwordx4 v[46:49], v51, s[92:93]
  v_add_u32 v50, 0x1000, v50
  v_min_u32 v51, L_chain-L_pc_L_attn-16, v50
  global_load_dwordx4 v[46:49], v51, s[92:93]
  v_add_u32 v50, 0x1000, v50
  s_mul_i32 s48, s17, 7
  s_add_u32 s48, s48, s19
  s_cmp_lt_u32 s48, 8
  s_cselect_b32 s49, 1, 0
  s_add_u32 s22, s20, 0x1f8000
  s_cmp_eq_u32 s49, 1
  s_cselect_b32 s22, s22, 0x80000000
  s_add_u32 s23, s21, 0x1f8000
  s_cmp_eq_u32 s49, 1
  s_cselect_b32 s23, s23, 0x80000000
  s_mov_b32 s30, 0x11111111
  s_mov_b32 s31, 0x11111111
  s_mov_b32 s32, 0x22222222
  s_mov_b32 s33, 0x22222222
  s_mov_b32 s34, 0x44444444
  s_mov_b32 s35, 0x44444444
  s_mov_b32 s36, 0x88888888
  s_mov_b32 s37, 0x88888888
  s_cmp_eq_u32 s49, 1
  s_cselect_b32 s38, 0x44444444, 0
  s_mov_b32 s39, s38
  s_mov_b32 s40, 0xcccccccc
  s_mov_b32 s41, 0xcccccccc
  s_mov_b32 s28, 0x3fb8aa3b
  s_mov_b32 s53, 0x3db504f3
  s_lshl_b32 s46, s18, 9
  s_add_u32 s46, s46, 0x1000
  s_lshl_b32 s47, s18, 3
  s_add_u32 s47, s47, s19
  s_lshl_b32 s47, s47, 11
  s_add_u32 s47, s47, 0x100000
  v_lshrrev_b32 v33, 4, v0
  v_and_b32 v34, 7, v0
  v_lshlrev_b32 v34, 4, v34
  v_lshl_add_u32 v34, v33, 8, v34
  v_bfe_u32 v32, v0, 3, 1
  v_mul_u32_u24 v2, 0x1c000, v32
  v_add_u32 v2, v2, v34
  v_lshl_add_u32 v3, v32, 30, v34
  v_and_b32 v32, 1, v0
  v_mov_b32 v33, 0xffff
  v_lshlrev_b32 v34, 4, v32
  v_lshlrev_b32 v4, v34, v33
  v_lshlrev_b32 v5, 4, v0
  v_add_u32 v5, s52, v5
  v_bfe_u32 v32, v0, 4, 1
  v_lshlrev_b32 v6, 5, v32
  v_bfe_u32 v32, v0, 1, 1
  v_lshl_add_u32 v6, v32, 4, v6
  v_lshrrev_b32 v32, 5, v0
  v_lshl_add_u32 v6, v32, 3, v6
  v_bfe_u32 v32, v0, 2, 2
  v_lshl_add_u32 v6, v32, 1, v6
  v_and_b32 v32, 1, v0
  v_add_u32 v6, v32, v6
  s_lshl_b32 s48, s17, 6
  v_add_u32 v6, s48, v6
  v_lshlrev_b32 v6, 3, v6
  v_lshlrev_b32 v32, 3, v0
  v_add_u32 v32, 1024, v32
  v_mov_b32 v33, 0x7f000000
  v_cmp_gt_u32 vcc, 2, v0
  s_nop 1
  v_cndmask_b32 v32, v33, v32, vcc
  s_cmp_eq_u32 s17, 2
  s_cselect_b64 vcc, -1, 0
  v_cndmask_b32 v6, v6, v32, vcc
  s_cmp_eq_u32 s17, 3
  s_cselect_b64 vcc, -1, 0
  v_cndmask_b32 v6, v6, v33, vcc
  s_mov_b32 s54, 0xf000f
  s_mov_b32 s55, 0xf000f
  s_mov_b32 s56, 0xf000f0
  s_mov_b32 s57, 0xf000f0
  s_mov_b32 s58, 0xf000f00
  s_mov_b32 s59, 0xf000f00
  s_mov_b32 s60, 0xf000f000
  s_mov_b32 s61, 0xf000f000
  s_mov_b32 s62, 0xaaaaaaaa
  s_mov_b32 s63, 0xaaaaaaaa
  s_waitcnt lgkmcnt(0)
  s_mul_i32 s16, s16, 0x9e3779b1
  s_add_u32 s16, s16, 0x85ebca6b
  s_waitcnt vmcnt(4)
  s_add_u32 m0, s52, 0x1800
  s_add_u32 s25, s21, 0x1c800
  buffer_load_dwordx4 v1, s[8:11], s25 offen nt lds
  s_add_u32 m0, s52, 0x1c00
  s_add_u32 s26, s21, 0x1cc00
  buffer_load_dwordx4 v1, s[8:11], s26 offen nt lds
  s_waitcnt vmcnt(4)
  s_add_u32 m0, s52, 0x2000
  s_add_u32 s27, s21, 0x38000
  buffer_load_dwordx4 v1, s[8:11], s27 offen nt lds
  s_add_u32 m0, s52, 0x2400
  s_add_u32 s24, s21, 0x38400
  buffer_load_dwordx4 v1, s[8:11], s24 offen nt lds
  s_waitcnt vmcnt(4)
  s_add_u32 m0, s52, 0x2800
  s_add_u32 s25, s21, 0x38800
  buffer_load_dwordx4 v1, s[8:11], s25 offen nt lds
  s_add_u32 m0, s52, 0x2c00
  s_add_u32 s26, s21, 0x38c00
  buffer_load_dwordx4 v1, s[8:11], s26 offen nt lds
  s_waitcnt vmcnt(4)
  s_add_u32 m0, s52, 0x3000
  s_add_u32 s27, s21, 0x54000
  buffer_load_dwordx4 v1, s[8:11], s27 offen nt lds
  s_add_u32 m0, s52, 0x3400
  s_add_u32 s24, s21, 0x54400
  buffer_load_dwordx4 v1, s[8:11], s24 offen nt lds
  s_waitcnt vmcnt(4)
  s_add_u32 m0, s52, 0x3800
  s_add_u32 s25, s21, 0x54800
  buffer_load_dwordx4 v1, s[8:11], s25 offen nt lds
  s_add_u32 m0, s52, 0x3c00
  s_add_u32 s26, s21, 0x54c00
  buffer_load_dwordx4 v1, s[8:11], s26 offen nt lds
  s_waitcnt vmcnt(4)
  s_add_u32 m0, s52, 0x4000
  s_add_u32 s27, s21, 0x70000
  buffer_load_dwordx4 v1, s[8:11], s27 offen nt lds
  s_add_u32 m0, s52, 0x4400
  s_add_u32 s24, s21, 0x70400
  buffer_load_dwordx4 v1, s[8:11], s24 offen nt lds
  s_waitcnt vmcnt(4)
  s_add_u32 m0, s52, 0x4800
  s_add_u32 s25, s21, 0x70800
  buffer_load_dwordx4 v1, s[8:11], s25 offen nt lds
  s_add_u32 m0, s52, 0x4c00
  s_add_u32 s26, s21, 0x70c00
  buffer_load_dwordx4 v1, s[8:11], s26 offen nt lds
  s_waitcnt vmcnt(4)
  s_add_u32 m0, s52, 0x5000
  s_add_u32 s27, s21, 0x8c000
  buffer_load_dwordx4 v1, s[8:11], s27 offen nt lds
  s_add_u32 m0, s52, 0x5400
  s_add_u32 s24, s21, 0x8c400
  buffer_load_dwordx4 v1, s[8:11], s24 offen nt lds
  s_waitcnt vmcnt(4)
  s_add_u32 m0, s52, 0x5800
  s_add_u32 s25, s21, 0x8c800
  buffer_load_dwordx4 v1, s[8:11], s25 offen nt lds
  s_add_u32 m0, s52, 0x5c00
  s_add_u32 s26, s21, 0x8cc00
  buffer_load_dwordx4 v1, s[8:11], s26 offen nt lds
  s_waitcnt vmcnt(4)
  s_add_u32 m0, s52, 0x6000
  s_add_u32 s27, s21, 0xa8000
  buffer_load_dwordx4 v1, s[8:11], s27 offen nt lds
  s_add_u32 m0, s52, 0x6400
  s_add_u32 s24, s21, 0xa8400
  buffer_load_dwordx4 v1, s[8:11], s24 offen nt lds
  s_waitcnt vmcnt(4)
  s_add_u32 m0, s52, 0x6800
  s_add_u32 s25, s21, 0xa8800
  buffer_load_dwordx4 v1, s[8:11], s25 offen nt lds
  s_add_u32 m0, s52, 0x6c00
  s_add_u32 s26, s21, 0xa8c00
  buffer_load_dwordx4 v1, s[8:11], s26 offen nt lds
  s_waitcnt vmcnt(4)
  s_add_u32 m0, s52, 0x7000
  s_add_u32 s27, s21, 0xc4000
  buffer_load_dwordx4 v1, s[8:11], s27 offen nt lds
  s_add_u32 m0, s52, 0x7400
  s_add_u32 s24, s21, 0xc4400
  buffer_load_dwordx4 v1, s[8:11], s24 offen nt lds
  s_waitcnt vmcnt(4)
  s_add_u32 m0, s52, 0x7800
  s_add_u32 s25, s21, 0xc4800
  buffer_load_dwordx4 v1, s[8:11], s25 offen nt lds
  s_add_u32 m0, s52, 0x7c00
  s_add_u32 s26, s21, 0xc4c00
  buffer_load_dwordx4 v1, s[8:11], s26 offen nt lds
  s_waitcnt vmcnt(4)
  s_add_u32 m0, s52, 0x8000
  s_add_u32 s27, s21, 0xe0000
  buffer_load_dwordx4 v1, s[8:11], s27 offen nt lds
  s_add_u32 m0, s52, 0x8400
  s_add_u32 s24, s21, 0xe0400
  buffer_load_dwordx4 v1, s[8:11], s24 offen nt lds
  s_waitcnt vmcnt(4)
  s_add_u32 m0, s52, 0x8800
  s_add_u32 s25, s21, 0xe0800
  buffer_load_dwordx4 v1, s[8:11], s25 offen nt lds
  s_add_u32 m0, s52, 0x8c00
  s_add_u32 s26, s21, 0xe0c00
  buffer_load_dwordx4 v1, s[8:11], s26 offen nt lds
  s_waitcnt vmcnt(4)
  s_add_u32 m0, s52, 0x9000
  s_add_u32 s27, s21, 0xfc000
  buffer_load_dwordx4 v1, s[8:11], s27 offen nt lds
  s_add_u32 m0, s52, 0x9400
  s_add_u32 s24, s21, 0xfc400
  buffer_load_dwordx4 v1, s[8:11], s24 offen nt lds
  s_waitcnt vmcnt(4)
  buffer_load_dwordx4 v[64:67], v1, s[8:11], s27 offen offset:2048 nt
  buffer_load_dwordx4 v[68:71], v1, s[8:11], s27 offen offset:3072 nt
  s_waitcnt vmcnt(4)
  s_add_u32 s25, s21, 0x118000
  buffer_load_dwordx4 v[72:75], v1, s[8:11], s25 offen nt
  buffer_load_dwordx4 v[76:79], v1, s[8:11], s25 offen offset:1024 nt
  s_waitcnt vmcnt(4)
  buffer_load_dwordx4 v[80:83], v1, s[8:11], s25 offen offset:2048 nt
  buffer_load_dwordx4 v[84:87], v1, s[8:11], s25 offen offset:3072 nt
  s_waitcnt vmcnt(4)
  s_add_u32 s26, s21, 0x134000
  buffer_load_dwordx4 v[88:91], v1, s[8:11], s26 offen nt
  buffer_load_dwordx4 v[92:95], v1, s[8:11], s26 offen offset:1024 nt
  s_waitcnt vmcnt(4)
  buffer_load_dwordx4 v[96:99], v1, s[8:11], s26 offen offset:2048 nt
  buffer_load_dwordx4 v[100:103], v1, s[8:11], s26 offen offset:3072 nt
  s_waitcnt vmcnt(4)
  s_add_u32 s27, s21, 0x150000
  buffer_load_dwordx4 v[104:107], v1, s[8:11], s27 offen nt
  buffer_load_dwordx4 v[108:111], v1, s[8:11], s27 offen offset:1024 nt
  s_waitcnt vmcnt(4)
  buffer_load_dwordx4 v[112:115], v1, s[8:11], s27 offen offset:2048 nt
  buffer_load_dwordx4 v[116:119], v1, s[8:11], s27 offen offset:3072 nt
  s_waitcnt vmcnt(4)
  s_add_u32 s24, s21, 0x16c000
  buffer_load_dwordx4 v[120:123], v1, s[8:11], s24 offen nt
  buffer_load_dwordx4 v[124:127], v1, s[8:11], s24 offen offset:1024 nt
  s_waitcnt vmcnt(4)
  buffer_load_dwordx4 v[128:131], v1, s[8:11], s24 offen offset:2048 nt
  buffer_load_dwordx4 v[132:135], v1, s[8:11], s24 offen offset:3072 nt
  s_waitcnt vmcnt(4)
  s_add_u32 s25, s21, 0x188000
  buffer_load_dwordx4 v[136:139], v1, s[8:11], s25 offen nt
  buffer_load_dwordx4 v[140:143], v1, s[8:11], s25 offen offset:1024 nt
  s_waitcnt vmcnt(4)
  buffer_load_dwordx4 v[144:147], v1, s[8:11], s25 offen offset:2048 nt
  buffer_load_dwordx4 v[148:151], v1, s[8:11], s25 offen offset:3072 nt
  s_waitcnt vmcnt(4)
  s_add_u32 s26, s21, 0x1a4000
  buffer_load_dwordx4 v[152:155], v1, s[8:11], s26 offen nt
  buffer_load_dwordx4 v[156:159], v1, s[8:11], s26 offen offset:1024 nt
  s_waitcnt vmcnt(4)
  buffer_load_dwordx4 v[160:163], v1, s[8:11], s26 offen offset:2048 nt
  buffer_load_dwordx4 v[164:167], v1, s[8:11], s26 offen offset:3072 nt
  s_waitcnt vmcnt(4)
  s_add_u32 s27, s21, 0x1c0000
  buffer_load_dwordx4 v[168:171], v1, s[8:11], s27 offen nt
  buffer_load_dwordx4 v[172:175], v1, s[8:11], s27 offen offset:1024 nt
  s_waitcnt vmcnt(4)
  buffer_load_dwordx4 v[176:179], v1, s[8:11], s27 offen offset:2048 nt
  buffer_load_dwordx4 v[180:183], v1, s[8:11], s27 offen offset:3072 nt
  s_waitcnt vmcnt(4)
  s_add_u32 s24, s21, 0x1dc000
  buffer_load_dwordx4 v[184:187], v1, s[8:11], s24 offen nt
  buffer_load_dwordx4 v[188:191], v1, s[8:11], s24 offen offset:1024 nt
  s_waitcnt vmcnt(4)
  buffer_load_dwordx4 v[192:195], v1, s[8:11], s24 offen offset:2048 nt
  buffer_load_dwordx4 v[196:199], v1, s[8:11], s24 offen offset:3072 nt
  s_waitcnt vmcnt(4)
  buffer_load_dwordx4 v[200:203], v1, s[8:11], s23 offen
  buffer_load_dwordx4 v[204:207], v1, s[8:11], s23 offen offset:1024
  s_waitcnt vmcnt(4)
  buffer_load_dwordx4 v[208:211], v1, s[8:11], s23 offen offset:2048
  buffer_load_dwordx4 v[212:215], v1, s[8:11], s23 offen offset:3072
  s_waitcnt vmcnt(4)
  buffer_load_dwordx4 v[216:219], v2, s[12:15], s21 offen nt
  buffer_load_dwordx4 v[220:223], v2, s[12:15], s21 offen offset:128 nt
  s_waitcnt vmcnt(4)
  buffer_load_dwordx4 v[224:227], v2, s[12:15], s21 offen offset:1024 nt
  buffer_load_dwordx4 v[228:231], v2, s[12:15], s21 offen offset:1152 nt
  s_waitcnt vmcnt(4)
  buffer_load_dwordx4 v[232:235], v2, s[12:15], s21 offen offset:2048 nt
  buffer_load_dwordx4 v[236:239], v2, s[12:15], s21 offen offset:2176 nt
  s_waitcnt vmcnt(4)
  buffer_load_dwordx4 v[240:243], v2, s[12:15], s21 offen offset:3072 nt
  buffer_load_dwordx4 v[244:247], v2, s[12:15], s21 offen offset:3200 nt
  s_waitcnt vmcnt(4)
  s_add_u32 s25, s21, 0x38000
  buffer_load_dwordx4 v[248:251], v2, s[12:15], s25 offen nt
  buffer_load_dwordx4 v[252:255], v2, s[12:15], s25 offen offset:128 nt
  s_waitcnt vmcnt(4)
  buffer_load_dwordx4 a[0:3], v2, s[12:15], s25 offen offset:1024 nt
  buffer_load_dwordx4 a[4:7], v2, s[12:15], s25 offen offset:1152 nt
  s_waitcnt vmcnt(4)
  buffer_load_dwordx4 a[8:11], v2, s[12:15], s25 offen offset:2048 nt
  buffer_load_dwordx4 a[12:15], v2, s[12:15], s25 offen offset:2176 nt
  s_waitcnt vmcnt(4)
  buffer_load_dwordx4 a[16:19], v2, s[12:15], s25 offen offset:3072 nt
  buffer_load_dwordx4 a[20:23], v2, s[12:15], s25 offen offset:3200 nt
  s_waitcnt vmcnt(4)
  s_add_u32 s26, s21, 0x70000
  buffer_load_dwordx4 a[24:27], v2, s[12:15], s26 offen nt
  buffer_load_dwordx4 a[28:31], v2, s[12:15], s26 offen offset:128 nt
  s_waitcnt vmcnt(4)
  buffer_load_dwordx4 a[32:35], v2, s[12:15], s26 offen offset:1024 nt
  buffer_load_dwordx4 a[36:39], v2, s[12:15], s26 offen offset:1152 nt
  s_waitcnt vmcnt(4)
  buffer_load_dwordx4 a[40:43], v2, s[12:15], s26 offen offset:2048 nt
  buffer_load_dwordx4 a[44:47], v2, s[12:15], s26 offen offset:2176 nt
  s_waitcnt vmcnt(4)
  buffer_load_dwordx4 a[48:51], v2, s[12:15], s26 offen offset:3072 nt
  buffer_load_dwordx4 a[52:55], v2, s[12:15], s26 offen offset:3200 nt
  s_waitcnt vmcnt(4)
  s_add_u32 s27, s21, 0xa8000
  buffer_load_dwordx4 a[56:59], v2, s[12:15], s27 offen nt
  buffer_load_dwordx4 a[60:63], v2, s[12:15], s27 offen offset:128 nt
  s_waitcnt vmcnt(4)
  buffer_load_dwordx4 a[64:67], v2, s[12:15], s27 offen offset:1024 nt
  buffer_load_dwordx4 a[68:71], v2, s[12:15], s27 offen offset:1152 nt
  s_waitcnt vmcnt(4)
  buffer_load_dwordx4 a[72:75], v2, s[12:15], s27 offen offset:2048 nt
  buffer_load_dwordx4 a[76:79], v2, s[12:15], s27 offen offset:2176 nt
  s_waitcnt vmcnt(4)
  buffer_load_dwordx4 a[80:83], v2, s[12:15], s27 offen offset:3072 nt
  buffer_load_dwordx4 a[84:87], v2, s[12:15], s27 offen offset:3200 nt
  s_waitcnt vmcnt(4)
  s_add_u32 s24, s21, 0xe0000
  buffer_load_dwordx4 a[88:91], v2, s[12:15], s24 offen nt
  buffer_load_dwordx4 a[92:95], v2, s[12:15], s24 offen offset:128 nt
  s_waitcnt vmcnt(4)
  buffer_load_dwordx4 a[96:99], v2, s[12:15], s24 offen offset:1024 nt
  buffer_load_dwordx4 a[100:103], v2, s[12:15], s24 offen offset:1152 nt
  s_waitcnt vmcnt(4)
  buffer_load_dwordx4 a[104:107], v2, s[12:15], s24 offen offset:2048 nt
  buffer_load_dwordx4 a[108:111], v2, s[12:15], s24 offen offset:2176 nt
  s_waitcnt vmcnt(4)
  buffer_load_dwordx4 a[112:115], v2, s[12:15], s24 offen offset:3072 nt
  buffer_load_dwordx4 a[116:119], v2, s[12:15], s24 offen offset:3200 nt
  s_waitcnt vmcnt(4)
  s_add_u32 s25, s21, 0x118000
  buffer_load_dwordx4 a[120:123], v2, s[12:15], s25 offen nt
  buffer_load_dwordx4 a[124:127], v2, s[12:15], s25 offen offset:128 nt
  s_waitcnt vmcnt(4)
  buffer_load_dwordx4 a[128:131], v2, s[12:15], s25 offen offset:1024 nt
  buffer_load_dwordx4 a[132:135], v2, s[12:15], s25 offen offset:1152 nt
  v_and_b32 v7, 0xff, v1
  v_lshlrev_b32 v7, 1, v7
  s_add_u32 s48, s46, 0x4000
  buffer_load_dwordx4 v[28:31], v7, s[4:7], s48 offen sc1
  buffer_load_dwordx4 v[32:35], v7, s[4:7], s48 offen offset:16 sc1
  s_waitcnt vmcnt(0)
  v_min3_u32 v62, v29, v31, v33
  v_max3_u32 v63, v29, v31, v33
  v_min_u32 v62, v62, v35
  v_max_u32 v63, v63, v35
  v_cmp_ne_u32 vcc, s16, v62
  v_cmp_ne_u32 s[50:51], s16, v63
  s_nop 0
  s_or_b64 vcc, vcc, s[50:51]
  s_nop 2
  s_cbranch_vccz L_qok_1
  s_mov_b32 s29, 0x2000
L_qretry_2:
  s_sleep 2
  v_and_b32 v7, 0xff, v1
  v_lshlrev_b32 v7, 1, v7
  s_add_u32 s48, s46, 0x4000
  buffer_load_dwordx4 v[28:31], v7, s[4:7], s48 offen sc1
  buffer_load_dwordx4 v[32:35], v7, s[4:7], s48 offen offset:16 sc1
  s_waitcnt vmcnt(0)
  v_min3_u32 v62, v29, v31, v33
  v_max3_u32 v63, v29, v31, v33
  v_min_u32 v62, v62, v35
  v_max_u32 v63, v63, v35
  v_cmp_ne_u32 vcc, s16, v62
  v_cmp_ne_u32 s[50:51], s16, v63
  s_nop 0
  s_or_b64 vcc, vcc, s[50:51]
  s_sub_u32 s29, s29, 1
  s_nop 1
  s_cbranch_scc1 L_qok_1
  s_cbranch_vccnz L_qretry_2
L_qok_1:
  v_cndmask_b32_e64 v8, 0, v28, s[54:55]
  v_cndmask_b32_e64 v9, 0, v30, s[54:55]
  v_cndmask_b32_e64 v10, 0, v32, s[54:55]
  v_cndmask_b32_e64 v11, 0, v34, s[54:55]
  v_cndmask_b32_e64 v12, 0, v28, s[56:57]
  v_cndmask_b32_e64 v13, 0, v30, s[56:57]
  v_cndmask_b32_e64 v14, 0, v32, s[56:57]
  v_cndmask_b32_e64 v15, 0, v34, s[56:57]
  v_cndmask_b32_e64 v16, 0, v28, s[58:59]
  v_cndmask_b32_e64 v17, 0, v30, s[58:59]
  v_cndmask_b32_e64 v18, 0, v32, s[58:59]
  v_cndmask_b32_e64 v19, 0, v34, s[58:59]
  v_cndmask_b32_e64 v20, 0, v28, s[60:61]
  v_cndmask_b32_e64 v21, 0, v30, s[60:61]
  v_cndmask_b32_e64 v22, 0, v32, s[60:61]
  v_cndmask_b32_e64 v23, 0, v34, s[60:61]
  buffer_load_dwordx4 a[136:139], v2, s[12:15], s25 offen offset:2048 nt
  buffer_load_dwordx4 a[140:143], v2, s[12:15], s25 offen offset:2176 nt
  buffer_load_dwordx4 a[144:147], v2, s[12:15], s25 offen offset:3072 nt
  buffer_load_dwordx4 a[148:151], v2, s[12:15], s25 offen offset:3200 nt
  s_add_u32 s26, s21, 0x150000
  buffer_load_dwordx4 a[152:155], v2, s[12:15], s26 offen nt
  buffer_load_dwordx4 a[156:159], v2, s[12:15], s26 offen offset:128 nt
  v_mov_b32 v40, 0xff800000
  ds_read_b128 v[46:49], v5 offset:0
  ds_read_b128 v[50:53], v5 offset:1024
  ds_read_b128 v[54:57], v5 offset:2048
  s_waitcnt lgkmcnt(2)
  v_mfma_f32_16x16x32_bf16 v[24:27], v[46:49], v[8:11], 0
  ds_read_b128 v[58:61], v5 offset:3072
  s_waitcnt lgkmcnt(2)
  v_mfma_f32_16x16x32_bf16 v[24:27], v[50:53], v[12:15], v[24:27]
  ds_read_b128 v[46:49], v5 offset:4096
  s_waitcnt lgkmcnt(2)
  v_mfma_f32_16x16x32_bf16 v[24:27], v[54:57], v[16:19], v[24:27]
  ds_read_b128 v[50:53], v5 offset:5120
  s_waitcnt lgkmcnt(2)
  v_mfma_f32_16x16x32_bf16 v[24:27], v[58:61], v[20:23], v[24:27]
  ds_read_b128 v[54:57], v5 offset:6144
  s_waitcnt lgkmcnt(2)
  v_mfma_f32_16x16x32_bf16 v[28:31], v[46:49], v[8:11], 0
  ds_read_b128 v[58:61], v5 offset:7168
  s_waitcnt lgkmcnt(2)
  v_mfma_f32_16x16x32_bf16 v[28:31], v[50:53], v[12:15], v[28:31]
  ds_read_b128 v[46:49], v5 offset:8192
  s_waitcnt lgkmcnt(2)
  v_mfma_f32_16x16x32_bf16 v[28:31], v[54:57], v[16:19], v[28:31]
  ds_read_b128 v[50:53], v5 offset:9216
  s_waitcnt lgkmcnt(2)
  v_mfma_f32_16x16x32_bf16 v[28:31], v[58:61], v[20:23], v[28:31]
  ds_read_b128 v[54:57], v5 offset:10240
  s_waitcnt lgkmcnt(2)
  v_mfma_f32_16x16x32_bf16 v[32:35], v[46:49], v[8:11], 0
  v_add_f32_dpp v62, v25, v24 quad_perm:[1,1,1,1] row_mask:0xf bank_mask:0xf
  v_add_f32_dpp v63, v26, v27 quad_perm:[2,2,2,2] row_mask:0xf bank_mask:0xf
  ds_read_b128 v[58:61], v5 offset:11264
  s_waitcnt lgkmcnt(2)
  v_mfma_f32_16x16x32_bf16 v[32:35], v[50:53], v[12:15], v[32:35]
  ds_read_b128 v[46:49], v5 offset:12288
  s_waitcnt lgkmcnt(2)
  v_mfma_f32_16x16x32_bf16 v[32:35], v[54:57], v[16:19], v[32:35]
  v_add_f32_dpp v36, v63, v62 quad_perm:[3,3,3,3] row_mask:0xf bank_mask:0xf
  ds_read_b128 v[50:53], v5 offset:13312
  s_waitcnt lgkmcnt(2)
  v_mfma_f32_16x16x32_bf16 v[32:35], v[58:61], v[20:23], v[32:35]
  ds_read_b128 v[54:57], v5 offset:14336
  s_waitcnt lgkmcnt(2)
  v_mfma_f32_16x16x32_bf16 v[24:27], v[46:49], v[8:11], 0
  v_add_f32_dpp v62, v28, v29 quad_perm:[0,0,0,0] row_mask:0xf bank_mask:0xf
  v_add_f32_dpp v63, v30, v31 quad_perm:[2,2,2,2] row_mask:0xf bank_mask:0xf
  ds_read_b128 v[58:61], v5 offset:15360
  s_waitcnt lgkmcnt(2)
  v_mfma_f32_16x16x32_bf16 v[24:27], v[50:53], v[12:15], v[24:27]
  ds_read_b128 v[46:49], v5 offset:16384
  s_waitcnt lgkmcnt(2)
  v_mfma_f32_16x16x32_bf16 v[24:27], v[54:57], v[16:19], v[24:27]
  v_add_f32_dpp v62, v63, v62 quad_perm:[3,3,3,3] row_mask:0xf bank_mask:0xf
  ds_read_b128 v[50:53], v5 offset:17408
  s_waitcnt lgkmcnt(2)
  v_mfma_f32_16x16x32_bf16 v[24:27], v[58:61], v[20:23], v[24:27]
  v_cndmask_b32_e64 v36, v36, v62, s[32:33]
  ds_read_b128 v[54:57], v5 offset:18432
  s_waitcnt lgkmcnt(2)
  v_mfma_f32_16x16x32_bf16 v[28:31], v[46:49], v[8:11], 0
  v_add_f32_dpp v62, v32, v33 quad_perm:[0,0,0,0] row_mask:0xf bank_mask:0xf
  v_add_f32_dpp v63, v35, v34 quad_perm:[3,3,3,3] row_mask:0xf bank_mask:0xf
  ds_read_b128 v[58:61], v5 offset:19456
  s_waitcnt lgkmcnt(2)
  v_mfma_f32_16x16x32_bf16 v[28:31], v[50:53], v[12:15], v[28:31]
  ds_read_b128 v[46:49], v5 offset:20480
  s_waitcnt lgkmcnt(2)
  v_mfma_f32_16x16x32_bf16 v[28:31], v[54:57], v[16:19], v[28:31]
  v_add_f32_dpp v62, v62, v63 quad_perm:[1,1,1,1] row_mask:0xf bank_mask:0xf
  ds_read_b128 v[50:53], v5 offset:21504
  s_waitcnt lgkmcnt(2)
  v_mfma_f32_16x16x32_bf16 v[28:31], v[58:61], v[20:23], v[28:31]
  v_cndmask_b32_e64 v36, v36, v62, s[34:35]
  ds_read_b128 v[54:57], v5 offset:22528
  s_waitcnt lgkmcnt(2)
  v_mfma_f32_16x16x32_bf16 v[32:35], v[46:49], v[8:11], 0
  v_add_f32_dpp v62, v24, v25 quad_perm:[0,0,0,0] row_mask:0xf bank_mask:0xf
  v_add_f32_dpp v63, v26, v27 quad_perm:[2,2,2,2] row_mask:0xf bank_mask:0xf
  ds_read_b128 v[58:61], v5 offset:23552
  s_waitcnt lgkmcnt(2)
  v_mfma_f32_16x16x32_bf16 v[32:35], v[50:53], v[12:15], v[32:35]
  ds_read_b128 v[46:49], v5 offset:24576
  s_waitcnt lgkmcnt(2)
  v_mfma_f32_16x16x32_bf16 v[32:35], v[54:57], v[16:19], v[32:35]
  v_add_f32_dpp v62, v62, v63 quad_perm:[1,1,1,1] row_mask:0xf bank_mask:0xf
  ds_read_b128 v[50:53], v5 offset:25600
  s_waitcnt lgkmcnt(2)
  v_mfma_f32_16x16x32_bf16 v[32:35], v[58:61], v[20:23], v[32:35]
  v_cndmask_b32_e64 v36, v36, v62, s[36:37]
  ds_read_b128 v[54:57], v5 offset:26624
  s_waitcnt lgkmcnt(2)
  v_mfma_f32_16x16x32_bf16 v[24:27], v[46:49], v[8:11], 0
  v_add_f32_dpp v62, v29, v28 quad_perm:[1,1,1,1] row_mask:0xf bank_mask:0xf
  v_add_f32_dpp v63, v30, v31 quad_perm:[2,2,2,2] row_mask:0xf bank_mask:0xf
  ds_read_b128 v[58:61], v5 offset:27648
  s_waitcnt lgkmcnt(2)
  v_mfma_f32_16x16x32_bf16 v[24:27], v[50:53], v[12:15], v[24:27]
  ds_read_b128 v[46:49], v5 offset:28672
  s_waitcnt lgkmcnt(2)
  v_mfma_f32_16x16x32_bf16 v[24:27], v[54:57], v[16:19], v[24:27]
  v_add_f32_dpp v37, v63, v62 quad_perm:[3,3,3,3] row_mask:0xf bank_mask:0xf
  ds_read_b128 v[50:53], v5 offset:29696
  s_waitcnt lgkmcnt(2)
  v_mfma_f32_16x16x32_bf16 v[24:27], v[58:61], v[20:23], v[24:27]
  ds_read_b128 v[54:57], v5 offset:30720
  s_waitcnt lgkmcnt(2)
  v_mfma_f32_16x16x32_bf16 v[28:31], v[46:49], v[8:11], 0
  v_add_f32_dpp v62, v32, v33 quad_perm:[0,0,0,0] row_mask:0xf bank_mask:0xf
  v_add_f32_dpp v63, v34, v35 quad_perm:[2,2,2,2] row_mask:0xf bank_mask:0xf
  ds_read_b128 v[58:61], v5 offset:31744
  s_waitcnt lgkmcnt(2)
  v_mfma_f32_16x16x32_bf16 v[28:31], v[50:53], v[12:15], v[28:31]
  ds_read_b128 v[46:49], v5 offset:32768
  s_waitcnt lgkmcnt(2)
  v_mfma_f32_16x16x32_bf16 v[28:31], v[54:57], v[16:19], v[28:31]
  v_add_f32_dpp v62, v63, v62 quad_perm:[3,3,3,3] row_mask:0xf bank_mask:0xf
  ds_read_b128 v[50:53], v5 offset:33792
  s_waitcnt lgkmcnt(2)
  v_mfma_f32_16x16x32_bf16 v[28:31], v[58:61], v[20:23], v[28:31]
  v_cndmask_b32_e64 v37, v37, v62, s[32:33]
  ds_read_b128 v[54:57], v5 offset:34816
  s_waitcnt lgkmcnt(2)
  v_mfma_f32_16x16x32_bf16 v[32:35], v[46:49], v[8:11], 0
  v_add_f32_dpp v62, v24, v25 quad_perm:[0,0,0,0] row_mask:0xf bank_mask:0xf
  v_add_f32_dpp v63, v27, v26 quad_perm:[3,3,3,3] row_mask:0xf bank_mask:0xf
  ds_read_b128 v[58:61], v5 offset:35840
  s_waitcnt lgkmcnt(2)
  v_mfma_f32_16x16x32_bf16 v[32:35], v[50:53], v[12:15], v[32:35]
  ds_read_b128 v[46:49], v5 offset:36864
  s_waitcnt lgkmcnt(2)
  v_mfma_f32_16x16x32_bf16 v[32:35], v[54:57], v[16:19], v[32:35]
  v_add_f32_dpp v62, v62, v63 quad_perm:[1,1,1,1] row_mask:0xf bank_mask:0xf
  ds_read_b128 v[50:53], v5 offset:37888
  s_waitcnt lgkmcnt(2)
  v_mfma_f32_16x16x32_bf16 v[32:35], v[58:61], v[20:23], v[32:35]
  v_cndmask_b32_e64 v37, v37, v62, s[34:35]
  s_waitcnt lgkmcnt(1)
  v_mfma_f32_16x16x32_bf16 v[24:27], v[46:49], v[8:11], 0
  v_add_f32_dpp v62, v28, v29 quad_perm:[0,0,0,0] row_mask:0xf bank_mask:0xf
  v_add_f32_dpp v63, v30, v31 quad_perm:[2,2,2,2] row_mask:0xf bank_mask:0xf
  s_waitcnt lgkmcnt(0)
  v_mfma_f32_16x16x32_bf16 v[24:27], v[50:53], v[12:15], v[24:27]
  v_mfma_f32_16x16x32_bf16 v[24:27], v[64:67], v[16:19], v[24:27]
  v_add_f32_dpp v62, v62, v63 quad_perm:[1,1,1,1] row_mask:0xf bank_mask:0xf
  v_mfma_f32_16x16x32_bf16 v[24:27], v[68:71], v[20:23], v[24:27]
  v_cndmask_b32_e64 v37, v37, v62, s[36:37]
  v_mfma_f32_16x16x32_bf16 v[28:31], v[72:75], v[8:11], 0
  v_add_f32_dpp v62, v33, v32 quad_perm:[1,1,1,1] row_mask:0xf bank_mask:0xf
  v_add_f32_dpp v63, v34, v35 quad_perm:[2,2,2,2] row_mask:0xf bank_mask:0xf
  v_mfma_f32_16x16x32_bf16 v[28:31], v[76:79], v[12:15], v[28:31]
  v_mfma_f32_16x16x32_bf16 v[28:31], v[80:83], v[16:19], v[28:31]
  v_add_f32_dpp v38, v63, v62 quad_perm:[3,3,3,3] row_mask:0xf bank_mask:0xf
  v_mfma_f32_16x16x32_bf16 v[28:31], v[84:87], v[20:23], v[28:31]
  v_mfma_f32_16x16x32_bf16 v[32:35], v[88:91], v[8:11], 0
  v_add_f32_dpp v62, v24, v25 quad_perm:[0,0,0,0] row_mask:0xf bank_mask:0xf
  v_add_f32_dpp v63, v26, v27 quad_perm:[2,2,2,2] row_mask:0xf bank_mask:0xf
  v_mfma_f32_16x16x32_bf16 v[32:35], v[92:95], v[12:15], v[32:35]
  v_mfma_f32_16x16x32_bf16 v[32:35], v[96:99], v[16:19], v[32:35]
  v_add_f32_dpp v62, v63, v62 quad_perm:[3,3,3,3] row_mask:0xf bank_mask:0xf
  v_mfma_f32_16x16x32_bf16 v[32:35], v[100:103], v[20:23], v[32:35]
  v_cndmask_b32_e64 v38, v38, v62, s[32:33]
  v_mfma_f32_16x16x32_bf16 v[24:27], v[104:107], v[8:11], 0
  v_add_f32_dpp v62, v28, v29 quad_perm:[0,0,0,0] row_mask:0xf bank_mask:0xf
  v_add_f32_dpp v63, v31, v30 quad_perm:[3,3,3,3] row_mask:0xf bank_mask:0xf
  v_mfma_f32_16x16x32_bf16 v[24:27], v[108:111], v[12:15], v[24:27]
  v_mfma_f32_16x16x32_bf16 v[24:27], v[112:115], v[16:19], v[24:27]
  v_add_f32_dpp v62, v62, v63 quad_perm:[1,1,1,1] row_mask:0xf bank_mask:0xf
  v_mfma_f32_16x16x32_bf16 v[24:27], v[116:119], v[20:23], v[24:27]
  v_cndmask_b32_e64 v38, v38, v62, s[34:35]
  v_mfma_f32_16x16x32_bf16 v[28:31], v[120:123], v[8:11], 0
  v_add_f32_dpp v62, v32, v33 quad_perm:[0,0,0,0] row_mask:0xf bank_mask:0xf
  v_add_f32_dpp v63, v34, v35 quad_perm:[2,2,2,2] row_mask:0xf bank_mask:0xf
  v_mfma_f32_16x16x32_bf16 v[28:31], v[124:127], v[12:15], v[28:31]
  v_mfma_f32_16x16x32_bf16 v[28:31], v[128:131], v[16:19], v[28:31]
  v_add_f32_dpp v62, v62, v63 quad_perm:[1,1,1,1] row_mask:0xf bank_mask:0xf
  v_mfma_f32_16x16x32_bf16 v[28:31], v[132:135], v[20:23], v[28:31]
  v_cndmask_b32_e64 v38, v38, v62, s[36:37]
  v_mfma_f32_16x16x32_bf16 v[32:35], v[136:139], v[8:11], 0
  v_add_f32_dpp v62, v25, v24 quad_perm:[1,1,1,1] row_mask:0xf bank_mask:0xf
  v_add_f32_dpp v63, v26, v27 quad_perm:[2,2,2,2] row_mask:0xf bank_mask:0xf
  v_mfma_f32_16x16x32_bf16 v[32:35], v[140:143], v[12:15], v[32:35]
  v_mfma_f32_16x16x32_bf16 v[32:35], v[144:147], v[16:19], v[32:35]
  v_add_f32_dpp v39, v63, v62 quad_perm:[3,3,3,3] row_mask:0xf bank_mask:0xf
  v_mfma_f32_16x16x32_bf16 v[32:35], v[148:151], v[20:23], v[32:35]
  v_mfma_f32_16x16x32_bf16 v[24:27], v[152:155], v[8:11], 0
  v_add_f32_dpp v62, v28, v29 quad_perm:[0,0,0,0] row_mask:0xf bank_mask:0xf
  v_add_f32_dpp v63, v30, v31 quad_perm:[2,2,2,2] row_mask:0xf bank_mask:0xf
  v_mfma_f32_16x16x32_bf16 v[24:27], v[156:159], v[12:15], v[24:27]
  v_mfma_f32_16x16x32_bf16 v[24:27], v[160:163], v[16:19], v[24:27]
  v_add_f32_dpp v62, v63, v62 quad_perm:[3,3,3,3] row_mask:0xf bank_mask:0xf
  v_mfma_f32_16x16x32_bf16 v[24:27], v[164:167], v[20:23], v[24:27]
  v_cndmask_b32_e64 v39, v39, v62, s[32:33]
  v_mfma_f32_16x16x32_bf16 v[28:31], v[168:171], v[8:11], 0
  v_add_f32_dpp v62, v32, v33 quad_perm:[0,0,0,0] row_mask:0xf bank_mask:0xf
  v_add_f32_dpp v63, v35, v34 quad_perm:[3,3,3,3] row_mask:0xf bank_mask:0xf
  v_mfma_f32_16x16x32_bf16 v[28:31], v[172:175], v[12:15], v[28:31]
  v_mfma_f32_16x16x32_bf16 v[28:31], v[176:179], v[16:19], v[28:31]
  v_add_f32_dpp v62, v62, v63 quad_perm:[1,1,1,1] row_mask:0xf bank_mask:0xf
  v_mfma_f32_16x16x32_bf16 v[28:31], v[180:183], v[20:23], v[28:31]
  v_cndmask_b32_e64 v39, v39, v62, s[34:35]
  v_mfma_f32_16x16x32_bf16 v[32:35], v[184:187], v[8:11], 0
  v_add_f32_dpp v62, v24, v25 quad_perm:[0,0,0,0] row_mask:0xf bank_mask:0xf
  v_add_f32_dpp v63, v26, v27 quad_perm:[2,2,2,2] row_mask:0xf bank_mask:0xf
  v_mfma_f32_16x16x32_bf16 v[32:35], v[188:191], v[12:15], v[32:35]
  v_mfma_f32_16x16x32_bf16 v[32:35], v[192:195], v[16:19], v[32:35]
  v_add_f32_dpp v62, v62, v63 quad_perm:[1,1,1,1] row_mask:0xf bank_mask:0xf
  v_mfma_f32_16x16x32_bf16 v[32:35], v[196:199], v[20:23], v[32:35]
  v_cndmask_b32_e64 v39, v39, v62, s[36:37]
  v_mfma_f32_16x16x32_bf16 v[24:27], v[200:203], v[8:11], 0
  v_add_f32_dpp v62, v29, v28 quad_perm:[1,1,1,1] row_mask:0xf bank_mask:0xf
  v_add_f32_dpp v63, v30, v31 quad_perm:[2,2,2,2] row_mask:0xf bank_mask:0xf
  v_mfma_f32_16x16x32_bf16 v[24:27], v[204:207], v[12:15], v[24:27]
  v_mfma_f32_16x16x32_bf16 v[24:27], v[208:211], v[16:19], v[24:27]
  v_add_f32_dpp v62, v63, v62 quad_perm:[3,3,3,3] row_mask:0xf bank_mask:0xf
  v_mfma_f32_16x16x32_bf16 v[24:27], v[212:215], v[20:23], v[24:27]
  v_cndmask_b32_e64 v40, v40, v62, s[30:31]
  v_add_f32_dpp v62, v32, v33 quad_perm:[0,0,0,0] row_mask:0xf bank_mask:0xf
  v_add_f32_dpp v63, v34, v35 quad_perm:[2,2,2,2] row_mask:0xf bank_mask:0xf
  s_nop 1
  v_add_f32_dpp v62, v63, v62 quad_perm:[3,3,3,3] row_mask:0xf bank_mask:0xf
  v_cndmask_b32_e64 v40, v40, v62, s[32:33]
  s_nop 0
  v_add_f32_dpp v62, v24, v25 quad_perm:[0,0,0,0] row_mask:0xf bank_mask:0xf
  v_add_f32_dpp v63, v27, v26 quad_perm:[3,3,3,3] row_mask:0xf bank_mask:0xf
  s_nop 1
  v_add_f32_dpp v62, v62, v63 quad_perm:[1,1,1,1] row_mask:0xf bank_mask:0xf
  v_cndmask_b32_e64 v40, v40, v62, s[38:39]
  v_cvt_pk_bf16_f32 v36, v36, v36
  v_cvt_pk_bf16_f32 v37, v37, v37
  v_cvt_pk_bf16_f32 v38, v38, v38
  v_cvt_pk_bf16_f32 v39, v39, v39
  v_cvt_pk_bf16_f32 v40, v40, v40
  v_and_b32 v36, 0xffff0000, v36
  v_and_b32 v37, 0xffff0000, v37
  v_and_b32 v38, 0xffff0000, v38
  v_and_b32 v39, 0xffff0000, v39
  v_and_b32 v40, 0xffff0000, v40
  v_mul_f32 v36, s53, v36
  v_mul_f32 v37, s53, v37
  v_mul_f32 v38, s53, v38
  v_mul_f32 v39, s53, v39
  v_mul_f32 v40, s53, v40
  v_cvt_pk_bf16_f32 v36, v36, v36
  v_cvt_pk_bf16_f32 v37, v37, v37
  v_cvt_pk_bf16_f32 v38, v38, v38
  v_cvt_pk_bf16_f32 v39, v39, v39
  v_cvt_pk_bf16_f32 v40, v40, v40
  v_and_b32 v36, 0xffff0000, v36
  v_and_b32 v37, 0xffff0000, v37
  v_and_b32 v38, 0xffff0000, v38
  v_and_b32 v39, 0xffff0000, v39
  v_and_b32 v40, 0xffff0000, v40
  v_max3_f32 v62, v36, v37, v38
  v_max3_f32 v62, v62, v39, v40
  s_nop 1
  v_max_f32_dpp v62, v62, v62 row_shr:1 row_mask:0xf bank_mask:0xf
  s_nop 1
  v_max_f32_dpp v62, v62, v62 row_shr:2 row_mask:0xf bank_mask:0xf
  s_nop 1
  v_max_f32_dpp v62, v62, v62 row_shr:4 row_mask:0xf bank_mask:0xf
  s_nop 1
  v_max_f32_dpp v62, v62, v62 row_shr:8 row_mask:0xf bank_mask:0xf
  s_nop 1
  v_max_f32_dpp v62, v62, v62 row_bcast:15 row_mask:0xa bank_mask:0xf
  s_nop 1
  v_max_f32_dpp v62, v62, v62 row_bcast:31 row_mask:0xc bank_mask:0xf
  s_nop 0
  v_readlane_b32 s43, v62, 63
  s_nop 1
  v_mov_b32 v63, s43
  v_mul_f32 v63, s28, v63
  v_fma_f32 v36, v36, s28, -v63
  v_fma_f32 v37, v37, s28, -v63
  v_fma_f32 v38, v38, s28, -v63
  v_fma_f32 v39, v39, s28, -v63
  v_fma_f32 v40, v40, s28, -v63
  v_exp_f32 v36, v36
  v_exp_f32 v37, v37
  v_exp_f32 v38, v38
  v_exp_f32 v39, v39
  v_exp_f32 v40, v40
  v_add_f32 v62, v36, v37
  v_add_f32 v63, v38, v39
  v_add_f32 v62, v62, v40
  v_cvt_pk_bf16_f32 v36, v36, v36
  v_cvt_pk_bf16_f32 v37, v37, v37
  v_cvt_pk_bf16_f32 v38, v38, v38
  v_cvt_pk_bf16_f32 v39, v39, v39
  v_cvt_pk_bf16_f32 v40, v40, v40
  v_add_f32 v62, v62, v63
  v_and_b32 v7, 0xff, v1
  v_lshlrev_b32 v7, 1, v7
  s_add_u32 s48, s46, 0x0
  buffer_load_dwordx4 v[28:31], v7, s[4:7], s48 offen sc1
  buffer_load_dwordx4 v[32:35], v7, s[4:7], s48 offen offset:16 sc1
  v_and_b32_dpp v24, v36, v4 quad_perm:[0,0,1,1] row_mask:0xf bank_mask:0xf
  v_mov_b32 v8, 0
  v_mov_b32 v9, 0
  v_mov_b32 v10, 0
  v_mov_b32 v11, 0
  v_mov_b32 v12, 0
  v_mov_b32 v13, 0
  v_mov_b32 v14, 0
  v_mov_b32 v15, 0
  v_mov_b32_dpp v8, v24 quad_perm:[0,1,2,3] row_mask:0xf bank_mask:0x1
  v_mov_b32_dpp v9, v24 row_ror:4 row_mask:0xf bank_mask:0x2
  v_mov_b32_dpp v10, v24 row_ror:8 row_mask:0xf bank_mask:0x4
  v_mov_b32_dpp v11, v24 row_ror:12 row_mask:0xf bank_mask:0x8
  s_nop 1
  v_mfma_f32_16x16x32_bf16 v[16:19], v[216:219], v[8:11], 0
  v_mov_b32_dpp v12, v24 row_ror:12 row_mask:0xf bank_mask:0x1
  v_mov_b32_dpp v13, v24 quad_perm:[0,1,2,3] row_mask:0xf bank_mask:0x2
  v_mfma_f32_16x16x32_bf16 v[20:23], v[220:223], v[8:11], 0
  v_mov_b32_dpp v14, v24 row_ror:4 row_mask:0xf bank_mask:0x4
  v_mov_b32_dpp v15, v24 row_ror:8 row_mask:0xf bank_mask:0x8
  v_add_f32_dpp v62, v62, v62 row_shr:1 row_mask:0xf bank_mask:0xf
  s_nop 0
  v_mfma_f32_16x16x32_bf16 v[16:19], v[224:227], v[12:15], v[16:19]
  v_mov_b32_dpp v8, v24 row_ror:8 row_mask:0xf bank_mask:0x1
  v_mov_b32_dpp v9, v24 row_ror:12 row_mask:0xf bank_mask:0x2
  v_and_b32_dpp v25, v36, v4 quad_perm:[2,2,3,3] row_mask:0xf bank_mask:0xf
  v_mfma_f32_16x16x32_bf16 v[20:23], v[228:231], v[12:15], v[20:23]
  v_mov_b32_dpp v10, v24 quad_perm:[0,1,2,3] row_mask:0xf bank_mask:0x4
  v_mov_b32_dpp v11, v24 row_ror:4 row_mask:0xf bank_mask:0x8
  v_add_f32_dpp v62, v62, v62 row_shr:2 row_mask:0xf bank_mask:0xf
  s_nop 0
  v_mfma_f32_16x16x32_bf16 v[16:19], v[232:235], v[8:11], v[16:19]
  v_mov_b32_dpp v12, v24 row_ror:4 row_mask:0xf bank_mask:0x1
  v_mov_b32_dpp v13, v24 row_ror:8 row_mask:0xf bank_mask:0x2
  v_mfma_f32_16x16x32_bf16 v[20:23], v[236:239], v[8:11], v[20:23]
  v_mov_b32_dpp v14, v24 row_ror:12 row_mask:0xf bank_mask:0x4
  v_mov_b32_dpp v15, v24 quad_perm:[0,1,2,3] row_mask:0xf bank_mask:0x8
  v_add_f32_dpp v62, v62, v62 row_shr:4 row_mask:0xf bank_mask:0xf
  s_nop 0
  v_mfma_f32_16x16x32_bf16 v[16:19], v[240:243], v[12:15], v[16:19]
  v_mov_b32_dpp v8, v25 quad_perm:[0,1,2,3] row_mask:0xf bank_mask:0x1
  v_mov_b32_dpp v9, v25 row_ror:4 row_mask:0xf bank_mask:0x2
  v_mfma_f32_16x16x32_bf16 v[20:23], v[244:247], v[12:15], v[20:23]
  v_mov_b32_dpp v10, v25 row_ror:8 row_mask:0xf bank_mask:0x4
  v_mov_b32_dpp v11, v25 row_ror:12 row_mask:0xf bank_mask:0x8
  v_add_f32_dpp v62, v62, v62 row_shr:8 row_mask:0xf bank_mask:0xf
  s_nop 0
  v_mfma_f32_16x16x32_bf16 v[16:19], v[248:251], v[8:11], v[16:19]
  v_mov_b32_dpp v12, v25 row_ror:12 row_mask:0xf bank_mask:0x1
  v_mov_b32_dpp v13, v25 quad_perm:[0,1,2,3] row_mask:0xf bank_mask:0x2
  v_mfma_f32_16x16x32_bf16 v[20:23], v[252:255], v[8:11], v[20:23]
  v_mov_b32_dpp v14, v25 row_ror:4 row_mask:0xf bank_mask:0x4
  v_mov_b32_dpp v15, v25 row_ror:8 row_mask:0xf bank_mask:0x8
  v_add_f32_dpp v62, v62, v62 row_bcast:15 row_mask:0xa bank_mask:0xf
  s_nop 0
  v_mfma_f32_16x16x32_bf16 v[16:19], a[0:3], v[12:15], v[16:19]
  v_mov_b32_dpp v8, v25 row_ror:8 row_mask:0xf bank_mask:0x1
  v_mov_b32_dpp v9, v25 row_ror:12 row_mask:0xf bank_mask:0x2
  v_and_b32_dpp v24, v37, v4 quad_perm:[0,0,1,1] row_mask:0xf bank_mask:0xf
  v_mfma_f32_16x16x32_bf16 v[20:23], a[4:7], v[12:15], v[20:23]
  v_mov_b32_dpp v10, v25 quad_perm:[0,1,2,3] row_mask:0xf bank_mask:0x4
  v_mov_b32_dpp v11, v25 row_ror:4 row_mask:0xf bank_mask:0x8
  v_add_f32_dpp v62, v62, v62 row_bcast:31 row_mask:0xc bank_mask:0xf
  s_nop 0
  v_mfma_f32_16x16x32_bf16 v[16:19], a[8:11], v[8:11], v[16:19]
  v_mov_b32_dpp v12, v25 row_ror:4 row_mask:0xf bank_mask:0x1
  v_mov_b32_dpp v13, v25 row_ror:8 row_mask:0xf bank_mask:0x2
  v_mfma_f32_16x16x32_bf16 v[20:23], a[12:15], v[8:11], v[20:23]
  v_mov_b32_dpp v14, v25 row_ror:12 row_mask:0xf bank_mask:0x4
  v_mov_b32_dpp v15, v25 quad_perm:[0,1,2,3] row_mask:0xf bank_mask:0x8
  v_readlane_b32 s45, v62, 63
  s_nop 0
  v_mfma_f32_16x16x32_bf16 v[16:19], a[16:19], v[12:15], v[16:19]
  v_mov_b32_dpp v8, v24 quad_perm:[0,1,2,3] row_mask:0xf bank_mask:0x1
  v_mov_b32_dpp v9, v24 row_ror:4 row_mask:0xf bank_mask:0x2
  v_mfma_f32_16x16x32_bf16 v[20:23], a[20:23], v[12:15], v[20:23]
  v_mov_b32_dpp v10, v24 row_ror:8 row_mask:0xf bank_mask:0x4
  v_mov_b32_dpp v11, v24 row_ror:12 row_mask:0xf bank_mask:0x8
  s_nop 1
  v_mfma_f32_16x16x32_bf16 v[16:19], a[24:27], v[8:11], v[16:19]
  v_mov_b32_dpp v12, v24 row_ror:12 row_mask:0xf bank_mask:0x1
  v_mov_b32_dpp v13, v24 quad_perm:[0,1,2,3] row_mask:0xf bank_mask:0x2
  v_mfma_f32_16x16x32_bf16 v[20:23], a[28:31], v[8:11], v[20:23]
  v_mov_b32_dpp v14, v24 row_ror:4 row_mask:0xf bank_mask:0x4
  v_mov_b32_dpp v15, v24 row_ror:8 row_mask:0xf bank_mask:0x8
  s_nop 1
  v_mfma_f32_16x16x32_bf16 v[16:19], a[32:35], v[12:15], v[16:19]
  v_mov_b32_dpp v8, v24 row_ror:8 row_mask:0xf bank_mask:0x1
  v_mov_b32_dpp v9, v24 row_ror:12 row_mask:0xf bank_mask:0x2
  v_and_b32_dpp v25, v37, v4 quad_perm:[2,2,3,3] row_mask:0xf bank_mask:0xf
  v_mfma_f32_16x16x32_bf16 v[20:23], a[36:39], v[12:15], v[20:23]
  v_mov_b32_dpp v10, v24 quad_perm:[0,1,2,3] row_mask:0xf bank_mask:0x4
  v_mov_b32_dpp v11, v24 row_ror:4 row_mask:0xf bank_mask:0x8
  s_nop 1
  v_mfma_f32_16x16x32_bf16 v[16:19], a[40:43], v[8:11], v[16:19]
  v_mov_b32_dpp v12, v24 row_ror:4 row_mask:0xf bank_mask:0x1
  v_mov_b32_dpp v13, v24 row_ror:8 row_mask:0xf bank_mask:0x2
  v_mfma_f32_16x16x32_bf16 v[20:23], a[44:47], v[8:11], v[20:23]
  v_mov_b32_dpp v14, v24 row_ror:12 row_mask:0xf bank_mask:0x4
  v_mov_b32_dpp v15, v24 quad_perm:[0,1,2,3] row_mask:0xf bank_mask:0x8
  s_nop 1
  v_mfma_f32_16x16x32_bf16 v[16:19], a[48:51], v[12:15], v[16:19]
  v_mov_b32_dpp v8, v25 quad_perm:[0,1,2,3] row_mask:0xf bank_mask:0x1
  v_mov_b32_dpp v9, v25 row_ror:4 row_mask:0xf bank_mask:0x2
  v_mfma_f32_16x16x32_bf16 v[20:23], a[52:55], v[12:15], v[20:23]
  v_mov_b32_dpp v10, v25 row_ror:8 row_mask:0xf bank_mask:0x4
  v_mov_b32_dpp v11, v25 row_ror:12 row_mask:0xf bank_mask:0x8
  s_nop 1
  v_mfma_f32_16x16x32_bf16 v[16:19], a[56:59], v[8:11], v[16:19]
  v_mov_b32_dpp v12, v25 row_ror:12 row_mask:0xf bank_mask:0x1
  v_mov_b32_dpp v13, v25 quad_perm:[0,1,2,3] row_mask:0xf bank_mask:0x2
  v_mfma_f32_16x16x32_bf16 v[20:23], a[60:63], v[8:11], v[20:23]
  v_mov_b32_dpp v14, v25 row_ror:4 row_mask:0xf bank_mask:0x4
  v_mov_b32_dpp v15, v25 row_ror:8 row_mask:0xf bank_mask:0x8
  s_nop 1
  v_mfma_f32_16x16x32_bf16 v[16:19], a[64:67], v[12:15], v[16:19]
  v_mov_b32_dpp v8, v25 row_ror:8 row_mask:0xf bank_mask:0x1
  v_mov_b32_dpp v9, v25 row_ror:12 row_mask:0xf bank_mask:0x2
  v_and_b32_dpp v24, v38, v4 quad_perm:[0,0,1,1] row_mask:0xf bank_mask:0xf
  v_mfma_f32_16x16x32_bf16 v[20:23], a[68:71], v[12:15], v[20:23]
  v_mov_b32_dpp v10, v25 quad_perm:[0,1,2,3] row_mask:0xf bank_mask:0x4
  v_mov_b32_dpp v11, v25 row_ror:4 row_mask:0xf bank_mask:0x8
  s_nop 1
  v_mfma_f32_16x16x32_bf16 v[16:19], a[72:75], v[8:11], v[16:19]
  v_mov_b32_dpp v12, v25 row_ror:4 row_mask:0xf bank_mask:0x1
  v_mov_b32_dpp v13, v25 row_ror:8 row_mask:0xf bank_mask:0x2
  v_mfma_f32_16x16x32_bf16 v[20:23], a[76:79], v[8:11], v[20:23]
  v_mov_b32_dpp v14, v25 row_ror:12 row_mask:0xf bank_mask:0x4
  v_mov_b32_dpp v15, v25 quad_perm:[0,1,2,3] row_mask:0xf bank_mask:0x8
  s_nop 1
  v_mfma_f32_16x16x32_bf16 v[16:19], a[80:83], v[12:15], v[16:19]
  v_mov_b32_dpp v8, v24 quad_perm:[0,1,2,3] row_mask:0xf bank_mask:0x1
  v_mov_b32_dpp v9, v24 row_ror:4 row_mask:0xf bank_mask:0x2
  v_mfma_f32_16x16x32_bf16 v[20:23], a[84:87], v[12:15], v[20:23]
  v_mov_b32_dpp v10, v24 row_ror:8 row_mask:0xf bank_mask:0x4
  v_mov_b32_dpp v11, v24 row_ror:12 row_mask:0xf bank_mask:0x8
  s_nop 1
  v_mfma_f32_16x16x32_bf16 v[16:19], a[88:91], v[8:11], v[16:19]
  v_mov_b32_dpp v12, v24 row_ror:12 row_mask:0xf bank_mask:0x1
  v_mov_b32_dpp v13, v24 quad_perm:[0,1,2,3] row_mask:0xf bank_mask:0x2
  v_mfma_f32_16x16x32_bf16 v[20:23], a[92:95], v[8:11], v[20:23]
  v_mov_b32_dpp v14, v24 row_ror:4 row_mask:0xf bank_mask:0x4
  v_mov_b32_dpp v15, v24 row_ror:8 row_mask:0xf bank_mask:0x8
  s_nop 1
  v_mfma_f32_16x16x32_bf16 v[16:19], a[96:99], v[12:15], v[16:19]
  v_mov_b32_dpp v8, v24 row_ror:8 row_mask:0xf bank_mask:0x1
  v_mov_b32_dpp v9, v24 row_ror:12 row_mask:0xf bank_mask:0x2
  v_and_b32_dpp v25, v38, v4 quad_perm:[2,2,3,3] row_mask:0xf bank_mask:0xf
  v_mfma_f32_16x16x32_bf16 v[20:23], a[100:103], v[12:15], v[20:23]
  v_mov_b32_dpp v10, v24 quad_perm:[0,1,2,3] row_mask:0xf bank_mask:0x4
  v_mov_b32_dpp v11, v24 row_ror:4 row_mask:0xf bank_mask:0x8
  s_nop 1
  v_mfma_f32_16x16x32_bf16 v[16:19], a[104:107], v[8:11], v[16:19]
  v_mov_b32_dpp v12, v24 row_ror:4 row_mask:0xf bank_mask:0x1
  v_mov_b32_dpp v13, v24 row_ror:8 row_mask:0xf bank_mask:0x2
  v_mfma_f32_16x16x32_bf16 v[20:23], a[108:111], v[8:11], v[20:23]
  v_mov_b32_dpp v14, v24 row_ror:12 row_mask:0xf bank_mask:0x4
  v_mov_b32_dpp v15, v24 quad_perm:[0,1,2,3] row_mask:0xf bank_mask:0x8
  s_nop 1
  v_mfma_f32_16x16x32_bf16 v[16:19], a[112:115], v[12:15], v[16:19]
  v_mov_b32_dpp v8, v25 quad_perm:[0,1,2,3] row_mask:0xf bank_mask:0x1
  v_mov_b32_dpp v9, v25 row_ror:4 row_mask:0xf bank_mask:0x2
  v_mfma_f32_16x16x32_bf16 v[20:23], a[116:119], v[12:15], v[20:23]
  v_mov_b32_dpp v10, v25 row_ror:8 row_mask:0xf bank_mask:0x4
  v_mov_b32_dpp v11, v25 row_ror:12 row_mask:0xf bank_mask:0x8
  s_nop 1
  v_mfma_f32_16x16x32_bf16 v[16:19], a[120:123], v[8:11], v[16:19]
  v_mov_b32_dpp v12, v25 row_ror:12 row_mask:0xf bank_mask:0x1
  v_mov_b32_dpp v13, v25 quad_perm:[0,1,2,3] row_mask:0xf bank_mask:0x2
  v_mfma_f32_16x16x32_bf16 v[20:23], a[124:127], v[8:11], v[20:23]
  v_mov_b32_dpp v14, v25 row_ror:4 row_mask:0xf bank_mask:0x4
  v_mov_b32_dpp v15, v25 row_ror:8 row_mask:0xf bank_mask:0x8
  s_nop 1
  v_mfma_f32_16x16x32_bf16 v[16:19], a[128:131], v[12:15], v[16:19]
  v_mov_b32_dpp v8, v25 row_ror:8 row_mask:0xf bank_mask:0x1
  v_mov_b32_dpp v9, v25 row_ror:12 row_mask:0xf bank_mask:0x2
  v_and_b32_dpp v24, v39, v4 quad_perm:[0,0,1,1] row_mask:0xf bank_mask:0xf
  v_mfma_f32_16x16x32_bf16 v[20:23], a[132:135], v[12:15], v[20:23]
  v_mov_b32_dpp v10, v25 quad_perm:[0,1,2,3] row_mask:0xf bank_mask:0x4
  v_mov_b32_dpp v11, v25 row_ror:4 row_mask:0xf bank_mask:0x8
  s_waitcnt vmcnt(7)
  s_nop 0
  v_mfma_f32_16x16x32_bf16 v[16:19], a[136:139], v[8:11], v[16:19]
  v_mov_b32_dpp v12, v25 row_ror:4 row_mask:0xf bank_mask:0x1
  v_mov_b32_dpp v13, v25 row_ror:8 row_mask:0xf bank_mask:0x2
  s_waitcnt vmcnt(6)
  v_mfma_f32_16x16x32_bf16 v[20:23], a[140:143], v[8:11], v[20:23]
  v_mov_b32_dpp v14, v25 row_ror:12 row_mask:0xf bank_mask:0x4
  v_mov_b32_dpp v15, v25 quad_perm:[0,1,2,3] row_mask:0xf bank_mask:0x8
  s_waitcnt vmcnt(5)
  s_nop 0
  v_mfma_f32_16x16x32_bf16 v[16:19], a[144:147], v[12:15], v[16:19]
  buffer_load_dwordx4 a[160:163], v2, s[12:15], s26 offen offset:1024 nt
  v_mov_b32_dpp v8, v24 quad_perm:[0,1,2,3] row_mask:0xf bank_mask:0x1
  v_mov_b32_dpp v9, v24 row_ror:4 row_mask:0xf bank_mask:0x2
  s_waitcnt vmcnt(5)
  v_mfma_f32_16x16x32_bf16 v[20:23], a[148:151], v[12:15], v[20:23]
  buffer_load_dwordx4 a[164:167], v2, s[12:15], s26 offen offset:1152 nt
  v_mov_b32_dpp v10, v24 row_ror:8 row_mask:0xf bank_mask:0x4
  v_mov_b32_dpp v11, v24 row_ror:12 row_mask:0xf bank_mask:0x8
  s_waitcnt vmcnt(5)
  s_nop 0
  v_mfma_f32_16x16x32_bf16 v[16:19], a[152:155], v[8:11], v[16:19]
  buffer_load_dwordx4 a[168:171], v2, s[12:15], s26 offen offset:2048 nt
  v_mov_b32_dpp v12, v24 row_ror:12 row_mask:0xf bank_mask:0x1
  v_mov_b32_dpp v13, v24 quad_perm:[0,1,2,3] row_mask:0xf bank_mask:0x2
  s_waitcnt vmcnt(5)
  v_mfma_f32_16x16x32_bf16 v[20:23], a[156:159], v[8:11], v[20:23]
  buffer_load_dwordx4 a[172:175], v2, s[12:15], s26 offen offset:2176 nt
  v_mov_b32_dpp v14, v24 row_ror:4 row_mask:0xf bank_mask:0x4
  v_mov_b32_dpp v15, v24 row_ror:8 row_mask:0xf bank_mask:0x8
  s_waitcnt vmcnt(3)
  s_nop 0
  v_mfma_f32_16x16x32_bf16 v[16:19], a[160:163], v[12:15], v[16:19]
  buffer_load_dwordx4 a[176:179], v2, s[12:15], s26 offen offset:3072 nt
  buffer_load_dwordx4 a[180:183], v2, s[12:15], s26 offen offset:3200 nt
  s_add_u32 s27, s21, 0x188000
  buffer_load_dwordx4 a[184:187], v2, s[12:15], s27 offen nt
  v_mov_b32_dpp v8, v24 row_ror:8 row_mask:0xf bank_mask:0x1
  v_mov_b32_dpp v9, v24 row_ror:12 row_mask:0xf bank_mask:0x2
  v_and_b32_dpp v25, v39, v4 quad_perm:[2,2,3,3] row_mask:0xf bank_mask:0xf
  s_waitcnt vmcnt(5)
  v_mfma_f32_16x16x32_bf16 v[20:23], a[164:167], v[12:15], v[20:23]
  buffer_load_dwordx4 a[188:191], v2, s[12:15], s27 offen offset:128 nt
  v_mov_b32_dpp v10, v24 quad_perm:[0,1,2,3] row_mask:0xf bank_mask:0x4
  v_mov_b32_dpp v11, v24 row_ror:4 row_mask:0xf bank_mask:0x8
  s_waitcnt vmcnt(5)
  s_nop 0
  v_mfma_f32_16x16x32_bf16 v[16:19], a[168:171], v[8:11], v[16:19]
  buffer_load_dwordx4 a[192:195], v2, s[12:15], s27 offen offset:1024 nt
  v_mov_b32_dpp v12, v24 row_ror:4 row_mask:0xf bank_mask:0x1
  v_mov_b32_dpp v13, v24 row_ror:8 row_mask:0xf bank_mask:0x2
  s_waitcnt vmcnt(5)
  v_mfma_f32_16x16x32_bf16 v[20:23], a[172:175], v[8:11], v[20:23]
  buffer_load_dwordx4 a[196:199], v2, s[12:15], s27 offen offset:1152 nt
  v_mov_b32_dpp v14, v24 row_ror:12 row_mask:0xf bank_mask:0x4
  v_mov_b32_dpp v15, v24 quad_perm:[0,1,2,3] row_mask:0xf bank_mask:0x8
  s_waitcnt vmcnt(5)
  s_nop 0
  v_mfma_f32_16x16x32_bf16 v[16:19], a[176:179], v[12:15], v[16:19]
  buffer_load_dwordx4 a[200:203], v2, s[12:15], s27 offen offset:2048 nt
  v_mov_b32_dpp v8, v25 quad_perm:[0,1,2,3] row_mask:0xf bank_mask:0x1
  v_mov_b32_dpp v9, v25 row_ror:4 row_mask:0xf bank_mask:0x2
  s_waitcnt vmcnt(5)
  v_mfma_f32_16x16x32_bf16 v[20:23], a[180:183], v[12:15], v[20:23]
  buffer_load_dwordx4 a[204:207], v2, s[12:15], s27 offen offset:2176 nt
  v_mov_b32_dpp v10, v25 row_ror:8 row_mask:0xf bank_mask:0x4
  v_mov_b32_dpp v11, v25 row_ror:12 row_mask:0xf bank_mask:0x8
  s_waitcnt vmcnt(5)
  s_nop 0
  v_mfma_f32_16x16x32_bf16 v[16:19], a[184:187], v[8:11], v[16:19]
  buffer_load_dwordx4 a[208:211], v2, s[12:15], s27 offen offset:3072 nt
  v_mov_b32_dpp v12, v25 row_ror:12 row_mask:0xf bank_mask:0x1
  v_mov_b32_dpp v13, v25 quad_perm:[0,1,2,3] row_mask:0xf bank_mask:0x2
  s_waitcnt vmcnt(5)
  v_mfma_f32_16x16x32_bf16 v[20:23], a[188:191], v[8:11], v[20:23]
  buffer_load_dwordx4 a[212:215], v2, s[12:15], s27 offen offset:3200 nt
  v_mov_b32_dpp v14, v25 row_ror:4 row_mask:0xf bank_mask:0x4
  v_mov_b32_dpp v15, v25 row_ror:8 row_mask:0xf bank_mask:0x8
  s_waitcnt vmcnt(5)
  s_nop 0
  v_mfma_f32_16x16x32_bf16 v[16:19], a[192:195], v[12:15], v[16:19]
  s_add_u32 s24, s21, 0x1c0000
  buffer_load_dwordx4 a[216:219], v2, s[12:15], s24 offen nt
  v_mov_b32_dpp v8, v25 row_ror:8 row_mask:0xf bank_mask:0x1
  v_mov_b32_dpp v9, v25 row_ror:12 row_mask:0xf bank_mask:0x2
  v_and_b32_dpp v24, v40, v4 quad_perm:[0,0,1,1] row_mask:0xf bank_mask:0xf
  s_waitcnt vmcnt(5)
  v_mfma_f32_16x16x32_bf16 v[20:23], a[196:199], v[12:15], v[20:23]
  buffer_load_dwordx4 a[220:223], v2, s[12:15], s24 offen offset:128 nt
  v_mov_b32_dpp v10, v25 quad_perm:[0,1,2,3] row_mask:0xf bank_mask:0x4
  v_mov_b32_dpp v11, v25 row_ror:4 row_mask:0xf bank_mask:0x8
  s_waitcnt vmcnt(5)
  s_nop 0
  v_mfma_f32_16x16x32_bf16 v[16:19], a[200:203], v[8:11], v[16:19]
  buffer_load_dwordx4 a[224:227], v2, s[12:15], s24 offen offset:1024 nt
  v_mov_b32_dpp v12, v25 row_ror:4 row_mask:0xf bank_mask:0x1
  v_mov_b32_dpp v13, v25 row_ror:8 row_mask:0xf bank_mask:0x2
  s_waitcnt vmcnt(5)
  v_mfma_f32_16x16x32_bf16 v[20:23], a[204:207], v[8:11], v[20:23]
  buffer_load_dwordx4 a[228:231], v2, s[12:15], s24 offen offset:1152 nt
  v_mov_b32_dpp v14, v25 row_ror:12 row_mask:0xf bank_mask:0x4
  v_mov_b32_dpp v15, v25 quad_perm:[0,1,2,3] row_mask:0xf bank_mask:0x8
  s_waitcnt vmcnt(5)
  s_nop 0
  v_mfma_f32_16x16x32_bf16 v[16:19], a[208:211], v[12:15], v[16:19]
  buffer_load_dwordx4 a[232:235], v2, s[12:15], s24 offen offset:2048 nt
  v_mov_b32_dpp v8, v24 quad_perm:[0,1,2,3] row_mask:0xf bank_mask:0x1
  v_mov_b32_dpp v9, v24 row_ror:4 row_mask:0xf bank_mask:0x2
  s_waitcnt vmcnt(5)
  v_mfma_f32_16x16x32_bf16 v[20:23], a[212:215], v[12:15], v[20:23]
  buffer_load_dwordx4 a[236:239], v2, s[12:15], s24 offen offset:2176 nt
  v_mov_b32_dpp v10, v24 row_ror:8 row_mask:0xf bank_mask:0x4
  v_mov_b32_dpp v11, v24 row_ror:12 row_mask:0xf bank_mask:0x8
  s_waitcnt vmcnt(5)
  s_nop 0
  v_mfma_f32_16x16x32_bf16 v[16:19], a[216:219], v[8:11], v[16:19]
  buffer_load_dwordx4 a[240:243], v2, s[12:15], s24 offen offset:3072
  v_mov_b32_dpp v12, v24 row_ror:12 row_mask:0xf bank_mask:0x1
  v_mov_b32_dpp v13, v24 quad_perm:[0,1,2,3] row_mask:0xf bank_mask:0x2
  s_waitcnt vmcnt(5)
  v_mfma_f32_16x16x32_bf16 v[20:23], a[220:223], v[8:11], v[20:23]
  buffer_load_dwordx4 a[244:247], v2, s[12:15], s24 offen offset:3200
  v_mov_b32_dpp v14, v24 row_ror:4 row_mask:0xf bank_mask:0x4
  v_mov_b32_dpp v15, v24 row_ror:8 row_mask:0xf bank_mask:0x8
  s_waitcnt vmcnt(5)
  s_nop 0
  v_mfma_f32_16x16x32_bf16 v[16:19], a[224:227], v[12:15], v[16:19]
  buffer_load_dwordx4 a[248:251], v3, s[12:15], s23 offen
  v_mov_b32_dpp v8, v24 row_ror:8 row_mask:0xf bank_mask:0x1
  v_mov_b32_dpp v9, v24 row_ror:12 row_mask:0xf bank_mask:0x2
  v_and_b32_dpp v25, v40, v4 quad_perm:[2,2,3,3] row_mask:0xf bank_mask:0xf
  s_waitcnt vmcnt(5)
  v_mfma_f32_16x16x32_bf16 v[20:23], a[228:231], v[12:15], v[20:23]
  buffer_load_dwordx4 a[252:255], v3, s[12:15], s23 offen offset:128
  v_mov_b32_dpp v10, v24 quad_perm:[0,1,2,3] row_mask:0xf bank_mask:0x4
  v_mov_b32_dpp v11, v24 row_ror:4 row_mask:0xf bank_mask:0x8
  s_waitcnt vmcnt(5)
  s_nop 0
  v_mfma_f32_16x16x32_bf16 v[16:19], a[232:235], v[8:11], v[16:19]
  buffer_load_dwordx4 v[200:203], v3, s[12:15], s23 offen offset:1024
  v_mov_b32_dpp v12, v24 row_ror:4 row_mask:0xf bank_mask:0x1
  v_mov_b32_dpp v13, v24 row_ror:8 row_mask:0xf bank_mask:0x2
  s_waitcnt vmcnt(5)
  v_mfma_f32_16x16x32_bf16 v[20:23], a[236:239], v[8:11], v[20:23]
  buffer_load_dwordx4 v[204:207], v3, s[12:15], s23 offen offset:1152
  v_mov_b32_dpp v14, v24 row_ror:12 row_mask:0xf bank_mask:0x4
  v_mov_b32_dpp v15, v24 quad_perm:[0,1,2,3] row_mask:0xf bank_mask:0x8
  s_waitcnt vmcnt(5)
  s_nop 0
  v_mfma_f32_16x16x32_bf16 v[16:19], a[240:243], v[12:15], v[16:19]
  buffer_load_dwordx4 v[208:211], v3, s[12:15], s23 offen offset:2048
  v_mov_b32_dpp v8, v25 quad_perm:[0,1,2,3] row_mask:0xf bank_mask:0x1
  v_mov_b32_dpp v9, v25 row_ror:4 row_mask:0xf bank_mask:0x2
  s_waitcnt vmcnt(5)
  v_mfma_f32_16x16x32_bf16 v[20:23], a[244:247], v[12:15], v[20:23]
  buffer_load_dwordx4 v[212:215], v3, s[12:15], s23 offen offset:2176
  v_mov_b32_dpp v10, v25 row_ror:8 row_mask:0xf bank_mask:0x4
  v_mov_b32_dpp v11, v25 row_ror:12 row_mask:0xf bank_mask:0x8
  s_waitcnt vmcnt(5)
  s_nop 0
  v_mfma_f32_16x16x32_bf16 v[16:19], a[248:251], v[8:11], v[16:19]
  buffer_load_dwordx4 a[240:243], v3, s[12:15], s23 offen offset:3072
  v_mov_b32_dpp v12, v25 row_ror:12 row_mask:0xf bank_mask:0x1
  v_mov_b32_dpp v13, v25 quad_perm:[0,1,2,3] row_mask:0xf bank_mask:0x2
  s_waitcnt vmcnt(5)
  v_mfma_f32_16x16x32_bf16 v[20:23], a[252:255], v[8:11], v[20:23]
  buffer_load_dwordx4 a[244:247], v3, s[12:15], s23 offen offset:3200
  v_mov_b32_dpp v14, v25 row_ror:4 row_mask:0xf bank_mask:0x4
  v_mov_b32_dpp v15, v25 row_ror:8 row_mask:0xf bank_mask:0x8
  s_waitcnt vmcnt(5)
  s_nop 0
  v_mfma_f32_16x16x32_bf16 v[16:19], v[200:203], v[12:15], v[16:19]
  buffer_load_dwordx4 a[248:251], v1, s[8:11], s20 offen nt
  v_mov_b32_dpp v8, v25 row_ror:8 row_mask:0xf bank_mask:0x1
  v_mov_b32_dpp v9, v25 row_ror:12 row_mask:0xf bank_mask:0x2
  s_waitcnt vmcnt(5)
  v_mfma_f32_16x16x32_bf16 v[20:23], v[204:207], v[12:15], v[20:23]
  buffer_load_dwordx4 a[252:255], v1, s[8:11], s20 offen offset:1024 nt
  v_mov_b32_dpp v10, v25 quad_perm:[0,1,2,3] row_mask:0xf bank_mask:0x4
  v_mov_b32_dpp v11, v25 row_ror:4 row_mask:0xf bank_mask:0x8
  s_waitcnt vmcnt(5)
  s_nop 0
  v_mfma_f32_16x16x32_bf16 v[16:19], v[208:211], v[8:11], v[16:19]
  buffer_load_dwordx4 v[200:203], v1, s[8:11], s20 offen offset:2048 nt
  v_mov_b32_dpp v12, v25 row_ror:4 row_mask:0xf bank_mask:0x1
  v_mov_b32_dpp v13, v25 row_ror:8 row_mask:0xf bank_mask:0x2
  s_waitcnt vmcnt(5)
  v_mfma_f32_16x16x32_bf16 v[20:23], v[212:215], v[8:11], v[20:23]
  buffer_load_dwordx4 v[204:207], v1, s[8:11], s20 offen offset:3072 nt
  v_mov_b32_dpp v14, v25 row_ror:12 row_mask:0xf bank_mask:0x4
  v_mov_b32_dpp v15, v25 quad_perm:[0,1,2,3] row_mask:0xf bank_mask:0x8
  s_waitcnt vmcnt(5)
  s_nop 0
  v_mfma_f32_16x16x32_bf16 v[16:19], a[240:243], v[12:15], v[16:19]
  s_add_u32 s25, s20, 0x1c000
  buffer_load_dwordx4 v[208:211], v1, s[8:11], s25 offen nt
  s_waitcnt vmcnt(5)
  v_mfma_f32_16x16x32_bf16 v[20:23], a[244:247], v[12:15], v[20:23]
  buffer_load_dwordx4 v[212:215], v1, s[8:11], s25 offen offset:1024 nt
  s_nop 2
  v_permlane32_swap_b32 v16, v17
  v_permlane32_swap_b32 v18, v19
  s_nop 0
  v_add_f32_dpp v8, v17, v16 quad_perm:[2,3,2,3] row_mask:0xf bank_mask:0xf
  v_add_f32_dpp v9, v18, v19 quad_perm:[0,1,0,1] row_mask:0xf bank_mask:0xf
  v_cndmask_b32_e64 v10, v8, v9, s[40:41]
  v_permlane32_swap_b32 v20, v21
  v_permlane32_swap_b32 v22, v23
  s_nop 0
  v_add_f32_dpp v11, v21, v20 quad_perm:[2,3,2,3] row_mask:0xf bank_mask:0xf
  v_add_f32_dpp v12, v22, v23 quad_perm:[0,1,0,1] row_mask:0xf bank_mask:0xf
  v_cndmask_b32_e64 v13, v11, v12, s[40:41]
  s_lshl_b32 s48, s17, 9
  s_add_u32 m0, s48, 0
  s_nop 0
  ds_write_addtid_b32 v10 offset:0
  ds_write_addtid_b32 v13 offset:256
  v_mov_b32 v8, s43
  v_mov_b32 v9, s45
  s_lshl_b32 s48, s17, 3
  s_add_u32 s48, s48, 2048
  v_mov_b32 v11, s48
  ds_write_b64 v11, v[8:9]
  s_waitcnt lgkmcnt(0)
  s_barrier
  v_mov_b32 v11, 2048
  ds_read_b128 v[16:19], v11
  ds_read_b128 v[20:23], v11 offset:16
  s_and_b32 s48, s17, 1
  s_lshl_b32 s48, s48, 8
  s_add_u32 m0, s48, 0
  s_nop 0
  ds_read_addtid_b32 v12 offset:0
  ds_read_addtid_b32 v13 offset:512
  ds_read_addtid_b32 v14 offset:1024
  ds_read_addtid_b32 v15 offset:1536
  s_waitcnt lgkmcnt(4)
  v_max3_f32 v8, v16, v18, v20
  v_max_f32 v8, v8, v22
  v_sub_f32 v16, v16, v8
  v_mul_f32 v16, s28, v16
  v_sub_f32 v18, v18, v8
  v_mul_f32 v18, s28, v18
  v_sub_f32 v20, v20, v8
  v_mul_f32 v20, s28, v20
  v_sub_f32 v22, v22, v8
  v_mul_f32 v22, s28, v22
  v_exp_f32 v16, v16
  v_exp_f32 v18, v18
  v_exp_f32 v20, v20
  v_exp_f32 v22, v22
  v_mul_f32 v9, v16, v17
  v_fmac_f32 v9, v18, v19
  v_fmac_f32 v9, v20, v21
  v_fmac_f32 v9, v22, v23
  v_mul_f32 v8, s28, v8
  s_waitcnt lgkmcnt(0)
  v_mul_f32 v10, v16, v12
  v_fmac_f32 v10, v18, v13
  v_fmac_f32 v10, v20, v14
  v_fmac_f32 v10, v22, v15
  v_cndmask_b32_e64 v8, v8, v9, s[62:63]
  s_cmp_lt_u32 s17, 2
  s_cselect_b64 vcc, -1, 0
  v_cndmask_b32 v10, v8, v10, vcc
  v_mov_b32 v11, s16
  s_add_u32 s48, s47, 0x80000
  buffer_store_dwordx2 v[10:11], v6, s[4:7], s48 offen sc1
  s_barrier
  v_min3_u32 v62, v29, v31, v33
  v_max3_u32 v63, v29, v31, v33
  v_min_u32 v62, v62, v35
  v_max_u32 v63, v63, v35
  v_cmp_ne_u32 vcc, s16, v62
  v_cmp_ne_u32 s[50:51], s16, v63
  s_nop 0
  s_or_b64 vcc, vcc, s[50:51]
  s_nop 2
  s_cbranch_vccz L_qok_3
  s_mov_b32 s29, 0x2000
L_qretry_4:
  s_sleep 2
  v_and_b32 v7, 0xff, v1
  v_lshlrev_b32 v7, 1, v7
  s_add_u32 s48, s46, 0x0
  buffer_load_dwordx4 v[28:31], v7, s[4:7], s48 offen sc1
  buffer_load_dwordx4 v[32:35], v7, s[4:7], s48 offen offset:16 sc1
  s_waitcnt vmcnt(0)
  v_min3_u32 v62, v29, v31, v33
  v_max3_u32 v63, v29, v31, v33
  v_min_u32 v62, v62, v35
  v_max_u32 v63, v63, v35
  v_cmp_ne_u32 vcc, s16, v62
  v_cmp_ne_u32 s[50:51], s16, v63
  s_nop 0
  s_or_b64 vcc, vcc, s[50:51]
  s_sub_u32 s29, s29, 1
  s_nop 1
  s_cbranch_scc1 L_qok_3
  s_cbranch_vccnz L_qretry_4
L_qok_3:
  v_cndmask_b32_e64 v8, 0, v28, s[54:55]
  v_cndmask_b32_e64 v9, 0, v30, s[54:55]
  v_cndmask_b32_e64 v10, 0, v32, s[54:55]
  v_cndmask_b32_e64 v11, 0, v34, s[54:55]
  v_cndmask_b32_e64 v12, 0, v28, s[56:57]
  v_cndmask_b32_e64 v13, 0, v30, s[56:57]
  v_cndmask_b32_e64 v14, 0, v32, s[56:57]
  v_cndmask_b32_e64 v15, 0, v34, s[56:57]
  v_cndmask_b32_e64 v16, 0, v28, s[58:59]
  v_cndmask_b32_e64 v17, 0, v30, s[58:59]
  v_cndmask_b32_e64 v18, 0, v32, s[58:59]
  v_cndmask_b32_e64 v19, 0, v34, s[58:59]
  v_cndmask_b32_e64 v20, 0, v28, s[60:61]
  v_cndmask_b32_e64 v21, 0, v30, s[60:61]
  v_cndmask_b32_e64 v22, 0, v32, s[60:61]
  v_cndmask_b32_e64 v23, 0, v34, s[60:61]
  v_mov_b32 v45, 0xff800000
  s_waitcnt vmcnt(6)
  v_mfma_f32_16x16x32_bf16 v[24:27], a[248:251], v[8:11], 0
  s_waitcnt vmcnt(5)
  v_mfma_f32_16x16x32_bf16 v[24:27], a[252:255], v[12:15], v[24:27]
  buffer_load_dwordx4 a[240:243], v1, s[8:11], s25 offen offset:2048 nt
  s_waitcnt vmcnt(5)
  v_mfma_f32_16x16x32_bf16 v[24:27], v[200:203], v[16:19], v[24:27]
  buffer_load_dwordx4 a[244:247], v1, s[8:11], s25 offen offset:3072 nt
  s_waitcnt vmcnt(5)
  v_mfma_f32_16x16x32_bf16 v[24:27], v[204:207], v[20:23], v[24:27]
  s_add_u32 s26, s20, 0x38000
  buffer_load_dwordx4 a[248:251], v1, s[8:11], s26 offen nt
  s_waitcnt vmcnt(5)
  v_mfma_f32_16x16x32_bf16 v[28:31], v[208:211], v[8:11], 0
  buffer_load_dwordx4 a[252:255], v1, s[8:11], s26 offen offset:1024 nt
  s_waitcnt vmcnt(5)
  v_mfma_f32_16x16x32_bf16 v[28:31], v[212:215], v[12:15], v[28:31]
  buffer_load_dwordx4 v[200:203], v1, s[8:11], s26 offen offset:2048 nt
  s_waitcnt vmcnt(4)
  v_mfma_f32_16x16x32_bf16 v[28:31], a[240:243], v[16:19], v[28:31]
  buffer_load_dwordx4 v[204:207], v1, s[8:11], s26 offen offset:3072 nt
  s_add_u32 s27, s20, 0x54000
  buffer_load_dwordx4 v[208:211], v1, s[8:11], s27 offen nt
  s_waitcnt vmcnt(5)
  v_mfma_f32_16x16x32_bf16 v[28:31], a[244:247], v[20:23], v[28:31]
  buffer_load_dwordx4 v[212:215], v1, s[8:11], s27 offen offset:1024 nt
  s_waitcnt vmcnt(5)
  v_mfma_f32_16x16x32_bf16 v[32:35], a[248:251], v[8:11], 0
  buffer_load_dwordx4 a[240:243], v1, s[8:11], s27 offen offset:2048 nt
  v_add_f32_dpp v62, v25, v24 quad_perm:[1,1,1,1] row_mask:0xf bank_mask:0xf
  v_add_f32_dpp v63, v26, v27 quad_perm:[2,2,2,2] row_mask:0xf bank_mask:0xf
  s_waitcnt vmcnt(5)
  v_mfma_f32_16x16x32_bf16 v[32:35], a[252:255], v[12:15], v[32:35]
  buffer_load_dwordx4 a[244:247], v1, s[8:11], s27 offen offset:3072 nt
  s_waitcnt vmcnt(5)
  v_mfma_f32_16x16x32_bf16 v[32:35], v[200:203], v[16:19], v[32:35]
  s_add_u32 s24, s20, 0x70000
  buffer_load_dwordx4 a[248:251], v1, s[8:11], s24 offen nt
  v_add_f32_dpp v41, v63, v62 quad_perm:[3,3,3,3] row_mask:0xf bank_mask:0xf
  s_waitcnt vmcnt(5)
  v_mfma_f32_16x16x32_bf16 v[32:35], v[204:207], v[20:23], v[32:35]
  buffer_load_dwordx4 a[252:255], v1, s[8:11], s24 offen offset:1024 nt
  s_waitcnt vmcnt(5)
  v_mfma_f32_16x16x32_bf16 v[24:27], v[208:211], v[8:11], 0
  buffer_load_dwordx4 v[200:203], v1, s[8:11], s24 offen offset:2048 nt
  v_add_f32_dpp v62, v28, v29 quad_perm:[0,0,0,0] row_mask:0xf bank_mask:0xf
  v_add_f32_dpp v63, v30, v31 quad_perm:[2,2,2,2] row_mask:0xf bank_mask:0xf
  s_waitcnt vmcnt(5)
  v_mfma_f32_16x16x32_bf16 v[24:27], v[212:215], v[12:15], v[24:27]
  buffer_load_dwordx4 v[204:207], v1, s[8:11], s24 offen offset:3072 nt
  s_waitcnt vmcnt(5)
  v_mfma_f32_16x16x32_bf16 v[24:27], a[240:243], v[16:19], v[24:27]
  s_add_u32 s25, s20, 0x8c000
  buffer_load_dwordx4 v[208:211], v1, s[8:11], s25 offen nt
  v_add_f32_dpp v62, v63, v62 quad_perm:[3,3,3,3] row_mask:0xf bank_mask:0xf
  s_waitcnt vmcnt(5)
  v_mfma_f32_16x16x32_bf16 v[24:27], a[244:247], v[20:23], v[24:27]
  buffer_load_dwordx4 v[212:215], v1, s[8:11], s25 offen offset:1024 nt
  v_cndmask_b32_e64 v41, v41, v62, s[32:33]
  s_waitcnt vmcnt(5)
  v_mfma_f32_16x16x32_bf16 v[28:31], a[248:251], v[8:11], 0
  buffer_load_dwordx4 a[240:243], v1, s[8:11], s25 offen offset:2048 nt
  v_add_f32_dpp v62, v32, v33 quad_perm:[0,0,0,0] row_mask:0xf bank_mask:0xf
  v_add_f32_dpp v63, v35, v34 quad_perm:[3,3,3,3] row_mask:0xf bank_mask:0xf
  s_waitcnt vmcnt(5)
  v_mfma_f32_16x16x32_bf16 v[28:31], a[252:255], v[12:15], v[28:31]
  buffer_load_dwordx4 a[244:247], v1, s[8:11], s25 offen offset:3072 nt
  s_waitcnt vmcnt(5)
  v_mfma_f32_16x16x32_bf16 v[28:31], v[200:203], v[16:19], v[28:31]
  s_add_u32 s26, s20, 0xa8000
  buffer_load_dwordx4 a[248:251], v1, s[8:11], s26 offen nt
  v_add_f32_dpp v62, v62, v63 quad_perm:[1,1,1,1] row_mask:0xf bank_mask:0xf
  s_waitcnt vmcnt(5)
  v_mfma_f32_16x16x32_bf16 v[28:31], v[204:207], v[20:23], v[28:31]
  buffer_load_dwordx4 a[252:255], v1, s[8:11], s26 offen offset:1024 nt
  v_cndmask_b32_e64 v41, v41, v62, s[34:35]
  s_waitcnt vmcnt(5)
  v_mfma_f32_16x16x32_bf16 v[32:35], v[208:211], v[8:11], 0
  buffer_load_dwordx4 v[200:203], v1, s[8:11], s26 offen offset:2048 nt
  v_add_f32_dpp v62, v24, v25 quad_perm:[0,0,0,0] row_mask:0xf bank_mask:0xf
  v_add_f32_dpp v63, v26, v27 quad_perm:[2,2,2,2] row_mask:0xf bank_mask:0xf
  s_waitcnt vmcnt(5)
  v_mfma_f32_16x16x32_bf16 v[32:35], v[212:215], v[12:15], v[32:35]
  buffer_load_dwordx4 v[204:207], v1, s[8:11], s26 offen offset:3072 nt
  s_waitcnt vmcnt(5)
  v_mfma_f32_16x16x32_bf16 v[32:35], a[240:243], v[16:19], v[32:35]
  s_add_u32 s27, s20, 0xc4000
  buffer_load_dwordx4 v[208:211], v1, s[8:11], s27 offen nt
  v_add_f32_dpp v62, v62, v63 quad_perm:[1,1,1,1] row_mask:0xf bank_mask:0xf
  s_waitcnt vmcnt(5)
  v_mfma_f32_16x16x32_bf16 v[32:35], a[244:247], v[20:23], v[32:35]
  buffer_load_dwordx4 v[212:215], v1, s[8:11], s27 offen offset:1024 nt
  v_cndmask_b32_e64 v41, v41, v62, s[36:37]
  s_waitcnt vmcnt(5)
  v_mfma_f32_16x16x32_bf16 v[24:27], a[248:251], v[8:11], 0
  buffer_load_dwordx4 a[240:243], v1, s[8:11], s27 offen offset:2048 nt
  v_add_f32_dpp v62, v29, v28 quad_perm:[1,1,1,1] row_mask:0xf bank_mask:0xf
  v_add_f32_dpp v63, v30, v31 quad_perm:[2,2,2,2] row_mask:0xf bank_mask:0xf
  s_waitcnt vmcnt(5)
  v_mfma_f32_16x16x32_bf16 v[24:27], a[252:255], v[12:15], v[24:27]
  buffer_load_dwordx4 a[244:247], v1, s[8:11], s27 offen offset:3072 nt
  s_waitcnt vmcnt(5)
  v_mfma_f32_16x16x32_bf16 v[24:27], v[200:203], v[16:19], v[24:27]
  s_add_u32 s24, s20, 0xe0000
  buffer_load_dwordx4 a[248:251], v1, s[8:11], s24 offen nt
  v_add_f32_dpp v42, v63, v62 quad_perm:[3,3,3,3] row_mask:0xf bank_mask:0xf
  s_waitcnt vmcnt(5)
  v_mfma_f32_16x16x32_bf16 v[24:27], v[204:207], v[20:23], v[24:27]
  buffer_load_dwordx4 a[252:255], v1, s[8:11], s24 offen offset:1024 nt
  s_waitcnt vmcnt(5)
  v_mfma_f32_16x16x32_bf16 v[28:31], v[208:211], v[8:11], 0
  buffer_load_dwordx4 v[200:203], v1, s[8:11], s24 offen offset:2048 nt
  v_add_f32_dpp v62, v32, v33 quad_perm:[0,0,0,0] row_mask:0xf bank_mask:0xf
  v_add_f32_dpp v63, v34, v35 quad_perm:[2,2,2,2] row_mask:0xf bank_mask:0xf
  s_waitcnt vmcnt(5)
  v_mfma_f32_16x16x32_bf16 v[28:31], v[212:215], v[12:15], v[28:31]
  buffer_load_dwordx4 v[204:207], v1, s[8:11], s24 offen offset:3072 nt
  s_waitcnt vmcnt(5)
  v_mfma_f32_16x16x32_bf16 v[28:31], a[240:243], v[16:19], v[28:31]
  s_add_u32 s25, s20, 0xfc000
  buffer_load_dwordx4 v[208:211], v1, s[8:11], s25 offen nt
  v_add_f32_dpp v62, v63, v62 quad_perm:[3,3,3,3] row_mask:0xf bank_mask:0xf
  s_waitcnt vmcnt(5)
  v_mfma_f32_16x16x32_bf16 v[28:31], a[244:247], v[20:23], v[28:31]
  buffer_load_dwordx4 v[212:215], v1, s[8:11], s25 offen offset:1024 nt
  v_cndmask_b32_e64 v42, v42, v62, s[32:33]
  s_waitcnt vmcnt(5)
  v_mfma_f32_16x16x32_bf16 v[32:35], a[248:251], v[8:11], 0
  buffer_load_dwordx4 a[240:243], v1, s[8:11], s25 offen offset:2048 nt
  v_add_f32_dpp v62, v24, v25 quad_perm:[0,0,0,0] row_mask:0xf bank_mask:0xf
  v_add_f32_dpp v63, v27, v26 quad_perm:[3,3,3,3] row_mask:0xf bank_mask:0xf
  s_waitcnt vmcnt(5)
  v_mfma_f32_16x16x32_bf16 v[32:35], a[252:255], v[12:15], v[32:35]
  buffer_load_dwordx4 a[244:247], v1, s[8:11], s25 offen offset:3072 nt
  s_waitcnt vmcnt(5)
  v_mfma_f32_16x16x32_bf16 v[32:35], v[200:203], v[16:19], v[32:35]
  s_add_u32 s26, s20, 0x118000
  buffer_load_dwordx4 a[248:251], v1, s[8:11], s26 offen nt
  v_add_f32_dpp v62, v62, v63 quad_perm:[1,1,1,1] row_mask:0xf bank_mask:0xf
  s_waitcnt vmcnt(5)
  v_mfma_f32_16x16x32_bf16 v[32:35], v[204:207], v[20:23], v[32:35]
  buffer_load_dwordx4 a[252:255], v1, s[8:11], s26 offen offset:1024 nt
  v_cndmask_b32_e64 v42, v42, v62, s[34:35]
  s_waitcnt vmcnt(5)
  v_mfma_f32_16x16x32_bf16 v[24:27], v[208:211], v[8:11], 0
  buffer_load_dwordx4 v[200:203], v1, s[8:11], s26 offen offset:2048 nt
  v_add_f32_dpp v62, v28, v29 quad_perm:[0,0,0,0] row_mask:0xf bank_mask:0xf
  v_add_f32_dpp v63, v30, v31 quad_perm:[2,2,2,2] row_mask:0xf bank_mask:0xf
  s_waitcnt vmcnt(5)
  v_mfma_f32_16x16x32_bf16 v[24:27], v[212:215], v[12:15], v[24:27]
  buffer_load_dwordx4 v[204:207], v1, s[8:11], s26 offen offset:3072 nt
  s_waitcnt vmcnt(5)
  v_mfma_f32_16x16x32_bf16 v[24:27], a[240:243], v[16:19], v[24:27]
  s_add_u32 s27, s20, 0x134000
  buffer_load_dwordx4 v[208:211], v1, s[8:11], s27 offen nt
  v_add_f32_dpp v62, v62, v63 quad_perm:[1,1,1,1] row_mask:0xf bank_mask:0xf
  s_waitcnt vmcnt(5)
  v_mfma_f32_16x16x32_bf16 v[24:27], a[244:247], v[20:23], v[24:27]
  buffer_load_dwordx4 v[212:215], v1, s[8:11], s27 offen offset:1024 nt
  v_cndmask_b32_e64 v42, v42, v62, s[36:37]
  s_waitcnt vmcnt(5)
  v_mfma_f32_16x16x32_bf16 v[28:31], a[248:251], v[8:11], 0
  buffer_load_dwordx4 a[240:243], v1, s[8:11], s27 offen offset:2048 nt
  v_add_f32_dpp v62, v33, v32 quad_perm:[1,1,1,1] row_mask:0xf bank_mask:0xf
  v_add_f32_dpp v63, v34, v35 quad_perm:[2,2,2,2] row_mask:0xf bank_mask:0xf
  s_waitcnt vmcnt(5)
  v_mfma_f32_16x16x32_bf16 v[28:31], a[252:255], v[12:15], v[28:31]
  buffer_load_dwordx4 a[244:247], v1, s[8:11], s27 offen offset:3072 nt
  s_waitcnt vmcnt(5)
  v_mfma_f32_16x16x32_bf16 v[28:31], v[200:203], v[16:19], v[28:31]
  s_add_u32 s24, s20, 0x150000
  buffer_load_dwordx4 a[248:251], v1, s[8:11], s24 offen nt
  v_add_f32_dpp v43, v63, v62 quad_perm:[3,3,3,3] row_mask:0xf bank_mask:0xf
  s_waitcnt vmcnt(5)
  v_mfma_f32_16x16x32_bf16 v[28:31], v[204:207], v[20:23], v[28:31]
  buffer_load_dwordx4 a[252:255], v1, s[8:11], s24 offen offset:1024 nt
  s_waitcnt vmcnt(5)
  v_mfma_f32_16x16x32_bf16 v[32:35], v[208:211], v[8:11], 0
  buffer_load_dwordx4 v[200:203], v1, s[8:11], s24 offen offset:2048 nt
  v_add_f32_dpp v62, v24, v25 quad_perm:[0,0,0,0] row_mask:0xf bank_mask:0xf
  v_add_f32_dpp v63, v26, v27 quad_perm:[2,2,2,2] row_mask:0xf bank_mask:0xf
  s_waitcnt vmcnt(5)
  v_mfma_f32_16x16x32_bf16 v[32:35], v[212:215], v[12:15], v[32:35]
  buffer_load_dwordx4 v[204:207], v1, s[8:11], s24 offen offset:3072 nt
  s_waitcnt vmcnt(5)
  v_mfma_f32_16x16x32_bf16 v[32:35], a[240:243], v[16:19], v[32:35]
  s_add_u32 s25, s20, 0x16c000
  buffer_load_dwordx4 v[208:211], v1, s[8:11], s25 offen
  v_add_f32_dpp v62, v63, v62 quad_perm:[3,3,3,3] row_mask:0xf bank_mask:0xf
  s_waitcnt vmcnt(5)
  v_mfma_f32_16x16x32_bf16 v[32:35], a[244:247], v[20:23], v[32:35]
  buffer_load_dwordx4 v[212:215], v1, s[8:11], s25 offen offset:1024
  v_cndmask_b32_e64 v43, v43, v62, s[32:33]
  s_waitcnt vmcnt(5)
  v_mfma_f32_16x16x32_bf16 v[24:27], a[248:251], v[8:11], 0
  buffer_load_dwordx4 a[240:243], v1, s[8:11], s25 offen offset:2048
  v_add_f32_dpp v62, v28, v29 quad_perm:[0,0,0,0] row_mask:0xf bank_mask:0xf
  v_add_f32_dpp v63, v31, v30 quad_perm:[3,3,3,3] row_mask:0xf bank_mask:0xf
  s_waitcnt vmcnt(5)
  v_mfma_f32_16x16x32_bf16 v[24:27], a[252:255], v[12:15], v[24:27]
  buffer_load_dwordx4 a[244:247], v1, s[8:11], s25 offen offset:3072
  s_waitcnt vmcnt(5)
  v_mfma_f32_16x16x32_bf16 v[24:27], v[200:203], v[16:19], v[24:27]
  s_add_u32 s26, s20, 0x188000
  buffer_load_dwordx4 a[248:251], v1, s[8:11], s26 offen
  v_add_f32_dpp v62, v62, v63 quad_perm:[1,1,1,1] row_mask:0xf bank_mask:0xf
  s_waitcnt vmcnt(5)
  v_mfma_f32_16x16x32_bf16 v[24:27], v[204:207], v[20:23], v[24:27]
  buffer_load_dwordx4 a[252:255], v1, s[8:11], s26 offen offset:1024
  v_cndmask_b32_e64 v43, v43, v62, s[34:35]
  s_waitcnt vmcnt(5)
  v_mfma_f32_16x16x32_bf16 v[28:31], v[208:211], v[8:11], 0
  buffer_load_dwordx4 v[200:203], v1, s[8:11], s26 offen offset:2048
  v_add_f32_dpp v62, v32, v33 quad_perm:[0,0,0,0] row_mask:0xf bank_mask:0xf
  v_add_f32_dpp v63, v34, v35 quad_perm:[2,2,2,2] row_mask:0xf bank_mask:0xf
  s_waitcnt vmcnt(5)
  v_mfma_f32_16x16x32_bf16 v[28:31], v[212:215], v[12:15], v[28:31]
  buffer_load_dwordx4 v[204:207], v1, s[8:11], s26 offen offset:3072
  s_waitcnt vmcnt(5)
  v_mfma_f32_16x16x32_bf16 v[28:31], a[240:243], v[16:19], v[28:31]
  s_add_u32 s27, s20, 0x1a4000
  buffer_load_dwordx4 v[208:211], v1, s[8:11], s27 offen
  v_add_f32_dpp v62, v62, v63 quad_perm:[1,1,1,1] row_mask:0xf bank_mask:0xf
  s_waitcnt vmcnt(5)
  v_mfma_f32_16x16x32_bf16 v[28:31], a[244:247], v[20:23], v[28:31]
  buffer_load_dwordx4 v[212:215], v1, s[8:11], s27 offen offset:1024
  v_cndmask_b32_e64 v43, v43, v62, s[36:37]
  s_waitcnt vmcnt(5)
  v_mfma_f32_16x16x32_bf16 v[32:35], a[248:251], v[8:11], 0
  buffer_load_dwordx4 a[240:243], v1, s[8:11], s27 offen offset:2048
  v_add_f32_dpp v62, v25, v24 quad_perm:[1,1,1,1] row_mask:0xf bank_mask:0xf
  v_add_f32_dpp v63, v26, v27 quad_perm:[2,2,2,2] row_mask:0xf bank_mask:0xf
  s_waitcnt vmcnt(5)
  v_mfma_f32_16x16x32_bf16 v[32:35], a[252:255], v[12:15], v[32:35]
  buffer_load_dwordx4 a[244:247], v1, s[8:11], s27 offen offset:3072
  s_waitcnt vmcnt(5)
  v_mfma_f32_16x16x32_bf16 v[32:35], v[200:203], v[16:19], v[32:35]
  s_add_u32 s24, s20, 0x1c0000
  buffer_load_dwordx4 a[248:251], v1, s[8:11], s24 offen
  v_add_f32_dpp v44, v63, v62 quad_perm:[3,3,3,3] row_mask:0xf bank_mask:0xf
  s_waitcnt vmcnt(5)
  v_mfma_f32_16x16x32_bf16 v[32:35], v[204:207], v[20:23], v[32:35]
  buffer_load_dwordx4 a[252:255], v1, s[8:11], s24 offen offset:1024
  s_waitcnt vmcnt(5)
  v_mfma_f32_16x16x32_bf16 v[24:27], v[208:211], v[8:11], 0
  buffer_load_dwordx4 v[200:203], v1, s[8:11], s24 offen offset:2048
  v_add_f32_dpp v62, v28, v29 quad_perm:[0,0,0,0] row_mask:0xf bank_mask:0xf
  v_add_f32_dpp v63, v30, v31 quad_perm:[2,2,2,2] row_mask:0xf bank_mask:0xf
  s_waitcnt vmcnt(5)
  v_mfma_f32_16x16x32_bf16 v[24:27], v[212:215], v[12:15], v[24:27]
  buffer_load_dwordx4 v[204:207], v1, s[8:11], s24 offen offset:3072
  s_waitcnt vmcnt(5)
  v_mfma_f32_16x16x32_bf16 v[24:27], a[240:243], v[16:19], v[24:27]
  s_add_u32 s25, s20, 0x1dc000
  buffer_load_dwordx4 v[208:211], v1, s[8:11], s25 offen
  v_add_f32_dpp v62, v63, v62 quad_perm:[3,3,3,3] row_mask:0xf bank_mask:0xf
  s_waitcnt vmcnt(5)
  v_mfma_f32_16x16x32_bf16 v[24:27], a[244:247], v[20:23], v[24:27]
  buffer_load_dwordx4 v[212:215], v1, s[8:11], s25 offen offset:1024
  v_cndmask_b32_e64 v44, v44, v62, s[32:33]
  s_waitcnt vmcnt(5)
  v_mfma_f32_16x16x32_bf16 v[28:31], a[248:251], v[8:11], 0
  buffer_load_dwordx4 a[240:243], v1, s[8:11], s25 offen offset:2048
  v_add_f32_dpp v62, v32, v33 quad_perm:[0,0,0,0] row_mask:0xf bank_mask:0xf
  v_add_f32_dpp v63, v35, v34 quad_perm:[3,3,3,3] row_mask:0xf bank_mask:0xf
  s_waitcnt vmcnt(5)
  v_mfma_f32_16x16x32_bf16 v[28:31], a[252:255], v[12:15], v[28:31]
  buffer_load_dwordx4 a[244:247], v1, s[8:11], s25 offen offset:3072
  s_waitcnt vmcnt(5)
  v_mfma_f32_16x16x32_bf16 v[28:31], v[200:203], v[16:19], v[28:31]
  buffer_load_dwordx4 a[248:251], v1, s[8:11], s22 offen
  v_add_f32_dpp v62, v62, v63 quad_perm:[1,1,1,1] row_mask:0xf bank_mask:0xf
  s_waitcnt vmcnt(5)
  v_mfma_f32_16x16x32_bf16 v[28:31], v[204:207], v[20:23], v[28:31]
  buffer_load_dwordx4 a[252:255], v1, s[8:11], s22 offen offset:1024
  v_cndmask_b32_e64 v44, v44, v62, s[34:35]
  s_waitcnt vmcnt(5)
  v_mfma_f32_16x16x32_bf16 v[32:35], v[208:211], v[8:11], 0
  buffer_load_dwordx4 v[200:203], v1, s[8:11], s22 offen offset:2048
  v_add_f32_dpp v62, v24, v25 quad_perm:[0,0,0,0] row_mask:0xf bank_mask:0xf
  v_add_f32_dpp v63, v26, v27 quad_perm:[2,2,2,2] row_mask:0xf bank_mask:0xf
  s_waitcnt vmcnt(5)
  v_mfma_f32_16x16x32_bf16 v[32:35], v[212:215], v[12:15], v[32:35]
  buffer_load_dwordx4 v[204:207], v1, s[8:11], s22 offen offset:3072
  s_waitcnt vmcnt(5)
  v_mfma_f32_16x16x32_bf16 v[32:35], a[240:243], v[16:19], v[32:35]
  buffer_load_dwordx4 v[208:211], v1, s[8:11], s23 offen nt
  v_add_f32_dpp v62, v62, v63 quad_perm:[1,1,1,1] row_mask:0xf bank_mask:0xf
  s_waitcnt vmcnt(5)
  v_mfma_f32_16x16x32_bf16 v[32:35], a[244:247], v[20:23], v[32:35]
  buffer_load_dwordx4 v[212:215], v1, s[8:11], s23 offen offset:1024 nt
  v_cndmask_b32_e64 v44, v44, v62, s[36:37]
  s_waitcnt vmcnt(5)
  v_mfma_f32_16x16x32_bf16 v[24:27], a[248:251], v[8:11], 0
  buffer_load_dwordx4 a[240:243], v1, s[8:11], s23 offen offset:2048 nt
  v_add_f32_dpp v62, v29, v28 quad_perm:[1,1,1,1] row_mask:0xf bank_mask:0xf
  v_add_f32_dpp v63, v30, v31 quad_perm:[2,2,2,2] row_mask:0xf bank_mask:0xf
  s_waitcnt vmcnt(5)
  v_mfma_f32_16x16x32_bf16 v[24:27], a[252:255], v[12:15], v[24:27]
  buffer_load_dwordx4 a[244:247], v1, s[8:11], s23 offen offset:3072 nt
  s_waitcnt vmcnt(5)
  v_mfma_f32_16x16x32_bf16 v[24:27], v[200:203], v[16:19], v[24:27]
  s_add_u32 s26, s21, 0x1c0000
  buffer_load_dwordx4 a[248:251], v2, s[12:15], s26 offen offset:3072 nt
  v_add_f32_dpp v62, v63, v62 quad_perm:[3,3,3,3] row_mask:0xf bank_mask:0xf
  s_waitcnt vmcnt(5)
  v_mfma_f32_16x16x32_bf16 v[24:27], v[204:207], v[20:23], v[24:27]
  buffer_load_dwordx4 a[252:255], v2, s[12:15], s26 offen offset:3200 nt
  v_cndmask_b32_e64 v45, v45, v62, s[30:31]
  v_add_f32_dpp v62, v32, v33 quad_perm:[0,0,0,0] row_mask:0xf bank_mask:0xf
  v_add_f32_dpp v63, v34, v35 quad_perm:[2,2,2,2] row_mask:0xf bank_mask:0xf
  s_nop 1
  v_add_f32_dpp v62, v63, v62 quad_perm:[3,3,3,3] row_mask:0xf bank_mask:0xf
  v_cndmask_b32_e64 v45, v45, v62, s[32:33]
  s_nop 0
  v_add_f32_dpp v62, v24, v25 quad_perm:[0,0,0,0] row_mask:0xf bank_mask:0xf
  v_add_f32_dpp v63, v27, v26 quad_perm:[3,3,3,3] row_mask:0xf bank_mask:0xf
  s_nop 1
  v_add_f32_dpp v62, v62, v63 quad_perm:[1,1,1,1] row_mask:0xf bank_mask:0xf
  v_cndmask_b32_e64 v45, v45, v62, s[38:39]
  v_cvt_pk_bf16_f32 v41, v41, v41
  v_cvt_pk_bf16_f32 v42, v42, v42
  v_cvt_pk_bf16_f32 v43, v43, v43
  v_cvt_pk_bf16_f32 v44, v44, v44
  v_cvt_pk_bf16_f32 v45, v45, v45
  v_and_b32 v41, 0xffff0000, v41
  v_and_b32 v42, 0xffff0000, v42
  v_and_b32 v43, 0xffff0000, v43
  v_and_b32 v44, 0xffff0000, v44
  v_and_b32 v45, 0xffff0000, v45
  v_mul_f32 v41, s53, v41
  v_mul_f32 v42, s53, v42
  v_mul_f32 v43, s53, v43
  v_mul_f32 v44, s53, v44
  v_mul_f32 v45, s53, v45
  v_cvt_pk_bf16_f32 v41, v41, v41
  v_cvt_pk_bf16_f32 v42, v42, v42
  v_cvt_pk_bf16_f32 v43, v43, v43
  v_cvt_pk_bf16_f32 v44, v44, v44
  v_cvt_pk_bf16_f32 v45, v45, v45
  v_and_b32 v41, 0xffff0000, v41
  v_and_b32 v42, 0xffff0000, v42
  v_and_b32 v43, 0xffff0000, v43
  v_and_b32 v44, 0xffff0000, v44
  v_and_b32 v45, 0xffff0000, v45
  v_max3_f32 v62, v41, v42, v43
  v_max3_f32 v62, v62, v44, v45
  s_nop 1
  v_max_f32_dpp v62, v62, v62 row_shr:1 row_mask:0xf bank_mask:0xf
  s_nop 1
  v_max_f32_dpp v62, v62, v62 row_shr:2 row_mask:0xf bank_mask:0xf
  s_nop 1
  v_max_f32_dpp v62, v62, v62 row_shr:4 row_mask:0xf bank_mask:0xf
  s_nop 1
  v_max_f32_dpp v62, v62, v62 row_shr:8 row_mask:0xf bank_mask:0xf
  s_nop 1
  v_max_f32_dpp v62, v62, v62 row_bcast:15 row_mask:0xa bank_mask:0xf
  s_nop 1
  v_max_f32_dpp v62, v62, v62 row_bcast:31 row_mask:0xc bank_mask:0xf
  s_nop 0
  v_readlane_b32 s42, v62, 63
  s_nop 1
  v_mov_b32 v63, s42
  v_mul_f32 v63, s28, v63
  v_fma_f32 v41, v41, s28, -v63
  v_fma_f32 v42, v42, s28, -v63
  v_fma_f32 v43, v43, s28, -v63
  v_fma_f32 v44, v44, s28, -v63
  v_fma_f32 v45, v45, s28, -v63
  v_exp_f32 v41, v41
  v_exp_f32 v42, v42
  v_exp_f32 v43, v43
  v_exp_f32 v44, v44
  v_exp_f32 v45, v45
  v_add_f32 v62, v41, v42
  v_add_f32 v63, v43, v44
  v_add_f32 v62, v62, v45
  v_cvt_pk_bf16_f32 v41, v41, v41
  v_cvt_pk_bf16_f32 v42, v42, v42
  v_cvt_pk_bf16_f32 v43, v43, v43
  v_cvt_pk_bf16_f32 v44, v44, v44
  v_cvt_pk_bf16_f32 v45, v45, v45
  v_add_f32 v62, v62, v63
  s_nop 1
  v_add_f32_dpp v62, v62, v62 row_shr:1 row_mask:0xf bank_mask:0xf
  s_nop 1
  v_add_f32_dpp v62, v62, v62 row_shr:2 row_mask:0xf bank_mask:0xf
  s_nop 1
  v_add_f32_dpp v62, v62, v62 row_shr:4 row_mask:0xf bank_mask:0xf
  s_nop 1
  v_add_f32_dpp v62, v62, v62 row_shr:8 row_mask:0xf bank_mask:0xf
  s_nop 1
  v_add_f32_dpp v62, v62, v62 row_bcast:15 row_mask:0xa bank_mask:0xf
  s_nop 1
  v_add_f32_dpp v62, v62, v62 row_bcast:31 row_mask:0xc bank_mask:0xf
  s_nop 0
  v_readlane_b32 s44, v62, 63
  s_waitcnt vmcnt(4)
  buffer_load_dwordx4 v[200:203], v3, s[12:15], s23 offen nt
  buffer_load_dwordx4 v[204:207], v3, s[12:15], s23 offen offset:128 nt
  v_and_b32 v7, 0xff, v1
  v_lshlrev_b32 v7, 1, v7
  s_add_u32 s48, s46, 0xc000
  buffer_load_dwordx4 v[28:31], v7, s[4:7], s48 offen sc1
  buffer_load_dwordx4 v[32:35], v7, s[4:7], s48 offen offset:16 sc1
  s_waitcnt vmcnt(0)
  v_min3_u32 v62, v29, v31, v33
  v_max3_u32 v63, v29, v31, v33
  v_min_u32 v62, v62, v35
  v_max_u32 v63, v63, v35
  v_cmp_ne_u32 vcc, s16, v62
  v_cmp_ne_u32 s[50:51], s16, v63
  s_nop 0
  s_or_b64 vcc, vcc, s[50:51]
  s_nop 2
  s_cbranch_vccz L_qok_5
  s_mov_b32 s29, 0x2000
L_qretry_6:
  s_sleep 2
  v_and_b32 v7, 0xff, v1
  v_lshlrev_b32 v7, 1, v7
  s_add_u32 s48, s46, 0xc000
  buffer_load_dwordx4 v[28:31], v7, s[4:7], s48 offen sc1
  buffer_load_dwordx4 v[32:35], v7, s[4:7], s48 offen offset:16 sc1
  s_waitcnt vmcnt(0)
  v_min3_u32 v62, v29, v31, v33
  v_max3_u32 v63, v29, v31, v33
  v_min_u32 v62, v62, v35
  v_max_u32 v63, v63, v35
  v_cmp_ne_u32 vcc, s16, v62
  v_cmp_ne_u32 s[50:51], s16, v63
  s_nop 0
  s_or_b64 vcc, vcc, s[50:51]
  s_sub_u32 s29, s29, 1
  s_nop 1
  s_cbranch_scc1 L_qok_5
  s_cbranch_vccnz L_qretry_6
L_qok_5:
  v_cndmask_b32_e64 v8, 0, v28, s[54:55]
  v_cndmask_b32_e64 v9, 0, v30, s[54:55]
  v_cndmask_b32_e64 v10, 0, v32, s[54:55]
  v_cndmask_b32_e64 v11, 0, v34, s[54:55]
  v_cndmask_b32_e64 v12, 0, v28, s[56:57]
  v_cndmask_b32_e64 v13, 0, v30, s[56:57]
  v_cndmask_b32_e64 v14, 0, v32, s[56:57]
  v_cndmask_b32_e64 v15, 0, v34, s[56:57]
  v_cndmask_b32_e64 v16, 0, v28, s[58:59]
  v_cndmask_b32_e64 v17, 0, v30, s[58:59]
  v_cndmask_b32_e64 v18, 0, v32, s[58:59]
  v_cndmask_b32_e64 v19, 0, v34, s[58:59]
  v_cndmask_b32_e64 v20, 0, v28, s[60:61]
  v_cndmask_b32_e64 v21, 0, v30, s[60:61]
  v_cndmask_b32_e64 v22, 0, v32, s[60:61]
  v_cndmask_b32_e64 v23, 0, v34, s[60:61]
  v_mov_b32 v40, 0xff800000
  ds_read_b128 v[54:57], v5 offset:0
  ds_read_b128 v[58:61], v5 offset:1024
  ds_read_b128 v[46:49], v5 offset:2048
  s_waitcnt lgkmcnt(2)
  v_mfma_f32_16x16x32_bf16 v[24:27], v[54:57], v[8:11], 0
  s_add_u32 m0, s52, 0x0
  s_add_u32 s27, s23, 0x400
  buffer_load_dwordx4 v3, s[12:15], s27 offen nt lds
  ds_read_b128 v[50:53], v5 offset:3072
  s_waitcnt lgkmcnt(2)
  v_mfma_f32_16x16x32_bf16 v[24:27], v[58:61], v[12:15], v[24:27]
  s_add_u32 m0, s52, 0x400
  s_add_u32 s24, s23, 0x480
  buffer_load_dwordx4 v3, s[12:15], s24 offen nt lds
  ds_read_b128 v[54:57], v5 offset:4096
  s_waitcnt lgkmcnt(2)
  v_mfma_f32_16x16x32_bf16 v[24:27], v[46:49], v[16:19], v[24:27]
  s_add_u32 m0, s52, 0x800
  s_add_u32 s25, s23, 0x800
  buffer_load_dwordx4 v3, s[12:15], s25 offen nt lds
  ds_read_b128 v[58:61], v5 offset:5120
  s_waitcnt lgkmcnt(2)
  v_mfma_f32_16x16x32_bf16 v[24:27], v[50:53], v[20:23], v[24:27]
  s_add_u32 m0, s52, 0xc00
  s_add_u32 s26, s23, 0x880
  buffer_load_dwordx4 v3, s[12:15], s26 offen nt lds
  ds_read_b128 v[46:49], v5 offset:6144
  s_waitcnt lgkmcnt(2)
  v_mfma_f32_16x16x32_bf16 v[28:31], v[54:57], v[8:11], 0
  s_add_u32 m0, s52, 0x1000
  s_add_u32 s27, s23, 0xc00
  buffer_load_dwordx4 v3, s[12:15], s27 offen nt lds
  ds_read_b128 v[50:53], v5 offset:7168
  s_waitcnt lgkmcnt(2)
  v_mfma_f32_16x16x32_bf16 v[28:31], v[58:61], v[12:15], v[28:31]
  s_add_u32 m0, s52, 0x1400
  s_add_u32 s24, s23, 0xc80
  buffer_load_dwordx4 v3, s[12:15], s24 offen nt lds
  ds_read_b128 v[54:57], v5 offset:8192
  s_waitcnt lgkmcnt(2)
  v_mfma_f32_16x16x32_bf16 v[28:31], v[46:49], v[16:19], v[28:31]
  s_add_u32 m0, s52, 0x1800
  s_nop 0
  buffer_load_dwordx4 v2, s[12:15], s20 offen nt lds
  ds_read_b128 v[58:61], v5 offset:9216
  s_waitcnt lgkmcnt(2)
  v_mfma_f32_16x16x32_bf16 v[28:31], v[50:53], v[20:23], v[28:31]
  s_add_u32 m0, s52, 0x1c00
  s_add_u32 s25, s20, 0x80
  buffer_load_dwordx4 v2, s[12:15], s25 offen nt lds
  ds_read_b128 v[46:49], v5 offset:10240
  s_waitcnt lgkmcnt(2)
  v_mfma_f32_16x16x32_bf16 v[32:35], v[54:57], v[8:11], 0
  s_add_u32 m0, s52, 0x2000
  s_add_u32 s26, s20, 0x400
  buffer_load_dwordx4 v2, s[12:15], s26 offen nt lds
  v_add_f32_dpp v62, v25, v24 quad_perm:[1,1,1,1] row_mask:0xf bank_mask:0xf
  v_add_f32_dpp v63, v26, v27 quad_perm:[2,2,2,2] row_mask:0xf bank_mask:0xf
  ds_read_b128 v[50:53], v5 offset:11264
  s_waitcnt lgkmcnt(2)
  v_mfma_f32_16x16x32_bf16 v[32:35], v[58:61], v[12:15], v[32:35]
  s_add_u32 m0, s52, 0x2400
  s_add_u32 s27, s20, 0x480
  buffer_load_dwordx4 v2, s[12:15], s27 offen nt lds
  ds_read_b128 v[54:57], v5 offset:12288
  s_waitcnt lgkmcnt(2)
  v_mfma_f32_16x16x32_bf16 v[32:35], v[46:49], v[16:19], v[32:35]
  s_add_u32 m0, s52, 0x2800
  s_add_u32 s24, s20, 0x800
  buffer_load_dwordx4 v2, s[12:15], s24 offen nt lds
  v_add_f32_dpp v36, v63, v62 quad_perm:[3,3,3,3] row_mask:0xf bank_mask:0xf
  ds_read_b128 v[58:61], v5 offset:13312
  s_waitcnt lgkmcnt(2)
  v_mfma_f32_16x16x32_bf16 v[32:35], v[50:53], v[20:23], v[32:35]
  s_add_u32 m0, s52, 0x2c00
  s_add_u32 s25, s20, 0x880
  buffer_load_dwordx4 v2, s[12:15], s25 offen nt lds
  ds_read_b128 v[46:49], v5 offset:14336
  s_waitcnt lgkmcnt(2)
  v_mfma_f32_16x16x32_bf16 v[24:27], v[54:57], v[8:11], 0
  v_add_f32_dpp v62, v28, v29 quad_perm:[0,0,0,0] row_mask:0xf bank_mask:0xf
  v_add_f32_dpp v63, v30, v31 quad_perm:[2,2,2,2] row_mask:0xf bank_mask:0xf
  ds_read_b128 v[50:53], v5 offset:15360
  s_waitcnt lgkmcnt(2)
  v_mfma_f32_16x16x32_bf16 v[24:27], v[58:61], v[12:15], v[24:27]
  ds_read_b128 v[54:57], v5 offset:16384
  s_waitcnt lgkmcnt(2)
  v_mfma_f32_16x16x32_bf16 v[24:27], v[46:49], v[16:19], v[24:27]
  v_add_f32_dpp v62, v63, v62 quad_perm:[3,3,3,3] row_mask:0xf bank_mask:0xf
  ds_read_b128 v[58:61], v5 offset:17408
  s_waitcnt lgkmcnt(2)
  v_mfma_f32_16x16x32_bf16 v[24:27], v[50:53], v[20:23], v[24:27]
  v_cndmask_b32_e64 v36, v36, v62, s[32:33]
  s_waitcnt vmcnt(10)
  s_add_u32 m0, s52, 0x3000
  s_add_u32 s26, s20, 0xc00
  buffer_load_dwordx4 v2, s[12:15], s26 offen nt lds
  s_add_u32 m0, s52, 0x3400
  s_add_u32 s27, s20, 0xc80
  buffer_load_dwordx4 v2, s[12:15], s27 offen nt lds
  ds_read_b128 v[46:49], v5 offset:18432
  s_waitcnt lgkmcnt(2)
  v_mfma_f32_16x16x32_bf16 v[28:31], v[54:57], v[8:11], 0
  v_add_f32_dpp v62, v32, v33 quad_perm:[0,0,0,0] row_mask:0xf bank_mask:0xf
  v_add_f32_dpp v63, v35, v34 quad_perm:[3,3,3,3] row_mask:0xf bank_mask:0xf
  ds_read_b128 v[50:53], v5 offset:19456
  s_waitcnt lgkmcnt(2)
  v_mfma_f32_16x16x32_bf16 v[28:31], v[58:61], v[12:15], v[28:31]
  ds_read_b128 v[54:57], v5 offset:20480
  s_waitcnt lgkmcnt(2)
  v_mfma_f32_16x16x32_bf16 v[28:31], v[46:49], v[16:19], v[28:31]
  v_add_f32_dpp v62, v62, v63 quad_perm:[1,1,1,1] row_mask:0xf bank_mask:0xf
  ds_read_b128 v[58:61], v5 offset:21504
  s_waitcnt lgkmcnt(2)
  v_mfma_f32_16x16x32_bf16 v[28:31], v[50:53], v[20:23], v[28:31]
  v_cndmask_b32_e64 v36, v36, v62, s[34:35]
  ds_read_b128 v[46:49], v5 offset:22528
  s_waitcnt lgkmcnt(2)
  v_mfma_f32_16x16x32_bf16 v[32:35], v[54:57], v[8:11], 0
  v_add_f32_dpp v62, v24, v25 quad_perm:[0,0,0,0] row_mask:0xf bank_mask:0xf
  v_add_f32_dpp v63, v26, v27 quad_perm:[2,2,2,2] row_mask:0xf bank_mask:0xf
  ds_read_b128 v[50:53], v5 offset:23552
  s_waitcnt lgkmcnt(2)
  v_mfma_f32_16x16x32_bf16 v[32:35], v[58:61], v[12:15], v[32:35]
  ds_read_b128 v[54:57], v5 offset:24576
  s_waitcnt lgkmcnt(2)
  v_mfma_f32_16x16x32_bf16 v[32:35], v[46:49], v[16:19], v[32:35]
  v_add_f32_dpp v62, v62, v63 quad_perm:[1,1,1,1] row_mask:0xf bank_mask:0xf
  ds_read_b128 v[58:61], v5 offset:25600
  s_waitcnt lgkmcnt(2)
  v_mfma_f32_16x16x32_bf16 v[32:35], v[50:53], v[20:23], v[32:35]
  v_cndmask_b32_e64 v36, v36, v62, s[36:37]
  ds_read_b128 v[46:49], v5 offset:26624
  s_waitcnt lgkmcnt(2)
  v_mfma_f32_16x16x32_bf16 v[24:27], v[54:57], v[8:11], 0
  v_add_f32_dpp v62, v29, v28 quad_perm:[1,1,1,1] row_mask:0xf bank_mask:0xf
  v_add_f32_dpp v63, v30, v31 quad_perm:[2,2,2,2] row_mask:0xf bank_mask:0xf
  ds_read_b128 v[50:53], v5 offset:27648
  s_waitcnt lgkmcnt(2)
  v_mfma_f32_16x16x32_bf16 v[24:27], v[58:61], v[12:15], v[24:27]
  ds_read_b128 v[54:57], v5 offset:28672
  s_waitcnt lgkmcnt(2)
  v_mfma_f32_16x16x32_bf16 v[24:27], v[46:49], v[16:19], v[24:27]
  v_add_f32_dpp v37, v63, v62 quad_perm:[3,3,3,3] row_mask:0xf bank_mask:0xf
  ds_read_b128 v[58:61], v5 offset:29696
  s_waitcnt lgkmcnt(2)
  v_mfma_f32_16x16x32_bf16 v[24:27], v[50:53], v[20:23], v[24:27]
  ds_read_b128 v[46:49], v5 offset:30720
  s_waitcnt lgkmcnt(2)
  v_mfma_f32_16x16x32_bf16 v[28:31], v[54:57], v[8:11], 0
  v_add_f32_dpp v62, v32, v33 quad_perm:[0,0,0,0] row_mask:0xf bank_mask:0xf
  v_add_f32_dpp v63, v34, v35 quad_perm:[2,2,2,2] row_mask:0xf bank_mask:0xf
  ds_read_b128 v[50:53], v5 offset:31744
  s_waitcnt lgkmcnt(2)
  v_mfma_f32_16x16x32_bf16 v[28:31], v[58:61], v[12:15], v[28:31]
  ds_read_b128 v[54:57], v5 offset:32768
  s_waitcnt lgkmcnt(2)
  v_mfma_f32_16x16x32_bf16 v[28:31], v[46:49], v[16:19], v[28:31]
  v_add_f32_dpp v62, v63, v62 quad_perm:[3,3,3,3] row_mask:0xf bank_mask:0xf
  ds_read_b128 v[58:61], v5 offset:33792
  s_waitcnt lgkmcnt(2)
  v_mfma_f32_16x16x32_bf16 v[28:31], v[50:53], v[20:23], v[28:31]
  v_cndmask_b32_e64 v37, v37, v62, s[32:33]
  s_waitcnt vmcnt(10)
  s_add_u32 m0, s52, 0x3800
  s_add_u32 s24, s20, 0x38000
  buffer_load_dwordx4 v2, s[12:15], s24 offen nt lds
  s_add_u32 m0, s52, 0x3c00
  s_add_u32 s25, s20, 0x38080
  buffer_load_dwordx4 v2, s[12:15], s25 offen nt lds
  ds_read_b128 v[46:49], v5 offset:34816
  s_waitcnt lgkmcnt(2)
  v_mfma_f32_16x16x32_bf16 v[32:35], v[54:57], v[8:11], 0
  v_add_f32_dpp v62, v24, v25 quad_perm:[0,0,0,0] row_mask:0xf bank_mask:0xf
  v_add_f32_dpp v63, v27, v26 quad_perm:[3,3,3,3] row_mask:0xf bank_mask:0xf
  ds_read_b128 v[50:53], v5 offset:35840
  s_waitcnt lgkmcnt(2)
  v_mfma_f32_16x16x32_bf16 v[32:35], v[58:61], v[12:15], v[32:35]
  ds_read_b128 v[54:57], v5 offset:36864
  s_waitcnt lgkmcnt(2)
  v_mfma_f32_16x16x32_bf16 v[32:35], v[46:49], v[16:19], v[32:35]
  v_add_f32_dpp v62, v62, v63 quad_perm:[1,1,1,1] row_mask:0xf bank_mask:0xf
  ds_read_b128 v[58:61], v5 offset:37888
  s_waitcnt lgkmcnt(2)
  v_mfma_f32_16x16x32_bf16 v[32:35], v[50:53], v[20:23], v[32:35]
  v_cndmask_b32_e64 v37, v37, v62, s[34:35]
  s_waitcnt lgkmcnt(1)
  v_mfma_f32_16x16x32_bf16 v[24:27], v[54:57], v[8:11], 0
  v_add_f32_dpp v62, v28, v29 quad_perm:[0,0,0,0] row_mask:0xf bank_mask:0xf
  v_add_f32_dpp v63, v30, v31 quad_perm:[2,2,2,2] row_mask:0xf bank_mask:0xf
  s_waitcnt lgkmcnt(0)
  v_mfma_f32_16x16x32_bf16 v[24:27], v[58:61], v[12:15], v[24:27]
  v_mfma_f32_16x16x32_bf16 v[24:27], v[64:67], v[16:19], v[24:27]
  v_add_f32_dpp v62, v62, v63 quad_perm:[1,1,1,1] row_mask:0xf bank_mask:0xf
  v_mfma_f32_16x16x32_bf16 v[24:27], v[68:71], v[20:23], v[24:27]
  v_cndmask_b32_e64 v37, v37, v62, s[36:37]
  v_mfma_f32_16x16x32_bf16 v[28:31], v[72:75], v[8:11], 0
  v_add_f32_dpp v62, v33, v32 quad_perm:[1,1,1,1] row_mask:0xf bank_mask:0xf
  v_add_f32_dpp v63, v34, v35 quad_perm:[2,2,2,2] row_mask:0xf bank_mask:0xf
  v_mfma_f32_16x16x32_bf16 v[28:31], v[76:79], v[12:15], v[28:31]
  v_mfma_f32_16x16x32_bf16 v[28:31], v[80:83], v[16:19], v[28:31]
  v_add_f32_dpp v38, v63, v62 quad_perm:[3,3,3,3] row_mask:0xf bank_mask:0xf
  v_mfma_f32_16x16x32_bf16 v[28:31], v[84:87], v[20:23], v[28:31]
  v_mfma_f32_16x16x32_bf16 v[32:35], v[88:91], v[8:11], 0
  v_add_f32_dpp v62, v24, v25 quad_perm:[0,0,0,0] row_mask:0xf bank_mask:0xf
  v_add_f32_dpp v63, v26, v27 quad_perm:[2,2,2,2] row_mask:0xf bank_mask:0xf
  v_mfma_f32_16x16x32_bf16 v[32:35], v[92:95], v[12:15], v[32:35]
  v_mfma_f32_16x16x32_bf16 v[32:35], v[96:99], v[16:19], v[32:35]
  v_add_f32_dpp v62, v63, v62 quad_perm:[3,3,3,3] row_mask:0xf bank_mask:0xf
  v_mfma_f32_16x16x32_bf16 v[32:35], v[100:103], v[20:23], v[32:35]
  v_cndmask_b32_e64 v38, v38, v62, s[32:33]
  s_waitcnt vmcnt(10)
  s_add_u32 m0, s52, 0x4000
  s_add_u32 s26, s20, 0x38400
  buffer_load_dwordx4 v2, s[12:15], s26 offen nt lds
  s_add_u32 m0, s52, 0x4400
  s_add_u32 s27, s20, 0x38480
  buffer_load_dwordx4 v2, s[12:15], s27 offen nt lds
  v_mfma_f32_16x16x32_bf16 v[24:27], v[104:107], v[8:11], 0
  v_add_f32_dpp v62, v28, v29 quad_perm:[0,0,0,0] row_mask:0xf bank_mask:0xf
  v_add_f32_dpp v63, v31, v30 quad_perm:[3,3,3,3] row_mask:0xf bank_mask:0xf
  v_mfma_f32_16x16x32_bf16 v[24:27], v[108:111], v[12:15], v[24:27]
  v_mfma_f32_16x16x32_bf16 v[24:27], v[112:115], v[16:19], v[24:27]
  v_add_f32_dpp v62, v62, v63 quad_perm:[1,1,1,1] row_mask:0xf bank_mask:0xf
  v_mfma_f32_16x16x32_bf16 v[24:27], v[116:119], v[20:23], v[24:27]
  v_cndmask_b32_e64 v38, v38, v62, s[34:35]
  v_mfma_f32_16x16x32_bf16 v[28:31], v[120:123], v[8:11], 0
  v_add_f32_dpp v62, v32, v33 quad_perm:[0,0,0,0] row_mask:0xf bank_mask:0xf
  v_add_f32_dpp v63, v34, v35 quad_perm:[2,2,2,2] row_mask:0xf bank_mask:0xf
  v_mfma_f32_16x16x32_bf16 v[28:31], v[124:127], v[12:15], v[28:31]
  v_mfma_f32_16x16x32_bf16 v[28:31], v[128:131], v[16:19], v[28:31]
  v_add_f32_dpp v62, v62, v63 quad_perm:[1,1,1,1] row_mask:0xf bank_mask:0xf
  v_mfma_f32_16x16x32_bf16 v[28:31], v[132:135], v[20:23], v[28:31]
  v_cndmask_b32_e64 v38, v38, v62, s[36:37]
  v_mfma_f32_16x16x32_bf16 v[32:35], v[136:139], v[8:11], 0
  v_add_f32_dpp v62, v25, v24 quad_perm:[1,1,1,1] row_mask:0xf bank_mask:0xf
  v_add_f32_dpp v63, v26, v27 quad_perm:[2,2,2,2] row_mask:0xf bank_mask:0xf
  v_mfma_f32_16x16x32_bf16 v[32:35], v[140:143], v[12:15], v[32:35]
  v_mfma_f32_16x16x32_bf16 v[32:35], v[144:147], v[16:19], v[32:35]
  v_add_f32_dpp v39, v63, v62 quad_perm:[3,3,3,3] row_mask:0xf bank_mask:0xf
  v_mfma_f32_16x16x32_bf16 v[32:35], v[148:151], v[20:23], v[32:35]
  v_mfma_f32_16x16x32_bf16 v[24:27], v[152:155], v[8:11], 0
  v_add_f32_dpp v62, v28, v29 quad_perm:[0,0,0,0] row_mask:0xf bank_mask:0xf
  v_add_f32_dpp v63, v30, v31 quad_perm:[2,2,2,2] row_mask:0xf bank_mask:0xf
  v_mfma_f32_16x16x32_bf16 v[24:27], v[156:159], v[12:15], v[24:27]
  v_mfma_f32_16x16x32_bf16 v[24:27], v[160:163], v[16:19], v[24:27]
  v_add_f32_dpp v62, v63, v62 quad_perm:[3,3,3,3] row_mask:0xf bank_mask:0xf
  v_mfma_f32_16x16x32_bf16 v[24:27], v[164:167], v[20:23], v[24:27]
  v_cndmask_b32_e64 v39, v39, v62, s[32:33]
  s_waitcnt vmcnt(10)
  s_add_u32 m0, s52, 0x4800
  s_add_u32 s24, s20, 0x38800
  buffer_load_dwordx4 v2, s[12:15], s24 offen nt lds
  s_add_u32 m0, s52, 0x4c00
  s_add_u32 s25, s20, 0x38880
  buffer_load_dwordx4 v2, s[12:15], s25 offen nt lds
  v_mfma_f32_16x16x32_bf16 v[28:31], v[168:171], v[8:11], 0
  v_add_f32_dpp v62, v32, v33 quad_perm:[0,0,0,0] row_mask:0xf bank_mask:0xf
  v_add_f32_dpp v63, v35, v34 quad_perm:[3,3,3,3] row_mask:0xf bank_mask:0xf
  v_mfma_f32_16x16x32_bf16 v[28:31], v[172:175], v[12:15], v[28:31]
  v_mfma_f32_16x16x32_bf16 v[28:31], v[176:179], v[16:19], v[28:31]
  v_add_f32_dpp v62, v62, v63 quad_perm:[1,1,1,1] row_mask:0xf bank_mask:0xf
  v_mfma_f32_16x16x32_bf16 v[28:31], v[180:183], v[20:23], v[28:31]
  v_cndmask_b32_e64 v39, v39, v62, s[34:35]
  v_mfma_f32_16x16x32_bf16 v[32:35], v[184:187], v[8:11], 0
  v_add_f32_dpp v62, v24, v25 quad_perm:[0,0,0,0] row_mask:0xf bank_mask:0xf
  v_add_f32_dpp v63, v26, v27 quad_perm:[2,2,2,2] row_mask:0xf bank_mask:0xf
  v_mfma_f32_16x16x32_bf16 v[32:35], v[188:191], v[12:15], v[32:35]
  v_mfma_f32_16x16x32_bf16 v[32:35], v[192:195], v[16:19], v[32:35]
  v_add_f32_dpp v62, v62, v63 quad_perm:[1,1,1,1] row_mask:0xf bank_mask:0xf
  v_mfma_f32_16x16x32_bf16 v[32:35], v[196:199], v[20:23], v[32:35]
  v_cndmask_b32_e64 v39, v39, v62, s[36:37]
  v_mfma_f32_16x16x32_bf16 v[24:27], v[208:211], v[8:11], 0
  v_add_f32_dpp v62, v29, v28 quad_perm:[1,1,1,1] row_mask:0xf bank_mask:0xf
  v_add_f32_dpp v63, v30, v31 quad_perm:[2,2,2,2] row_mask:0xf bank_mask:0xf
  v_mfma_f32_16x16x32_bf16 v[24:27], v[212:215], v[12:15], v[24:27]
  v_mfma_f32_16x16x32_bf16 v[24:27], a[240:243], v[16:19], v[24:27]
  v_add_f32_dpp v62, v63, v62 quad_perm:[3,3,3,3] row_mask:0xf bank_mask:0xf
  v_mfma_f32_16x16x32_bf16 v[24:27], a[244:247], v[20:23], v[24:27]
  v_cndmask_b32_e64 v40, v40, v62, s[30:31]
  v_add_f32_dpp v62, v32, v33 quad_perm:[0,0,0,0] row_mask:0xf bank_mask:0xf
  v_add_f32_dpp v63, v34, v35 quad_perm:[2,2,2,2] row_mask:0xf bank_mask:0xf
  s_nop 1
  v_add_f32_dpp v62, v63, v62 quad_perm:[3,3,3,3] row_mask:0xf bank_mask:0xf
  v_cndmask_b32_e64 v40, v40, v62, s[32:33]
  s_nop 0
  v_add_f32_dpp v62, v24, v25 quad_perm:[0,0,0,0] row_mask:0xf bank_mask:0xf
  v_add_f32_dpp v63, v27, v26 quad_perm:[3,3,3,3] row_mask:0xf bank_mask:0xf
  s_nop 1
  v_add_f32_dpp v62, v62, v63 quad_perm:[1,1,1,1] row_mask:0xf bank_mask:0xf
  v_cndmask_b32_e64 v40, v40, v62, s[38:39]
  v_cvt_pk_bf16_f32 v36, v36, v36
  v_cvt_pk_bf16_f32 v37, v37, v37
  v_cvt_pk_bf16_f32 v38, v38, v38
  v_cvt_pk_bf16_f32 v39, v39, v39
  v_cvt_pk_bf16_f32 v40, v40, v40
  v_and_b32 v36, 0xffff0000, v36
  v_and_b32 v37, 0xffff0000, v37
  v_and_b32 v38, 0xffff0000, v38
  v_and_b32 v39, 0xffff0000, v39
  v_and_b32 v40, 0xffff0000, v40
  v_mul_f32 v36, s53, v36
  v_mul_f32 v37, s53, v37
  v_mul_f32 v38, s53, v38
  v_mul_f32 v39, s53, v39
  v_mul_f32 v40, s53, v40
  v_cvt_pk_bf16_f32 v36, v36, v36
  v_cvt_pk_bf16_f32 v37, v37, v37
  v_cvt_pk_bf16_f32 v38, v38, v38
  v_cvt_pk_bf16_f32 v39, v39, v39
  v_cvt_pk_bf16_f32 v40, v40, v40
  v_and_b32 v36, 0xffff0000, v36
  v_and_b32 v37, 0xffff0000, v37
  v_and_b32 v38, 0xffff0000, v38
  v_and_b32 v39, 0xffff0000, v39
  v_and_b32 v40, 0xffff0000, v40
  v_max3_f32 v62, v36, v37, v38
  v_max3_f32 v62, v62, v39, v40
  s_nop 1
  v_max_f32_dpp v62, v62, v62 row_shr:1 row_mask:0xf bank_mask:0xf
  s_nop 1
  v_max_f32_dpp v62, v62, v62 row_shr:2 row_mask:0xf bank_mask:0xf
  s_nop 1
  v_max_f32_dpp v62, v62, v62 row_shr:4 row_mask:0xf bank_mask:0xf
  s_nop 1
  v_max_f32_dpp v62, v62, v62 row_shr:8 row_mask:0xf bank_mask:0xf
  s_nop 1
  v_max_f32_dpp v62, v62, v62 row_bcast:15 row_mask:0xa bank_mask:0xf
  s_nop 1
  v_max_f32_dpp v62, v62, v62 row_bcast:31 row_mask:0xc bank_mask:0xf
  s_nop 0
  v_readlane_b32 s43, v62, 63
  s_nop 1
  v_mov_b32 v63, s43
  v_mul_f32 v63, s28, v63
  v_fma_f32 v36, v36, s28, -v63
  v_fma_f32 v37, v37, s28, -v63
  v_fma_f32 v38, v38, s28, -v63
  v_fma_f32 v39, v39, s28, -v63
  v_fma_f32 v40, v40, s28, -v63
  v_exp_f32 v36, v36
  v_exp_f32 v37, v37
  v_exp_f32 v38, v38
  v_exp_f32 v39, v39
  v_exp_f32 v40, v40
  v_add_f32 v62, v36, v37
  v_add_f32 v63, v38, v39
  v_add_f32 v62, v62, v40
  v_cvt_pk_bf16_f32 v36, v36, v36
  v_cvt_pk_bf16_f32 v37, v37, v37
  v_cvt_pk_bf16_f32 v38, v38, v38
  v_cvt_pk_bf16_f32 v39, v39, v39
  v_cvt_pk_bf16_f32 v40, v40, v40
  v_add_f32 v62, v62, v63
  v_and_b32_dpp v24, v36, v4 quad_perm:[0,0,1,1] row_mask:0xf bank_mask:0xf
  v_mov_b32 v8, 0
  v_mov_b32 v9, 0
  v_mov_b32 v10, 0
  v_mov_b32 v11, 0
  v_mov_b32 v12, 0
  v_mov_b32 v13, 0
  v_mov_b32 v14, 0
  v_mov_b32 v15, 0
  v_mov_b32_dpp v8, v24 quad_perm:[0,1,2,3] row_mask:0xf bank_mask:0x1
  v_mov_b32_dpp v9, v24 row_ror:4 row_mask:0xf bank_mask:0x2
  v_mov_b32_dpp v10, v24 row_ror:8 row_mask:0xf bank_mask:0x4
  v_mov_b32_dpp v11, v24 row_ror:12 row_mask:0xf bank_mask:0x8
  s_nop 1
  v_mfma_f32_16x16x32_bf16 v[16:19], v[216:219], v[8:11], 0
  v_mov_b32_dpp v12, v24 row_ror:12 row_mask:0xf bank_mask:0x1
  v_mov_b32_dpp v13, v24 quad_perm:[0,1,2,3] row_mask:0xf bank_mask:0x2
  v_mfma_f32_16x16x32_bf16 v[20:23], v[220:223], v[8:11], 0
  v_mov_b32_dpp v14, v24 row_ror:4 row_mask:0xf bank_mask:0x4
  v_mov_b32_dpp v15, v24 row_ror:8 row_mask:0xf bank_mask:0x8
  v_add_f32_dpp v62, v62, v62 row_shr:1 row_mask:0xf bank_mask:0xf
  s_nop 0
  v_mfma_f32_16x16x32_bf16 v[16:19], v[224:227], v[12:15], v[16:19]
  v_mov_b32_dpp v8, v24 row_ror:8 row_mask:0xf bank_mask:0x1
  v_mov_b32_dpp v9, v24 row_ror:12 row_mask:0xf bank_mask:0x2
  v_and_b32_dpp v25, v36, v4 quad_perm:[2,2,3,3] row_mask:0xf bank_mask:0xf
  v_mfma_f32_16x16x32_bf16 v[20:23], v[228:231], v[12:15], v[20:23]
  v_mov_b32_dpp v10, v24 quad_perm:[0,1,2,3] row_mask:0xf bank_mask:0x4
  v_mov_b32_dpp v11, v24 row_ror:4 row_mask:0xf bank_mask:0x8
  v_add_f32_dpp v62, v62, v62 row_shr:2 row_mask:0xf bank_mask:0xf
  s_nop 0
  v_mfma_f32_16x16x32_bf16 v[16:19], v[232:235], v[8:11], v[16:19]
  v_mov_b32_dpp v12, v24 row_ror:4 row_mask:0xf bank_mask:0x1
  v_mov_b32_dpp v13, v24 row_ror:8 row_mask:0xf bank_mask:0x2
  v_mfma_f32_16x16x32_bf16 v[20:23], v[236:239], v[8:11], v[20:23]
  v_mov_b32_dpp v14, v24 row_ror:12 row_mask:0xf bank_mask:0x4
  v_mov_b32_dpp v15, v24 quad_perm:[0,1,2,3] row_mask:0xf bank_mask:0x8
  v_add_f32_dpp v62, v62, v62 row_shr:4 row_mask:0xf bank_mask:0xf
  s_nop 0
  v_mfma_f32_16x16x32_bf16 v[16:19], v[240:243], v[12:15], v[16:19]
  v_mov_b32_dpp v8, v25 quad_perm:[0,1,2,3] row_mask:0xf bank_mask:0x1
  v_mov_b32_dpp v9, v25 row_ror:4 row_mask:0xf bank_mask:0x2
  v_mfma_f32_16x16x32_bf16 v[20:23], v[244:247], v[12:15], v[20:23]
  v_mov_b32_dpp v10, v25 row_ror:8 row_mask:0xf bank_mask:0x4
  v_mov_b32_dpp v11, v25 row_ror:12 row_mask:0xf bank_mask:0x8
  v_add_f32_dpp v62, v62, v62 row_shr:8 row_mask:0xf bank_mask:0xf
  s_waitcnt vmcnt(10)
  s_add_u32 m0, s52, 0x5000
  s_add_u32 s26, s20, 0x38c00
  buffer_load_dwordx4 v2, s[12:15], s26 offen nt lds
  s_add_u32 m0, s52, 0x5400
  s_add_u32 s27, s20, 0x38c80
  buffer_load_dwordx4 v2, s[12:15], s27 offen nt lds
  v_mfma_f32_16x16x32_bf16 v[16:19], v[248:251], v[8:11], v[16:19]
  v_mov_b32_dpp v12, v25 row_ror:12 row_mask:0xf bank_mask:0x1
  v_mov_b32_dpp v13, v25 quad_perm:[0,1,2,3] row_mask:0xf bank_mask:0x2
  v_mfma_f32_16x16x32_bf16 v[20:23], v[252:255], v[8:11], v[20:23]
  v_mov_b32_dpp v14, v25 row_ror:4 row_mask:0xf bank_mask:0x4
  v_mov_b32_dpp v15, v25 row_ror:8 row_mask:0xf bank_mask:0x8
  v_add_f32_dpp v62, v62, v62 row_bcast:15 row_mask:0xa bank_mask:0xf
  s_nop 0
  v_mfma_f32_16x16x32_bf16 v[16:19], a[0:3], v[12:15], v[16:19]
  v_mov_b32_dpp v8, v25 row_ror:8 row_mask:0xf bank_mask:0x1
  v_mov_b32_dpp v9, v25 row_ror:12 row_mask:0xf bank_mask:0x2
  v_and_b32_dpp v24, v37, v4 quad_perm:[0,0,1,1] row_mask:0xf bank_mask:0xf
  v_mfma_f32_16x16x32_bf16 v[20:23], a[4:7], v[12:15], v[20:23]
  v_mov_b32_dpp v10, v25 quad_perm:[0,1,2,3] row_mask:0xf bank_mask:0x4
  v_mov_b32_dpp v11, v25 row_ror:4 row_mask:0xf bank_mask:0x8
  v_add_f32_dpp v62, v62, v62 row_bcast:31 row_mask:0xc bank_mask:0xf
  s_nop 0
  v_mfma_f32_16x16x32_bf16 v[16:19], a[8:11], v[8:11], v[16:19]
  v_mov_b32_dpp v12, v25 row_ror:4 row_mask:0xf bank_mask:0x1
  v_mov_b32_dpp v13, v25 row_ror:8 row_mask:0xf bank_mask:0x2
  v_mfma_f32_16x16x32_bf16 v[20:23], a[12:15], v[8:11], v[20:23]
  v_mov_b32_dpp v14, v25 row_ror:12 row_mask:0xf bank_mask:0x4
  v_mov_b32_dpp v15, v25 quad_perm:[0,1,2,3] row_mask:0xf bank_mask:0x8
  v_readlane_b32 s45, v62, 63
  s_nop 0
  v_mfma_f32_16x16x32_bf16 v[16:19], a[16:19], v[12:15], v[16:19]
  v_mov_b32_dpp v8, v24 quad_perm:[0,1,2,3] row_mask:0xf bank_mask:0x1
  v_mov_b32_dpp v9, v24 row_ror:4 row_mask:0xf bank_mask:0x2
  v_mfma_f32_16x16x32_bf16 v[20:23], a[20:23], v[12:15], v[20:23]
  v_mov_b32_dpp v10, v24 row_ror:8 row_mask:0xf bank_mask:0x4
  v_mov_b32_dpp v11, v24 row_ror:12 row_mask:0xf bank_mask:0x8
  s_waitcnt vmcnt(10)
  s_add_u32 m0, s52, 0x5800
  s_add_u32 s24, s20, 0x70000
  buffer_load_dwordx4 v2, s[12:15], s24 offen nt lds
  s_add_u32 m0, s52, 0x5c00
  s_add_u32 s25, s20, 0x70080
  buffer_load_dwordx4 v2, s[12:15], s25 offen nt lds
  v_mfma_f32_16x16x32_bf16 v[16:19], a[24:27], v[8:11], v[16:19]
  v_mov_b32_dpp v12, v24 row_ror:12 row_mask:0xf bank_mask:0x1
  v_mov_b32_dpp v13, v24 quad_perm:[0,1,2,3] row_mask:0xf bank_mask:0x2
  v_mfma_f32_16x16x32_bf16 v[20:23], a[28:31], v[8:11], v[20:23]
  v_mov_b32_dpp v14, v24 row_ror:4 row_mask:0xf bank_mask:0x4
  v_mov_b32_dpp v15, v24 row_ror:8 row_mask:0xf bank_mask:0x8
  s_nop 1
  v_mfma_f32_16x16x32_bf16 v[16:19], a[32:35], v[12:15], v[16:19]
  v_mov_b32_dpp v8, v24 row_ror:8 row_mask:0xf bank_mask:0x1
  v_mov_b32_dpp v9, v24 row_ror:12 row_mask:0xf bank_mask:0x2
  v_and_b32_dpp v25, v37, v4 quad_perm:[2,2,3,3] row_mask:0xf bank_mask:0xf
  v_mfma_f32_16x16x32_bf16 v[20:23], a[36:39], v[12:15], v[20:23]
  v_mov_b32_dpp v10, v24 quad_perm:[0,1,2,3] row_mask:0xf bank_mask:0x4
  v_mov_b32_dpp v11, v24 row_ror:4 row_mask:0xf bank_mask:0x8
  s_nop 1
  v_mfma_f32_16x16x32_bf16 v[16:19], a[40:43], v[8:11], v[16:19]
  v_mov_b32_dpp v12, v24 row_ror:4 row_mask:0xf bank_mask:0x1
  v_mov_b32_dpp v13, v24 row_ror:8 row_mask:0xf bank_mask:0x2
  v_mfma_f32_16x16x32_bf16 v[20:23], a[44:47], v[8:11], v[20:23]
  v_mov_b32_dpp v14, v24 row_ror:12 row_mask:0xf bank_mask:0x4
  v_mov_b32_dpp v15, v24 quad_perm:[0,1,2,3] row_mask:0xf bank_mask:0x8
  s_nop 1
  v_mfma_f32_16x16x32_bf16 v[16:19], a[48:51], v[12:15], v[16:19]
  v_mov_b32_dpp v8, v25 quad_perm:[0,1,2,3] row_mask:0xf bank_mask:0x1
  v_mov_b32_dpp v9, v25 row_ror:4 row_mask:0xf bank_mask:0x2
  v_mfma_f32_16x16x32_bf16 v[20:23], a[52:55], v[12:15], v[20:23]
  v_mov_b32_dpp v10, v25 row_ror:8 row_mask:0xf bank_mask:0x4
  v_mov_b32_dpp v11, v25 row_ror:12 row_mask:0xf bank_mask:0x8
  s_waitcnt vmcnt(10)
  s_add_u32 m0, s52, 0x6000
  s_add_u32 s26, s20, 0x70400
  buffer_load_dwordx4 v2, s[12:15], s26 offen nt lds
  s_add_u32 m0, s52, 0x6400
  s_add_u32 s27, s20, 0x70480
  buffer_load_dwordx4 v2, s[12:15], s27 offen nt lds
  v_mfma_f32_16x16x32_bf16 v[16:19], a[56:59], v[8:11], v[16:19]
  v_mov_b32_dpp v12, v25 row_ror:12 row_mask:0xf bank_mask:0x1
  v_mov_b32_dpp v13, v25 quad_perm:[0,1,2,3] row_mask:0xf bank_mask:0x2
  v_mfma_f32_16x16x32_bf16 v[20:23], a[60:63], v[8:11], v[20:23]
  v_mov_b32_dpp v14, v25 row_ror:4 row_mask:0xf bank_mask:0x4
  v_mov_b32_dpp v15, v25 row_ror:8 row_mask:0xf bank_mask:0x8
  s_nop 1
  v_mfma_f32_16x16x32_bf16 v[16:19], a[64:67], v[12:15], v[16:19]
  v_mov_b32_dpp v8, v25 row_ror:8 row_mask:0xf bank_mask:0x1
  v_mov_b32_dpp v9, v25 row_ror:12 row_mask:0xf bank_mask:0x2
  v_and_b32_dpp v24, v38, v4 quad_perm:[0,0,1,1] row_mask:0xf bank_mask:0xf
  v_mfma_f32_16x16x32_bf16 v[20:23], a[68:71], v[12:15], v[20:23]
  v_mov_b32_dpp v10, v25 quad_perm:[0,1,2,3] row_mask:0xf bank_mask:0x4
  v_mov_b32_dpp v11, v25 row_ror:4 row_mask:0xf bank_mask:0x8
  s_nop 1
  v_mfma_f32_16x16x32_bf16 v[16:19], a[72:75], v[8:11], v[16:19]
  v_mov_b32_dpp v12, v25 row_ror:4 row_mask:0xf bank_mask:0x1
  v_mov_b32_dpp v13, v25 row_ror:8 row_mask:0xf bank_mask:0x2
  v_mfma_f32_16x16x32_bf16 v[20:23], a[76:79], v[8:11], v[20:23]
  v_mov_b32_dpp v14, v25 row_ror:12 row_mask:0xf bank_mask:0x4
  v_mov_b32_dpp v15, v25 quad_perm:[0,1,2,3] row_mask:0xf bank_mask:0x8
  s_nop 1
  v_mfma_f32_16x16x32_bf16 v[16:19], a[80:83], v[12:15], v[16:19]
  v_mov_b32_dpp v8, v24 quad_perm:[0,1,2,3] row_mask:0xf bank_mask:0x1
  v_mov_b32_dpp v9, v24 row_ror:4 row_mask:0xf bank_mask:0x2
  v_mfma_f32_16x16x32_bf16 v[20:23], a[84:87], v[12:15], v[20:23]
  v_mov_b32_dpp v10, v24 row_ror:8 row_mask:0xf bank_mask:0x4
  v_mov_b32_dpp v11, v24 row_ror:12 row_mask:0xf bank_mask:0x8
  s_waitcnt vmcnt(10)
  s_add_u32 m0, s52, 0x6800
  s_add_u32 s24, s20, 0x70800
  buffer_load_dwordx4 v2, s[12:15], s24 offen nt lds
  s_add_u32 m0, s52, 0x6c00
  s_add_u32 s25, s20, 0x70880
  buffer_load_dwordx4 v2, s[12:15], s25 offen nt lds
  v_mfma_f32_16x16x32_bf16 v[16:19], a[88:91], v[8:11], v[16:19]
  v_mov_b32_dpp v12, v24 row_ror:12 row_mask:0xf bank_mask:0x1
  v_mov_b32_dpp v13, v24 quad_perm:[0,1,2,3] row_mask:0xf bank_mask:0x2
  v_mfma_f32_16x16x32_bf16 v[20:23], a[92:95], v[8:11], v[20:23]
  v_mov_b32_dpp v14, v24 row_ror:4 row_mask:0xf bank_mask:0x4
  v_mov_b32_dpp v15, v24 row_ror:8 row_mask:0xf bank_mask:0x8
  s_nop 1
  v_mfma_f32_16x16x32_bf16 v[16:19], a[96:99], v[12:15], v[16:19]
  v_mov_b32_dpp v8, v24 row_ror:8 row_mask:0xf bank_mask:0x1
  v_mov_b32_dpp v9, v24 row_ror:12 row_mask:0xf bank_mask:0x2
  v_and_b32_dpp v25, v38, v4 quad_perm:[2,2,3,3] row_mask:0xf bank_mask:0xf
  v_mfma_f32_16x16x32_bf16 v[20:23], a[100:103], v[12:15], v[20:23]
  v_mov_b32_dpp v10, v24 quad_perm:[0,1,2,3] row_mask:0xf bank_mask:0x4
  v_mov_b32_dpp v11, v24 row_ror:4 row_mask:0xf bank_mask:0x8
  s_nop 1
  v_mfma_f32_16x16x32_bf16 v[16:19], a[104:107], v[8:11], v[16:19]
  v_mov_b32_dpp v12, v24 row_ror:4 row_mask:0xf bank_mask:0x1
  v_mov_b32_dpp v13, v24 row_ror:8 row_mask:0xf bank_mask:0x2
  v_mfma_f32_16x16x32_bf16 v[20:23], a[108:111], v[8:11], v[20:23]
  v_mov_b32_dpp v14, v24 row_ror:12 row_mask:0xf bank_mask:0x4
  v_mov_b32_dpp v15, v24 quad_perm:[0,1,2,3] row_mask:0xf bank_mask:0x8
  s_nop 1
  v_mfma_f32_16x16x32_bf16 v[16:19], a[112:115], v[12:15], v[16:19]
  v_mov_b32_dpp v8, v25 quad_perm:[0,1,2,3] row_mask:0xf bank_mask:0x1
  v_mov_b32_dpp v9, v25 row_ror:4 row_mask:0xf bank_mask:0x2
  v_mfma_f32_16x16x32_bf16 v[20:23], a[116:119], v[12:15], v[20:23]
  v_mov_b32_dpp v10, v25 row_ror:8 row_mask:0xf bank_mask:0x4
  v_mov_b32_dpp v11, v25 row_ror:12 row_mask:0xf bank_mask:0x8
  s_waitcnt vmcnt(10)
  s_add_u32 m0, s52, 0x7000
  s_add_u32 s26, s20, 0x70c00
  buffer_load_dwordx4 v2, s[12:15], s26 offen nt lds
  s_add_u32 m0, s52, 0x7400
  s_add_u32 s27, s20, 0x70c80
  buffer_load_dwordx4 v2, s[12:15], s27 offen nt lds
  v_mfma_f32_16x16x32_bf16 v[16:19], a[120:123], v[8:11], v[16:19]
  v_mov_b32_dpp v12, v25 row_ror:12 row_mask:0xf bank_mask:0x1
  v_mov_b32_dpp v13, v25 quad_perm:[0,1,2,3] row_mask:0xf bank_mask:0x2
  v_mfma_f32_16x16x32_bf16 v[20:23], a[124:127], v[8:11], v[20:23]
  v_mov_b32_dpp v14, v25 row_ror:4 row_mask:0xf bank_mask:0x4
  v_mov_b32_dpp v15, v25 row_ror:8 row_mask:0xf bank_mask:0x8
  s_nop 1
  v_mfma_f32_16x16x32_bf16 v[16:19], a[128:131], v[12:15], v[16:19]
  v_mov_b32_dpp v8, v25 row_ror:8 row_mask:0xf bank_mask:0x1
  v_mov_b32_dpp v9, v25 row_ror:12 row_mask:0xf bank_mask:0x2
  v_and_b32_dpp v24, v39, v4 quad_perm:[0,0,1,1] row_mask:0xf bank_mask:0xf
  v_mfma_f32_16x16x32_bf16 v[20:23], a[132:135], v[12:15], v[20:23]
  v_mov_b32_dpp v10, v25 quad_perm:[0,1,2,3] row_mask:0xf bank_mask:0x4
  v_mov_b32_dpp v11, v25 row_ror:4 row_mask:0xf bank_mask:0x8
  s_nop 1
  v_mfma_f32_16x16x32_bf16 v[16:19], a[136:139], v[8:11], v[16:19]
  v_mov_b32_dpp v12, v25 row_ror:4 row_mask:0xf bank_mask:0x1
  v_mov_b32_dpp v13, v25 row_ror:8 row_mask:0xf bank_mask:0x2
  v_mfma_f32_16x16x32_bf16 v[20:23], a[140:143], v[8:11], v[20:23]
  v_mov_b32_dpp v14, v25 row_ror:12 row_mask:0xf bank_mask:0x4
  v_mov_b32_dpp v15, v25 quad_perm:[0,1,2,3] row_mask:0xf bank_mask:0x8
  s_nop 1
  v_mfma_f32_16x16x32_bf16 v[16:19], a[144:147], v[12:15], v[16:19]
  v_mov_b32_dpp v8, v24 quad_perm:[0,1,2,3] row_mask:0xf bank_mask:0x1
  v_mov_b32_dpp v9, v24 row_ror:4 row_mask:0xf bank_mask:0x2
  v_mfma_f32_16x16x32_bf16 v[20:23], a[148:151], v[12:15], v[20:23]
  v_mov_b32_dpp v10, v24 row_ror:8 row_mask:0xf bank_mask:0x4
  v_mov_b32_dpp v11, v24 row_ror:12 row_mask:0xf bank_mask:0x8
  s_waitcnt vmcnt(10)
  s_add_u32 m0, s52, 0x7800
  s_add_u32 s24, s20, 0xa8000
  buffer_load_dwordx4 v2, s[12:15], s24 offen nt lds
  s_add_u32 m0, s52, 0x7c00
  s_add_u32 s25, s20, 0xa8080
  buffer_load_dwordx4 v2, s[12:15], s25 offen nt lds
  v_mfma_f32_16x16x32_bf16 v[16:19], a[152:155], v[8:11], v[16:19]
  v_mov_b32_dpp v12, v24 row_ror:12 row_mask:0xf bank_mask:0x1
  v_mov_b32_dpp v13, v24 quad_perm:[0,1,2,3] row_mask:0xf bank_mask:0x2
  v_mfma_f32_16x16x32_bf16 v[20:23], a[156:159], v[8:11], v[20:23]
  v_mov_b32_dpp v14, v24 row_ror:4 row_mask:0xf bank_mask:0x4
  v_mov_b32_dpp v15, v24 row_ror:8 row_mask:0xf bank_mask:0x8
  s_nop 1
  v_mfma_f32_16x16x32_bf16 v[16:19], a[160:163], v[12:15], v[16:19]
  v_mov_b32_dpp v8, v24 row_ror:8 row_mask:0xf bank_mask:0x1
  v_mov_b32_dpp v9, v24 row_ror:12 row_mask:0xf bank_mask:0x2
  v_and_b32_dpp v25, v39, v4 quad_perm:[2,2,3,3] row_mask:0xf bank_mask:0xf
  v_mfma_f32_16x16x32_bf16 v[20:23], a[164:167], v[12:15], v[20:23]
  v_mov_b32_dpp v10, v24 quad_perm:[0,1,2,3] row_mask:0xf bank_mask:0x4
  v_mov_b32_dpp v11, v24 row_ror:4 row_mask:0xf bank_mask:0x8
  s_nop 1
  v_mfma_f32_16x16x32_bf16 v[16:19], a[168:171], v[8:11], v[16:19]
  v_mov_b32_dpp v12, v24 row_ror:4 row_mask:0xf bank_mask:0x1
  v_mov_b32_dpp v13, v24 row_ror:8 row_mask:0xf bank_mask:0x2
  v_mfma_f32_16x16x32_bf16 v[20:23], a[172:175], v[8:11], v[20:23]
  v_mov_b32_dpp v14, v24 row_ror:12 row_mask:0xf bank_mask:0x4
  v_mov_b32_dpp v15, v24 quad_perm:[0,1,2,3] row_mask:0xf bank_mask:0x8
  s_nop 1
  v_mfma_f32_16x16x32_bf16 v[16:19], a[176:179], v[12:15], v[16:19]
  v_mov_b32_dpp v8, v25 quad_perm:[0,1,2,3] row_mask:0xf bank_mask:0x1
  v_mov_b32_dpp v9, v25 row_ror:4 row_mask:0xf bank_mask:0x2
  v_mfma_f32_16x16x32_bf16 v[20:23], a[180:183], v[12:15], v[20:23]
  v_mov_b32_dpp v10, v25 row_ror:8 row_mask:0xf bank_mask:0x4
  v_mov_b32_dpp v11, v25 row_ror:12 row_mask:0xf bank_mask:0x8
  s_waitcnt vmcnt(10)
  s_add_u32 m0, s52, 0x8000
  s_add_u32 s26, s20, 0xa8400
  buffer_load_dwordx4 v2, s[12:15], s26 offen nt lds
  s_add_u32 m0, s52, 0x8400
  s_add_u32 s27, s20, 0xa8480
  buffer_load_dwordx4 v2, s[12:15], s27 offen nt lds
  v_mfma_f32_16x16x32_bf16 v[16:19], a[184:187], v[8:11], v[16:19]
  v_mov_b32_dpp v12, v25 row_ror:12 row_mask:0xf bank_mask:0x1
  v_mov_b32_dpp v13, v25 quad_perm:[0,1,2,3] row_mask:0xf bank_mask:0x2
  v_mfma_f32_16x16x32_bf16 v[20:23], a[188:191], v[8:11], v[20:23]
  v_mov_b32_dpp v14, v25 row_ror:4 row_mask:0xf bank_mask:0x4
  v_mov_b32_dpp v15, v25 row_ror:8 row_mask:0xf bank_mask:0x8
  s_nop 1
  v_mfma_f32_16x16x32_bf16 v[16:19], a[192:195], v[12:15], v[16:19]
  v_mov_b32_dpp v8, v25 row_ror:8 row_mask:0xf bank_mask:0x1
  v_mov_b32_dpp v9, v25 row_ror:12 row_mask:0xf bank_mask:0x2
  v_and_b32_dpp v24, v40, v4 quad_perm:[0,0,1,1] row_mask:0xf bank_mask:0xf
  v_mfma_f32_16x16x32_bf16 v[20:23], a[196:199], v[12:15], v[20:23]
  v_mov_b32_dpp v10, v25 quad_perm:[0,1,2,3] row_mask:0xf bank_mask:0x4
  v_mov_b32_dpp v11, v25 row_ror:4 row_mask:0xf bank_mask:0x8
  s_nop 1
  v_mfma_f32_16x16x32_bf16 v[16:19], a[200:203], v[8:11], v[16:19]
  v_mov_b32_dpp v12, v25 row_ror:4 row_mask:0xf bank_mask:0x1
  v_mov_b32_dpp v13, v25 row_ror:8 row_mask:0xf bank_mask:0x2
  v_mfma_f32_16x16x32_bf16 v[20:23], a[204:207], v[8:11], v[20:23]
  v_mov_b32_dpp v14, v25 row_ror:12 row_mask:0xf bank_mask:0x4
  v_mov_b32_dpp v15, v25 quad_perm:[0,1,2,3] row_mask:0xf bank_mask:0x8
  s_nop 1
  v_mfma_f32_16x16x32_bf16 v[16:19], a[208:211], v[12:15], v[16:19]
  v_mov_b32_dpp v8, v24 quad_perm:[0,1,2,3] row_mask:0xf bank_mask:0x1
  v_mov_b32_dpp v9, v24 row_ror:4 row_mask:0xf bank_mask:0x2
  v_mfma_f32_16x16x32_bf16 v[20:23], a[212:215], v[12:15], v[20:23]
  v_mov_b32_dpp v10, v24 row_ror:8 row_mask:0xf bank_mask:0x4
  v_mov_b32_dpp v11, v24 row_ror:12 row_mask:0xf bank_mask:0x8
  s_waitcnt vmcnt(10)
  s_add_u32 m0, s52, 0x8800
  s_add_u32 s24, s20, 0xa8800
  buffer_load_dwordx4 v2, s[12:15], s24 offen nt lds
  s_add_u32 m0, s52, 0x8c00
  s_add_u32 s25, s20, 0xa8880
  buffer_load_dwordx4 v2, s[12:15], s25 offen nt lds
  v_mfma_f32_16x16x32_bf16 v[16:19], a[216:219], v[8:11], v[16:19]
  v_mov_b32_dpp v12, v24 row_ror:12 row_mask:0xf bank_mask:0x1
  v_mov_b32_dpp v13, v24 quad_perm:[0,1,2,3] row_mask:0xf bank_mask:0x2
  v_mfma_f32_16x16x32_bf16 v[20:23], a[220:223], v[8:11], v[20:23]
  v_mov_b32_dpp v14, v24 row_ror:4 row_mask:0xf bank_mask:0x4
  v_mov_b32_dpp v15, v24 row_ror:8 row_mask:0xf bank_mask:0x8
  s_nop 1
  v_mfma_f32_16x16x32_bf16 v[16:19], a[224:227], v[12:15], v[16:19]
  v_mov_b32_dpp v8, v24 row_ror:8 row_mask:0xf bank_mask:0x1
  v_mov_b32_dpp v9, v24 row_ror:12 row_mask:0xf bank_mask:0x2
  v_and_b32_dpp v25, v40, v4 quad_perm:[2,2,3,3] row_mask:0xf bank_mask:0xf
  ds_read_b128 v[46:49], v5 offset:0
  v_mfma_f32_16x16x32_bf16 v[20:23], a[228:231], v[12:15], v[20:23]
  v_mov_b32_dpp v10, v24 quad_perm:[0,1,2,3] row_mask:0xf bank_mask:0x4
  v_mov_b32_dpp v11, v24 row_ror:4 row_mask:0xf bank_mask:0x8
  ds_read_b128 v[50:53], v5 offset:1024
  s_nop 0
  v_mfma_f32_16x16x32_bf16 v[16:19], a[232:235], v[8:11], v[16:19]
  v_mov_b32_dpp v12, v24 row_ror:4 row_mask:0xf bank_mask:0x1
  v_mov_b32_dpp v13, v24 row_ror:8 row_mask:0xf bank_mask:0x2
  ds_read_b128 v[54:57], v5 offset:2048
  v_mfma_f32_16x16x32_bf16 v[20:23], a[236:239], v[8:11], v[20:23]
  v_mov_b32_dpp v14, v24 row_ror:12 row_mask:0xf bank_mask:0x4
  v_mov_b32_dpp v15, v24 quad_perm:[0,1,2,3] row_mask:0xf bank_mask:0x8
  s_nop 1
  v_mfma_f32_16x16x32_bf16 v[16:19], a[248:251], v[12:15], v[16:19]
  v_mov_b32_dpp v8, v25 quad_perm:[0,1,2,3] row_mask:0xf bank_mask:0x1
  v_mov_b32_dpp v9, v25 row_ror:4 row_mask:0xf bank_mask:0x2
  v_mfma_f32_16x16x32_bf16 v[20:23], a[252:255], v[12:15], v[20:23]
  v_mov_b32_dpp v10, v25 row_ror:8 row_mask:0xf bank_mask:0x4
  v_mov_b32_dpp v11, v25 row_ror:12 row_mask:0xf bank_mask:0x8
  s_waitcnt vmcnt(10)
  s_add_u32 m0, s52, 0x9000
  s_add_u32 s26, s20, 0xa8c00
  buffer_load_dwordx4 v2, s[12:15], s26 offen nt lds
  s_add_u32 m0, s52, 0x9400
  s_add_u32 s27, s20, 0xa8c80
  buffer_load_dwordx4 v2, s[12:15], s27 offen nt lds
  v_mfma_f32_16x16x32_bf16 v[16:19], v[200:203], v[8:11], v[16:19]
  v_mov_b32_dpp v12, v25 row_ror:12 row_mask:0xf bank_mask:0x1
  v_mov_b32_dpp v13, v25 quad_perm:[0,1,2,3] row_mask:0xf bank_mask:0x2
  v_mfma_f32_16x16x32_bf16 v[20:23], v[204:207], v[8:11], v[20:23]
  v_mov_b32_dpp v14, v25 row_ror:4 row_mask:0xf bank_mask:0x4
  v_mov_b32_dpp v15, v25 row_ror:8 row_mask:0xf bank_mask:0x8
  s_waitcnt lgkmcnt(2)
  s_nop 0
  v_mfma_f32_16x16x32_bf16 v[16:19], v[46:49], v[12:15], v[16:19]
  v_mov_b32_dpp v8, v25 row_ror:8 row_mask:0xf bank_mask:0x1
  v_mov_b32_dpp v9, v25 row_ror:12 row_mask:0xf bank_mask:0x2
  ds_read_b128 v[58:61], v5 offset:3072
  s_waitcnt lgkmcnt(2)
  v_mfma_f32_16x16x32_bf16 v[20:23], v[50:53], v[12:15], v[20:23]
  v_mov_b32_dpp v10, v25 quad_perm:[0,1,2,3] row_mask:0xf bank_mask:0x4
  v_mov_b32_dpp v11, v25 row_ror:4 row_mask:0xf bank_mask:0x8
  ds_read_b128 v[46:49], v5 offset:4096
  s_waitcnt lgkmcnt(2)
  v_mfma_f32_16x16x32_bf16 v[16:19], v[54:57], v[8:11], v[16:19]
  v_mov_b32_dpp v12, v25 row_ror:4 row_mask:0xf bank_mask:0x1
  v_mov_b32_dpp v13, v25 row_ror:8 row_mask:0xf bank_mask:0x2
  ds_read_b128 v[50:53], v5 offset:5120
  s_waitcnt lgkmcnt(2)
  v_mfma_f32_16x16x32_bf16 v[20:23], v[58:61], v[8:11], v[20:23]
  v_mov_b32_dpp v14, v25 row_ror:12 row_mask:0xf bank_mask:0x4
  v_mov_b32_dpp v15, v25 quad_perm:[0,1,2,3] row_mask:0xf bank_mask:0x8
  s_waitcnt lgkmcnt(1)
  s_nop 0
  v_mfma_f32_16x16x32_bf16 v[16:19], v[46:49], v[12:15], v[16:19]
  s_waitcnt lgkmcnt(0)
  v_mfma_f32_16x16x32_bf16 v[20:23], v[50:53], v[12:15], v[20:23]
  s_waitcnt vmcnt(10)
  s_add_u32 s24, s20, 0xe0000
  buffer_load_dwordx4 v[64:67], v2, s[12:15], s24 offen nt
  buffer_load_dwordx4 v[68:71], v2, s[12:15], s24 offen offset:128 nt
  s_nop 1
  v_permlane32_swap_b32 v16, v17
  v_permlane32_swap_b32 v18, v19
  s_nop 0
  v_add_f32_dpp v8, v17, v16 quad_perm:[2,3,2,3] row_mask:0xf bank_mask:0xf
  v_add_f32_dpp v9, v18, v19 quad_perm:[0,1,0,1] row_mask:0xf bank_mask:0xf
  v_cndmask_b32_e64 v10, v8, v9, s[40:41]
  v_permlane32_swap_b32 v20, v21
  v_permlane32_swap_b32 v22, v23
  s_nop 0
  v_add_f32_dpp v11, v21, v20 quad_perm:[2,3,2,3] row_mask:0xf bank_mask:0xf
  v_add_f32_dpp v12, v22, v23 quad_perm:[0,1,0,1] row_mask:0xf bank_mask:0xf
  v_cndmask_b32_e64 v13, v11, v12, s[40:41]
  s_lshl_b32 s48, s17, 9
  s_add_u32 m0, s48, 0
  s_nop 0
  ds_write_addtid_b32 v10 offset:0
  ds_write_addtid_b32 v13 offset:256
  v_mov_b32 v8, s43
  v_mov_b32 v9, s45
  s_lshl_b32 s48, s17, 3
  s_add_u32 s48, s48, 2048
  v_mov_b32 v11, s48
  ds_write_b64 v11, v[8:9]
  s_waitcnt lgkmcnt(0)
  s_barrier
  v_mov_b32 v11, 2048
  ds_read_b128 v[16:19], v11
  ds_read_b128 v[20:23], v11 offset:16
  s_and_b32 s48, s17, 1
  s_lshl_b32 s48, s48, 8
  s_add_u32 m0, s48, 0
  s_nop 0
  ds_read_addtid_b32 v12 offset:0
  ds_read_addtid_b32 v13 offset:512
  ds_read_addtid_b32 v14 offset:1024
  ds_read_addtid_b32 v15 offset:1536
  s_waitcnt lgkmcnt(4)
  v_max3_f32 v8, v16, v18, v20
  v_max_f32 v8, v8, v22
  v_sub_f32 v16, v16, v8
  v_mul_f32 v16, s28, v16
  v_sub_f32 v18, v18, v8
  v_mul_f32 v18, s28, v18
  v_sub_f32 v20, v20, v8
  v_mul_f32 v20, s28, v20
  v_sub_f32 v22, v22, v8
  v_mul_f32 v22, s28, v22
  v_exp_f32 v16, v16
  v_exp_f32 v18, v18
  v_exp_f32 v20, v20
  v_exp_f32 v22, v22
  v_mul_f32 v9, v16, v17
  v_fmac_f32 v9, v18, v19
  v_fmac_f32 v9, v20, v21
  v_fmac_f32 v9, v22, v23
  v_mul_f32 v8, s28, v8
  s_waitcnt lgkmcnt(0)
  v_mul_f32 v10, v16, v12
  v_fmac_f32 v10, v18, v13
  v_fmac_f32 v10, v20, v14
  v_fmac_f32 v10, v22, v15
  v_cndmask_b32_e64 v8, v8, v9, s[62:63]
  s_cmp_lt_u32 s17, 2
  s_cselect_b64 vcc, -1, 0
  v_cndmask_b32 v10, v8, v10, vcc
  v_mov_b32 v11, s16
  s_add_u32 s48, s47, 0x180000
  buffer_store_dwordx2 v[10:11], v6, s[4:7], s48 offen sc1
  s_barrier
  v_and_b32_dpp v24, v41, v4 quad_perm:[0,0,1,1] row_mask:0xf bank_mask:0xf
  v_mov_b32 v8, 0
  v_mov_b32 v9, 0
  v_mov_b32 v10, 0
  v_mov_b32 v11, 0
  v_mov_b32 v12, 0
  v_mov_b32 v13, 0
  v_mov_b32 v14, 0
  v_mov_b32 v15, 0
  v_mov_b32_dpp v8, v24 quad_perm:[0,1,2,3] row_mask:0xf bank_mask:0x1
  v_mov_b32_dpp v9, v24 row_ror:4 row_mask:0xf bank_mask:0x2
  v_mov_b32_dpp v10, v24 row_ror:8 row_mask:0xf bank_mask:0x4
  v_mov_b32_dpp v11, v24 row_ror:12 row_mask:0xf bank_mask:0x8
  ds_read_b128 v[54:57], v5 offset:6144
  ds_read_b128 v[58:61], v5 offset:7168
  ds_read_b128 v[46:49], v5 offset:8192
  s_waitcnt lgkmcnt(2)
  v_mfma_f32_16x16x32_bf16 v[16:19], v[54:57], v[8:11], 0
  v_mov_b32_dpp v12, v24 row_ror:12 row_mask:0xf bank_mask:0x1
  v_mov_b32_dpp v13, v24 quad_perm:[0,1,2,3] row_mask:0xf bank_mask:0x2
  ds_read_b128 v[50:53], v5 offset:9216
  s_waitcnt lgkmcnt(2)
  v_mfma_f32_16x16x32_bf16 v[20:23], v[58:61], v[8:11], 0
  v_mov_b32_dpp v14, v24 row_ror:4 row_mask:0xf bank_mask:0x4
  v_mov_b32_dpp v15, v24 row_ror:8 row_mask:0xf bank_mask:0x8
  ds_read_b128 v[54:57], v5 offset:10240
  s_waitcnt lgkmcnt(2)
  v_mfma_f32_16x16x32_bf16 v[16:19], v[46:49], v[12:15], v[16:19]
  v_mov_b32_dpp v8, v24 row_ror:8 row_mask:0xf bank_mask:0x1
  v_mov_b32_dpp v9, v24 row_ror:12 row_mask:0xf bank_mask:0x2
  v_and_b32_dpp v25, v41, v4 quad_perm:[2,2,3,3] row_mask:0xf bank_mask:0xf
  ds_read_b128 v[58:61], v5 offset:11264
  s_waitcnt lgkmcnt(2)
  v_mfma_f32_16x16x32_bf16 v[20:23], v[50:53], v[12:15], v[20:23]
  v_mov_b32_dpp v10, v24 quad_perm:[0,1,2,3] row_mask:0xf bank_mask:0x4
  v_mov_b32_dpp v11, v24 row_ror:4 row_mask:0xf bank_mask:0x8
  ds_read_b128 v[46:49], v5 offset:12288
  s_waitcnt lgkmcnt(2)
  v_mfma_f32_16x16x32_bf16 v[16:19], v[54:57], v[8:11], v[16:19]
  v_mov_b32_dpp v12, v24 row_ror:4 row_mask:0xf bank_mask:0x1
  v_mov_b32_dpp v13, v24 row_ror:8 row_mask:0xf bank_mask:0x2
  ds_read_b128 v[50:53], v5 offset:13312
  s_waitcnt lgkmcnt(2)
  v_mfma_f32_16x16x32_bf16 v[20:23], v[58:61], v[8:11], v[20:23]
  v_mov_b32_dpp v14, v24 row_ror:12 row_mask:0xf bank_mask:0x4
  v_mov_b32_dpp v15, v24 quad_perm:[0,1,2,3] row_mask:0xf bank_mask:0x8
  ds_read_b128 v[54:57], v5 offset:14336
  s_waitcnt lgkmcnt(2)
  v_mfma_f32_16x16x32_bf16 v[16:19], v[46:49], v[12:15], v[16:19]
  v_mov_b32_dpp v8, v25 quad_perm:[0,1,2,3] row_mask:0xf bank_mask:0x1
  v_mov_b32_dpp v9, v25 row_ror:4 row_mask:0xf bank_mask:0x2
  ds_read_b128 v[58:61], v5 offset:15360
  s_waitcnt lgkmcnt(2)
  v_mfma_f32_16x16x32_bf16 v[20:23], v[50:53], v[12:15], v[20:23]
  v_mov_b32_dpp v10, v25 row_ror:8 row_mask:0xf bank_mask:0x4
  v_mov_b32_dpp v11, v25 row_ror:12 row_mask:0xf bank_mask:0x8
  ds_read_b128 v[46:49], v5 offset:16384
  s_waitcnt lgkmcnt(2)
  v_mfma_f32_16x16x32_bf16 v[16:19], v[54:57], v[8:11], v[16:19]
  v_mov_b32_dpp v12, v25 row_ror:12 row_mask:0xf bank_mask:0x1
  v_mov_b32_dpp v13, v25 quad_perm:[0,1,2,3] row_mask:0xf bank_mask:0x2
  ds_read_b128 v[50:53], v5 offset:17408
  s_waitcnt lgkmcnt(2)
  v_mfma_f32_16x16x32_bf16 v[20:23], v[58:61], v[8:11], v[20:23]
  v_mov_b32_dpp v14, v25 row_ror:4 row_mask:0xf bank_mask:0x4
  v_mov_b32_dpp v15, v25 row_ror:8 row_mask:0xf bank_mask:0x8
  ds_read_b128 v[54:57], v5 offset:18432
  s_waitcnt lgkmcnt(2)
  v_mfma_f32_16x16x32_bf16 v[16:19], v[46:49], v[12:15], v[16:19]
  v_mov_b32_dpp v8, v25 row_ror:8 row_mask:0xf bank_mask:0x1
  v_mov_b32_dpp v9, v25 row_ror:12 row_mask:0xf bank_mask:0x2
  v_and_b32_dpp v24, v42, v4 quad_perm:[0,0,1,1] row_mask:0xf bank_mask:0xf
  ds_read_b128 v[58:61], v5 offset:19456
  s_waitcnt lgkmcnt(2)
  v_mfma_f32_16x16x32_bf16 v[20:23], v[50:53], v[12:15], v[20:23]
  v_mov_b32_dpp v10, v25 quad_perm:[0,1,2,3] row_mask:0xf bank_mask:0x4
  v_mov_b32_dpp v11, v25 row_ror:4 row_mask:0xf bank_mask:0x8
  ds_read_b128 v[46:49], v5 offset:20480
  s_waitcnt lgkmcnt(2)
  v_mfma_f32_16x16x32_bf16 v[16:19], v[54:57], v[8:11], v[16:19]
  v_mov_b32_dpp v12, v25 row_ror:4 row_mask:0xf bank_mask:0x1
  v_mov_b32_dpp v13, v25 row_ror:8 row_mask:0xf bank_mask:0x2
  ds_read_b128 v[50:53], v5 offset:21504
  s_waitcnt lgkmcnt(2)
  v_mfma_f32_16x16x32_bf16 v[20:23], v[58:61], v[8:11], v[20:23]
  v_mov_b32_dpp v14, v25 row_ror:12 row_mask:0xf bank_mask:0x4
  v_mov_b32_dpp v15, v25 quad_perm:[0,1,2,3] row_mask:0xf bank_mask:0x8
  ds_read_b128 v[54:57], v5 offset:22528
  s_waitcnt lgkmcnt(2)
  v_mfma_f32_16x16x32_bf16 v[16:19], v[46:49], v[12:15], v[16:19]
  v_mov_b32_dpp v8, v24 quad_perm:[0,1,2,3] row_mask:0xf bank_mask:0x1
  v_mov_b32_dpp v9, v24 row_ror:4 row_mask:0xf bank_mask:0x2
  ds_read_b128 v[58:61], v5 offset:23552
  s_waitcnt lgkmcnt(2)
  v_mfma_f32_16x16x32_bf16 v[20:23], v[50:53], v[12:15], v[20:23]
  v_mov_b32_dpp v10, v24 row_ror:8 row_mask:0xf bank_mask:0x4
  v_mov_b32_dpp v11, v24 row_ror:12 row_mask:0xf bank_mask:0x8
  ds_read_b128 v[46:49], v5 offset:24576
  s_waitcnt lgkmcnt(2)
  v_mfma_f32_16x16x32_bf16 v[16:19], v[54:57], v[8:11], v[16:19]
  v_mov_b32_dpp v12, v24 row_ror:12 row_mask:0xf bank_mask:0x1
  v_mov_b32_dpp v13, v24 quad_perm:[0,1,2,3] row_mask:0xf bank_mask:0x2
  ds_read_b128 v[50:53], v5 offset:25600
  s_waitcnt lgkmcnt(2)
  v_mfma_f32_16x16x32_bf16 v[20:23], v[58:61], v[8:11], v[20:23]
  v_mov_b32_dpp v14, v24 row_ror:4 row_mask:0xf bank_mask:0x4
  v_mov_b32_dpp v15, v24 row_ror:8 row_mask:0xf bank_mask:0x8
  ds_read_b128 v[54:57], v5 offset:26624
  s_waitcnt lgkmcnt(2)
  v_mfma_f32_16x16x32_bf16 v[16:19], v[46:49], v[12:15], v[16:19]
  v_mov_b32_dpp v8, v24 row_ror:8 row_mask:0xf bank_mask:0x1
  v_mov_b32_dpp v9, v24 row_ror:12 row_mask:0xf bank_mask:0x2
  v_and_b32_dpp v25, v42, v4 quad_perm:[2,2,3,3] row_mask:0xf bank_mask:0xf
  ds_read_b128 v[58:61], v5 offset:27648
  s_waitcnt lgkmcnt(2)
  v_mfma_f32_16x16x32_bf16 v[20:23], v[50:53], v[12:15], v[20:23]
  v_mov_b32_dpp v10, v24 quad_perm:[0,1,2,3] row_mask:0xf bank_mask:0x4
  v_mov_b32_dpp v11, v24 row_ror:4 row_mask:0xf bank_mask:0x8
  s_waitcnt vmcnt(12)
  ds_read_b128 v[46:49], v5 offset:28672
  s_waitcnt lgkmcnt(2)
  v_mfma_f32_16x16x32_bf16 v[16:19], v[54:57], v[8:11], v[16:19]
  v_mov_b32_dpp v12, v24 row_ror:4 row_mask:0xf bank_mask:0x1
  v_mov_b32_dpp v13, v24 row_ror:8 row_mask:0xf bank_mask:0x2
  s_waitcnt vmcnt(11)
  ds_read_b128 v[50:53], v5 offset:29696
  s_waitcnt lgkmcnt(2)
  v_mfma_f32_16x16x32_bf16 v[20:23], v[58:61], v[8:11], v[20:23]
  v_mov_b32_dpp v14, v24 row_ror:12 row_mask:0xf bank_mask:0x4
  v_mov_b32_dpp v15, v24 quad_perm:[0,1,2,3] row_mask:0xf bank_mask:0x8
  s_waitcnt vmcnt(10)
  ds_read_b128 v[54:57], v5 offset:30720
  s_waitcnt lgkmcnt(2)
  v_mfma_f32_16x16x32_bf16 v[16:19], v[46:49], v[12:15], v[16:19]
  v_mov_b32_dpp v8, v25 quad_perm:[0,1,2,3] row_mask:0xf bank_mask:0x1
  v_mov_b32_dpp v9, v25 row_ror:4 row_mask:0xf bank_mask:0x2
  s_waitcnt vmcnt(9)
  ds_read_b128 v[58:61], v5 offset:31744
  s_waitcnt lgkmcnt(2)
  v_mfma_f32_16x16x32_bf16 v[20:23], v[50:53], v[12:15], v[20:23]
  v_mov_b32_dpp v10, v25 row_ror:8 row_mask:0xf bank_mask:0x4
  v_mov_b32_dpp v11, v25 row_ror:12 row_mask:0xf bank_mask:0x8
  s_waitcnt vmcnt(8)
  ds_read_b128 v[46:49], v5 offset:32768
  s_waitcnt lgkmcnt(2)
  v_mfma_f32_16x16x32_bf16 v[16:19], v[54:57], v[8:11], v[16:19]
  v_mov_b32_dpp v12, v25 row_ror:12 row_mask:0xf bank_mask:0x1
  v_mov_b32_dpp v13, v25 quad_perm:[0,1,2,3] row_mask:0xf bank_mask:0x2
  s_waitcnt vmcnt(7)
  ds_read_b128 v[50:53], v5 offset:33792
  s_waitcnt lgkmcnt(2)
  v_mfma_f32_16x16x32_bf16 v[20:23], v[58:61], v[8:11], v[20:23]
  buffer_load_dwordx4 v[72:75], v2, s[12:15], s24 offen offset:1024 nt
  v_mov_b32_dpp v14, v25 row_ror:4 row_mask:0xf bank_mask:0x4
  v_mov_b32_dpp v15, v25 row_ror:8 row_mask:0xf bank_mask:0x8
  s_waitcnt vmcnt(7)
  ds_read_b128 v[54:57], v5 offset:34816
  s_waitcnt lgkmcnt(2)
  v_mfma_f32_16x16x32_bf16 v[16:19], v[46:49], v[12:15], v[16:19]
  buffer_load_dwordx4 v[76:79], v2, s[12:15], s24 offen offset:1152 nt
  v_mov_b32_dpp v8, v25 row_ror:8 row_mask:0xf bank_mask:0x1
  v_mov_b32_dpp v9, v25 row_ror:12 row_mask:0xf bank_mask:0x2
  v_and_b32_dpp v24, v43, v4 quad_perm:[0,0,1,1] row_mask:0xf bank_mask:0xf
  s_waitcnt vmcnt(7)
  ds_read_b128 v[58:61], v5 offset:35840
  s_waitcnt lgkmcnt(2)
  v_mfma_f32_16x16x32_bf16 v[20:23], v[50:53], v[12:15], v[20:23]
  buffer_load_dwordx4 v[80:83], v2, s[12:15], s24 offen offset:2048 nt
  v_mov_b32_dpp v10, v25 quad_perm:[0,1,2,3] row_mask:0xf bank_mask:0x4
  v_mov_b32_dpp v11, v25 row_ror:4 row_mask:0xf bank_mask:0x8
  s_waitcnt vmcnt(7)
  ds_read_b128 v[46:49], v5 offset:36864
  s_waitcnt lgkmcnt(2)
  v_mfma_f32_16x16x32_bf16 v[16:19], v[54:57], v[8:11], v[16:19]
  buffer_load_dwordx4 v[84:87], v2, s[12:15], s24 offen offset:2176 nt
  v_mov_b32_dpp v12, v25 row_ror:4 row_mask:0xf bank_mask:0x1
  v_mov_b32_dpp v13, v25 row_ror:8 row_mask:0xf bank_mask:0x2
  s_waitcnt vmcnt(7)
  ds_read_b128 v[50:53], v5 offset:37888
  s_waitcnt lgkmcnt(2)
  v_mfma_f32_16x16x32_bf16 v[20:23], v[58:61], v[8:11], v[20:23]
  buffer_load_dwordx4 v[88:91], v2, s[12:15], s24 offen offset:3072 nt
  v_mov_b32_dpp v14, v25 row_ror:12 row_mask:0xf bank_mask:0x4
  v_mov_b32_dpp v15, v25 quad_perm:[0,1,2,3] row_mask:0xf bank_mask:0x8
  s_waitcnt lgkmcnt(1)
  s_nop 0
  v_mfma_f32_16x16x32_bf16 v[16:19], v[46:49], v[12:15], v[16:19]
  v_mov_b32_dpp v8, v24 quad_perm:[0,1,2,3] row_mask:0xf bank_mask:0x1
  v_mov_b32_dpp v9, v24 row_ror:4 row_mask:0xf bank_mask:0x2
  s_waitcnt lgkmcnt(0)
  v_mfma_f32_16x16x32_bf16 v[20:23], v[50:53], v[12:15], v[20:23]
  v_mov_b32_dpp v10, v24 row_ror:8 row_mask:0xf bank_mask:0x4
  v_mov_b32_dpp v11, v24 row_ror:12 row_mask:0xf bank_mask:0x8
  s_waitcnt vmcnt(7)
  s_nop 0
  v_mfma_f32_16x16x32_bf16 v[16:19], v[64:67], v[8:11], v[16:19]
  buffer_load_dwordx4 v[92:95], v2, s[12:15], s24 offen offset:3200 nt
  v_mov_b32_dpp v12, v24 row_ror:12 row_mask:0xf bank_mask:0x1
  v_mov_b32_dpp v13, v24 quad_perm:[0,1,2,3] row_mask:0xf bank_mask:0x2
  s_waitcnt vmcnt(7)
  v_mfma_f32_16x16x32_bf16 v[20:23], v[68:71], v[8:11], v[20:23]
  s_add_u32 s25, s20, 0x118000
  buffer_load_dwordx4 v[96:99], v2, s[12:15], s25 offen nt
  v_mov_b32_dpp v14, v24 row_ror:4 row_mask:0xf bank_mask:0x4
  v_mov_b32_dpp v15, v24 row_ror:8 row_mask:0xf bank_mask:0x8
  s_waitcnt vmcnt(6)
  s_nop 0
  v_mfma_f32_16x16x32_bf16 v[16:19], v[72:75], v[12:15], v[16:19]
  buffer_load_dwordx4 v[100:103], v2, s[12:15], s25 offen offset:128 nt
  buffer_load_dwordx4 v[104:107], v2, s[12:15], s25 offen offset:1024 nt
  v_mov_b32_dpp v8, v24 row_ror:8 row_mask:0xf bank_mask:0x1
  v_mov_b32_dpp v9, v24 row_ror:12 row_mask:0xf bank_mask:0x2
  v_and_b32_dpp v25, v43, v4 quad_perm:[2,2,3,3] row_mask:0xf bank_mask:0xf
  s_waitcnt vmcnt(7)
  v_mfma_f32_16x16x32_bf16 v[20:23], v[76:79], v[12:15], v[20:23]
  buffer_load_dwordx4 v[108:111], v2, s[12:15], s25 offen offset:1152 nt
  v_mov_b32_dpp v10, v24 quad_perm:[0,1,2,3] row_mask:0xf bank_mask:0x4
  v_mov_b32_dpp v11, v24 row_ror:4 row_mask:0xf bank_mask:0x8
  s_waitcnt vmcnt(7)
  s_nop 0
  v_mfma_f32_16x16x32_bf16 v[16:19], v[80:83], v[8:11], v[16:19]
  buffer_load_dwordx4 v[112:115], v2, s[12:15], s25 offen offset:2048 nt
  v_mov_b32_dpp v12, v24 row_ror:4 row_mask:0xf bank_mask:0x1
  v_mov_b32_dpp v13, v24 row_ror:8 row_mask:0xf bank_mask:0x2
  s_waitcnt vmcnt(7)
  v_mfma_f32_16x16x32_bf16 v[20:23], v[84:87], v[8:11], v[20:23]
  buffer_load_dwordx4 v[116:119], v2, s[12:15], s25 offen offset:2176 nt
  v_mov_b32_dpp v14, v24 row_ror:12 row_mask:0xf bank_mask:0x4
  v_mov_b32_dpp v15, v24 quad_perm:[0,1,2,3] row_mask:0xf bank_mask:0x8
  s_waitcnt vmcnt(7)
  s_nop 0
  v_mfma_f32_16x16x32_bf16 v[16:19], v[88:91], v[12:15], v[16:19]
  buffer_load_dwordx4 v[120:123], v2, s[12:15], s25 offen offset:3072 nt
  v_mov_b32_dpp v8, v25 quad_perm:[0,1,2,3] row_mask:0xf bank_mask:0x1
  v_mov_b32_dpp v9, v25 row_ror:4 row_mask:0xf bank_mask:0x2
  s_waitcnt vmcnt(7)
  v_mfma_f32_16x16x32_bf16 v[20:23], v[92:95], v[12:15], v[20:23]
  buffer_load_dwordx4 v[124:127], v2, s[12:15], s25 offen offset:3200 nt
  v_mov_b32_dpp v10, v25 row_ror:8 row_mask:0xf bank_mask:0x4
  v_mov_b32_dpp v11, v25 row_ror:12 row_mask:0xf bank_mask:0x8
  s_waitcnt vmcnt(7)
  s_nop 0
  v_mfma_f32_16x16x32_bf16 v[16:19], v[96:99], v[8:11], v[16:19]
  s_add_u32 s26, s20, 0x150000
  buffer_load_dwordx4 v[128:131], v2, s[12:15], s26 offen nt
  v_mov_b32_dpp v12, v25 row_ror:12 row_mask:0xf bank_mask:0x1
  v_mov_b32_dpp v13, v25 quad_perm:[0,1,2,3] row_mask:0xf bank_mask:0x2
  s_waitcnt vmcnt(7)
  v_mfma_f32_16x16x32_bf16 v[20:23], v[100:103], v[8:11], v[20:23]
  buffer_load_dwordx4 v[132:135], v2, s[12:15], s26 offen offset:128 nt
  v_mov_b32_dpp v14, v25 row_ror:4 row_mask:0xf bank_mask:0x4
  v_mov_b32_dpp v15, v25 row_ror:8 row_mask:0xf bank_mask:0x8
  s_waitcnt vmcnt(7)
  s_nop 0
  v_mfma_f32_16x16x32_bf16 v[16:19], v[104:107], v[12:15], v[16:19]
  buffer_load_dwordx4 v[136:139], v2, s[12:15], s26 offen offset:1024 nt
  v_mov_b32_dpp v8, v25 row_ror:8 row_mask:0xf bank_mask:0x1
  v_mov_b32_dpp v9, v25 row_ror:12 row_mask:0xf bank_mask:0x2
  v_and_b32_dpp v24, v44, v4 quad_perm:[0,0,1,1] row_mask:0xf bank_mask:0xf
  s_waitcnt vmcnt(7)
  v_mfma_f32_16x16x32_bf16 v[20:23], v[108:111], v[12:15], v[20:23]
  buffer_load_dwordx4 v[140:143], v2, s[12:15], s26 offen offset:1152 nt
  v_mov_b32_dpp v10, v25 quad_perm:[0,1,2,3] row_mask:0xf bank_mask:0x4
  v_mov_b32_dpp v11, v25 row_ror:4 row_mask:0xf bank_mask:0x8
  s_waitcnt vmcnt(7)
  s_nop 0
  v_mfma_f32_16x16x32_bf16 v[16:19], v[112:115], v[8:11], v[16:19]
  buffer_load_dwordx4 v[144:147], v2, s[12:15], s26 offen offset:2048 nt
  v_mov_b32_dpp v12, v25 row_ror:4 row_mask:0xf bank_mask:0x1
  v_mov_b32_dpp v13, v25 row_ror:8 row_mask:0xf bank_mask:0x2
  s_waitcnt vmcnt(7)
  v_mfma_f32_16x16x32_bf16 v[20:23], v[116:119], v[8:11], v[20:23]
  buffer_load_dwordx4 v[148:151], v2, s[12:15], s26 offen offset:2176 nt
  v_mov_b32_dpp v14, v25 row_ror:12 row_mask:0xf bank_mask:0x4
  v_mov_b32_dpp v15, v25 quad_perm:[0,1,2,3] row_mask:0xf bank_mask:0x8
  s_waitcnt vmcnt(7)
  s_nop 0
  v_mfma_f32_16x16x32_bf16 v[16:19], v[120:123], v[12:15], v[16:19]
  buffer_load_dwordx4 v[152:155], v2, s[12:15], s26 offen offset:3072 nt
  v_mov_b32_dpp v8, v24 quad_perm:[0,1,2,3] row_mask:0xf bank_mask:0x1
  v_mov_b32_dpp v9, v24 row_ror:4 row_mask:0xf bank_mask:0x2
  s_waitcnt vmcnt(7)
  v_mfma_f32_16x16x32_bf16 v[20:23], v[124:127], v[12:15], v[20:23]
  buffer_load_dwordx4 v[156:159], v2, s[12:15], s26 offen offset:3200 nt
  v_mov_b32_dpp v10, v24 row_ror:8 row_mask:0xf bank_mask:0x4
  v_mov_b32_dpp v11, v24 row_ror:12 row_mask:0xf bank_mask:0x8
  s_waitcnt vmcnt(7)
  s_nop 0
  v_mfma_f32_16x16x32_bf16 v[16:19], v[128:131], v[8:11], v[16:19]
  s_add_u32 s27, s20, 0x188000
  buffer_load_dwordx4 v[160:163], v2, s[12:15], s27 offen nt
  v_mov_b32_dpp v12, v24 row_ror:12 row_mask:0xf bank_mask:0x1
  v_mov_b32_dpp v13, v24 quad_perm:[0,1,2,3] row_mask:0xf bank_mask:0x2
  s_waitcnt vmcnt(7)
  v_mfma_f32_16x16x32_bf16 v[20:23], v[132:135], v[8:11], v[20:23]
  buffer_load_dwordx4 v[164:167], v2, s[12:15], s27 offen offset:128 nt
  v_mov_b32_dpp v14, v24 row_ror:4 row_mask:0xf bank_mask:0x4
  v_mov_b32_dpp v15, v24 row_ror:8 row_mask:0xf bank_mask:0x8
  s_waitcnt vmcnt(7)
  s_nop 0
  v_mfma_f32_16x16x32_bf16 v[16:19], v[136:139], v[12:15], v[16:19]
  buffer_load_dwordx4 v[168:171], v2, s[12:15], s27 offen offset:1024 nt
  v_mov_b32_dpp v8, v24 row_ror:8 row_mask:0xf bank_mask:0x1
  v_mov_b32_dpp v9, v24 row_ror:12 row_mask:0xf bank_mask:0x2
  v_and_b32_dpp v25, v44, v4 quad_perm:[2,2,3,3] row_mask:0xf bank_mask:0xf
  s_waitcnt vmcnt(7)
  v_mfma_f32_16x16x32_bf16 v[20:23], v[140:143], v[12:15], v[20:23]
  buffer_load_dwordx4 v[172:175], v2, s[12:15], s27 offen offset:1152 nt
  v_mov_b32_dpp v10, v24 quad_perm:[0,1,2,3] row_mask:0xf bank_mask:0x4
  v_mov_b32_dpp v11, v24 row_ror:4 row_mask:0xf bank_mask:0x8
  s_waitcnt vmcnt(7)
  s_nop 0
  v_mfma_f32_16x16x32_bf16 v[16:19], v[144:147], v[8:11], v[16:19]
  buffer_load_dwordx4 v[176:179], v2, s[12:15], s27 offen offset:2048 nt
  v_mov_b32_dpp v12, v24 row_ror:4 row_mask:0xf bank_mask:0x1
  v_mov_b32_dpp v13, v24 row_ror:8 row_mask:0xf bank_mask:0x2
  s_waitcnt vmcnt(7)
  v_mfma_f32_16x16x32_bf16 v[20:23], v[148:151], v[8:11], v[20:23]
  buffer_load_dwordx4 v[180:183], v2, s[12:15], s27 offen offset:2176 nt
  v_mov_b32_dpp v14, v24 row_ror:12 row_mask:0xf bank_mask:0x4
  v_mov_b32_dpp v15, v24 quad_perm:[0,1,2,3] row_mask:0xf bank_mask:0x8
  s_waitcnt vmcnt(7)
  s_nop 0
  v_mfma_f32_16x16x32_bf16 v[16:19], v[152:155], v[12:15], v[16:19]
  buffer_load_dwordx4 v[184:187], v2, s[12:15], s27 offen offset:3072 nt
  v_mov_b32_dpp v8, v25 quad_perm:[0,1,2,3] row_mask:0xf bank_mask:0x1
  v_mov_b32_dpp v9, v25 row_ror:4 row_mask:0xf bank_mask:0x2
  s_waitcnt vmcnt(7)
  v_mfma_f32_16x16x32_bf16 v[20:23], v[156:159], v[12:15], v[20:23]
  buffer_load_dwordx4 v[188:191], v2, s[12:15], s27 offen offset:3200 nt
  v_mov_b32_dpp v10, v25 row_ror:8 row_mask:0xf bank_mask:0x4
  v_mov_b32_dpp v11, v25 row_ror:12 row_mask:0xf bank_mask:0x8
  s_waitcnt vmcnt(7)
  s_nop 0
  v_mfma_f32_16x16x32_bf16 v[16:19], v[160:163], v[8:11], v[16:19]
  s_add_u32 s24, s20, 0x1c0000
  buffer_load_dwordx4 v[192:195], v2, s[12:15], s24 offen nt
  v_mov_b32_dpp v12, v25 row_ror:12 row_mask:0xf bank_mask:0x1
  v_mov_b32_dpp v13, v25 quad_perm:[0,1,2,3] row_mask:0xf bank_mask:0x2
  s_waitcnt vmcnt(7)
  v_mfma_f32_16x16x32_bf16 v[20:23], v[164:167], v[8:11], v[20:23]
  buffer_load_dwordx4 v[196:199], v2, s[12:15], s24 offen offset:128 nt
  v_mov_b32_dpp v14, v25 row_ror:4 row_mask:0xf bank_mask:0x4
  v_mov_b32_dpp v15, v25 row_ror:8 row_mask:0xf bank_mask:0x8
  s_waitcnt vmcnt(7)
  s_nop 0
  v_mfma_f32_16x16x32_bf16 v[16:19], v[168:171], v[12:15], v[16:19]
  buffer_load_dwordx4 v[208:211], v2, s[12:15], s24 offen offset:1024 nt
  v_mov_b32_dpp v8, v25 row_ror:8 row_mask:0xf bank_mask:0x1
  v_mov_b32_dpp v9, v25 row_ror:12 row_mask:0xf bank_mask:0x2
  v_and_b32_dpp v24, v45, v4 quad_perm:[0,0,1,1] row_mask:0xf bank_mask:0xf
  s_waitcnt vmcnt(7)
  v_mfma_f32_16x16x32_bf16 v[20:23], v[172:175], v[12:15], v[20:23]
  buffer_load_dwordx4 v[212:215], v2, s[12:15], s24 offen offset:1152 nt
  v_mov_b32_dpp v10, v25 quad_perm:[0,1,2,3] row_mask:0xf bank_mask:0x4
  v_mov_b32_dpp v11, v25 row_ror:4 row_mask:0xf bank_mask:0x8
  s_waitcnt vmcnt(7)
  s_nop 0
  v_mfma_f32_16x16x32_bf16 v[16:19], v[176:179], v[8:11], v[16:19]
  buffer_load_dwordx4 a[240:243], v2, s[12:15], s24 offen offset:2048 nt
  v_mov_b32_dpp v12, v25 row_ror:4 row_mask:0xf bank_mask:0x1
  v_mov_b32_dpp v13, v25 row_ror:8 row_mask:0xf bank_mask:0x2
  s_waitcnt vmcnt(7)
  v_mfma_f32_16x16x32_bf16 v[20:23], v[180:183], v[8:11], v[20:23]
  buffer_load_dwordx4 a[244:247], v2, s[12:15], s24 offen offset:2176 nt
  v_mov_b32_dpp v14, v25 row_ror:12 row_mask:0xf bank_mask:0x4
  v_mov_b32_dpp v15, v25 quad_perm:[0,1,2,3] row_mask:0xf bank_mask:0x8
  s_waitcnt vmcnt(7)
  s_nop 0
  v_mfma_f32_16x16x32_bf16 v[16:19], v[184:187], v[12:15], v[16:19]
  buffer_load_dwordx4 v[216:219], v2, s[12:15], s24 offen offset:3072 nt
  v_mov_b32_dpp v8, v24 quad_perm:[0,1,2,3] row_mask:0xf bank_mask:0x1
  v_mov_b32_dpp v9, v24 row_ror:4 row_mask:0xf bank_mask:0x2
  s_waitcnt vmcnt(7)
  v_mfma_f32_16x16x32_bf16 v[20:23], v[188:191], v[12:15], v[20:23]
  buffer_load_dwordx4 v[220:223], v2, s[12:15], s24 offen offset:3200 nt
  v_mov_b32_dpp v10, v24 row_ror:8 row_mask:0xf bank_mask:0x4
  v_mov_b32_dpp v11, v24 row_ror:12 row_mask:0xf bank_mask:0x8
  s_waitcnt vmcnt(7)
  s_nop 0
  v_mfma_f32_16x16x32_bf16 v[16:19], v[192:195], v[8:11], v[16:19]
  buffer_load_dwordx4 v[224:227], v3, s[12:15], s22 offen nt
  v_mov_b32_dpp v12, v24 row_ror:12 row_mask:0xf bank_mask:0x1
  v_mov_b32_dpp v13, v24 quad_perm:[0,1,2,3] row_mask:0xf bank_mask:0x2
  s_waitcnt vmcnt(7)
  v_mfma_f32_16x16x32_bf16 v[20:23], v[196:199], v[8:11], v[20:23]
  buffer_load_dwordx4 v[228:231], v3, s[12:15], s22 offen offset:128 nt
  v_mov_b32_dpp v14, v24 row_ror:4 row_mask:0xf bank_mask:0x4
  v_mov_b32_dpp v15, v24 row_ror:8 row_mask:0xf bank_mask:0x8
  s_waitcnt vmcnt(7)
  s_nop 0
  v_mfma_f32_16x16x32_bf16 v[16:19], v[208:211], v[12:15], v[16:19]
  buffer_load_dwordx4 v[232:235], v3, s[12:15], s22 offen offset:1024 nt
  v_mov_b32_dpp v8, v24 row_ror:8 row_mask:0xf bank_mask:0x1
  v_mov_b32_dpp v9, v24 row_ror:12 row_mask:0xf bank_mask:0x2
  v_and_b32_dpp v25, v45, v4 quad_perm:[2,2,3,3] row_mask:0xf bank_mask:0xf
  s_waitcnt vmcnt(7)
  v_mfma_f32_16x16x32_bf16 v[20:23], v[212:215], v[12:15], v[20:23]
  buffer_load_dwordx4 v[236:239], v3, s[12:15], s22 offen offset:1152 nt
  v_mov_b32_dpp v10, v24 quad_perm:[0,1,2,3] row_mask:0xf bank_mask:0x4
  v_mov_b32_dpp v11, v24 row_ror:4 row_mask:0xf bank_mask:0x8
  s_waitcnt vmcnt(7)
  s_nop 0
  v_mfma_f32_16x16x32_bf16 v[16:19], a[240:243], v[8:11], v[16:19]
  buffer_load_dwordx4 v[240:243], v3, s[12:15], s22 offen offset:2048 nt
  v_mov_b32_dpp v12, v24 row_ror:4 row_mask:0xf bank_mask:0x1
  v_mov_b32_dpp v13, v24 row_ror:8 row_mask:0xf bank_mask:0x2
  s_waitcnt vmcnt(7)
  v_mfma_f32_16x16x32_bf16 v[20:23], a[244:247], v[8:11], v[20:23]
  buffer_load_dwordx4 v[244:247], v3, s[12:15], s22 offen offset:2176 nt
  v_mov_b32_dpp v14, v24 row_ror:12 row_mask:0xf bank_mask:0x4
  v_mov_b32_dpp v15, v24 quad_perm:[0,1,2,3] row_mask:0xf bank_mask:0x8
  s_waitcnt vmcnt(7)
  s_nop 0
  v_mfma_f32_16x16x32_bf16 v[16:19], v[216:219], v[12:15], v[16:19]
  buffer_load_dwordx4 v[248:251], v3, s[12:15], s22 offen offset:3072 nt
  v_mov_b32_dpp v8, v25 quad_perm:[0,1,2,3] row_mask:0xf bank_mask:0x1
  v_mov_b32_dpp v9, v25 row_ror:4 row_mask:0xf bank_mask:0x2
  s_waitcnt vmcnt(7)
  v_mfma_f32_16x16x32_bf16 v[20:23], v[220:223], v[12:15], v[20:23]
  buffer_load_dwordx4 v[252:255], v3, s[12:15], s22 offen offset:3200 nt
  v_mov_b32_dpp v10, v25 row_ror:8 row_mask:0xf bank_mask:0x4
  v_mov_b32_dpp v11, v25 row_ror:12 row_mask:0xf bank_mask:0x8
  s_waitcnt vmcnt(7)
  s_nop 0
  v_mfma_f32_16x16x32_bf16 v[16:19], v[224:227], v[8:11], v[16:19]
  buffer_load_dwordx4 a[0:3], v1, s[8:11], s20 offen nt
  v_mov_b32_dpp v12, v25 row_ror:12 row_mask:0xf bank_mask:0x1
  v_mov_b32_dpp v13, v25 quad_perm:[0,1,2,3] row_mask:0xf bank_mask:0x2
  s_waitcnt vmcnt(7)
  v_mfma_f32_16x16x32_bf16 v[20:23], v[228:231], v[8:11], v[20:23]
  buffer_load_dwordx4 a[4:7], v1, s[8:11], s20 offen offset:1024 nt
  v_mov_b32_dpp v14, v25 row_ror:4 row_mask:0xf bank_mask:0x4
  v_mov_b32_dpp v15, v25 row_ror:8 row_mask:0xf bank_mask:0x8
  s_waitcnt vmcnt(7)
  s_nop 0
  v_mfma_f32_16x16x32_bf16 v[16:19], v[232:235], v[12:15], v[16:19]
  buffer_load_dwordx4 a[8:11], v1, s[8:11], s20 offen offset:2048 nt
  v_mov_b32_dpp v8, v25 row_ror:8 row_mask:0xf bank_mask:0x1
  v_mov_b32_dpp v9, v25 row_ror:12 row_mask:0xf bank_mask:0x2
  s_waitcnt vmcnt(7)
  v_mfma_f32_16x16x32_bf16 v[20:23], v[236:239], v[12:15], v[20:23]
  buffer_load_dwordx4 a[12:15], v1, s[8:11], s20 offen offset:3072 nt
  v_mov_b32_dpp v10, v25 quad_perm:[0,1,2,3] row_mask:0xf bank_mask:0x4
  v_mov_b32_dpp v11, v25 row_ror:4 row_mask:0xf bank_mask:0x8
  s_waitcnt vmcnt(7)
  s_nop 0
  v_mfma_f32_16x16x32_bf16 v[16:19], v[240:243], v[8:11], v[16:19]
  s_add_u32 s25, s20, 0x1c000
  buffer_load_dwordx4 a[16:19], v1, s[8:11], s25 offen nt
  v_mov_b32_dpp v12, v25 row_ror:4 row_mask:0xf bank_mask:0x1
  v_mov_b32_dpp v13, v25 row_ror:8 row_mask:0xf bank_mask:0x2
  s_waitcnt vmcnt(7)
  v_mfma_f32_16x16x32_bf16 v[20:23], v[244:247], v[8:11], v[20:23]
  buffer_load_dwordx4 a[20:23], v1, s[8:11], s25 offen offset:1024 nt
  v_mov_b32_dpp v14, v25 row_ror:12 row_mask:0xf bank_mask:0x4
  v_mov_b32_dpp v15, v25 quad_perm:[0,1,2,3] row_mask:0xf bank_mask:0x8
  s_waitcnt vmcnt(7)
  s_nop 0
  v_mfma_f32_16x16x32_bf16 v[16:19], v[248:251], v[12:15], v[16:19]
  buffer_load_dwordx4 a[24:27], v1, s[8:11], s25 offen offset:2048 nt
  s_waitcnt vmcnt(7)
  v_mfma_f32_16x16x32_bf16 v[20:23], v[252:255], v[12:15], v[20:23]
  buffer_load_dwordx4 a[28:31], v1, s[8:11], s25 offen offset:3072 nt
  s_nop 3
  v_permlane32_swap_b32 v16, v17
  v_permlane32_swap_b32 v18, v19
  s_nop 0
  v_add_f32_dpp v8, v17, v16 quad_perm:[2,3,2,3] row_mask:0xf bank_mask:0xf
  v_add_f32_dpp v9, v18, v19 quad_perm:[0,1,0,1] row_mask:0xf bank_mask:0xf
  v_cndmask_b32_e64 v10, v8, v9, s[40:41]
  v_permlane32_swap_b32 v20, v21
  v_permlane32_swap_b32 v22, v23
  s_nop 0
  v_add_f32_dpp v11, v21, v20 quad_perm:[2,3,2,3] row_mask:0xf bank_mask:0xf
  v_add_f32_dpp v12, v22, v23 quad_perm:[0,1,0,1] row_mask:0xf bank_mask:0xf
  v_cndmask_b32_e64 v13, v11, v12, s[40:41]
  s_lshl_b32 s48, s17, 9
  s_add_u32 m0, s48, 0
  s_nop 0
  ds_write_addtid_b32 v10 offset:0
  ds_write_addtid_b32 v13 offset:256
  v_mov_b32 v8, s42
  v_mov_b32 v9, s44
  s_lshl_b32 s48, s17, 3
  s_add_u32 s48, s48, 2048
  v_mov_b32 v11, s48
  ds_write_b64 v11, v[8:9]
  s_waitcnt lgkmcnt(0)
  s_barrier
  v_mov_b32 v11, 2048
  ds_read_b128 v[16:19], v11
  ds_read_b128 v[20:23], v11 offset:16
  s_and_b32 s48, s17, 1
  s_lshl_b32 s48, s48, 8
  s_add_u32 m0, s48, 0
  s_nop 0
  ds_read_addtid_b32 v12 offset:0
  ds_read_addtid_b32 v13 offset:512
  ds_read_addtid_b32 v14 offset:1024
  ds_read_addtid_b32 v15 offset:1536
  s_waitcnt lgkmcnt(4)
  v_max3_f32 v8, v16, v18, v20
  v_max_f32 v8, v8, v22
  v_sub_f32 v16, v16, v8
  v_mul_f32 v16, s28, v16
  v_sub_f32 v18, v18, v8
  v_mul_f32 v18, s28, v18
  v_sub_f32 v20, v20, v8
  v_mul_f32 v20, s28, v20
  v_sub_f32 v22, v22, v8
  v_mul_f32 v22, s28, v22
  v_exp_f32 v16, v16
  v_exp_f32 v18, v18
  v_exp_f32 v20, v20
  v_exp_f32 v22, v22
  v_mul_f32 v9, v16, v17
  v_fmac_f32 v9, v18, v19
  v_fmac_f32 v9, v20, v21
  v_fmac_f32 v9, v22, v23
  v_mul_f32 v8, s28, v8
  s_waitcnt lgkmcnt(0)
  v_mul_f32 v10, v16, v12
  v_fmac_f32 v10, v18, v13
  v_fmac_f32 v10, v20, v14
  v_fmac_f32 v10, v22, v15
  v_cndmask_b32_e64 v8, v8, v9, s[62:63]
  s_cmp_lt_u32 s17, 2
  s_cselect_b64 vcc, -1, 0
  v_cndmask_b32 v10, v8, v10, vcc
  v_mov_b32 v11, s16
  s_add_u32 s48, s47, 0x0
  buffer_store_dwordx2 v[10:11], v6, s[4:7], s48 offen sc1
  s_barrier
  s_add_u32 s26, s20, 0x38000
  buffer_load_dwordx4 a[32:35], v1, s[8:11], s26 offen nt
  buffer_load_dwordx4 a[36:39], v1, s[8:11], s26 offen offset:1024 nt
  buffer_load_dwordx4 a[40:43], v1, s[8:11], s26 offen offset:2048 nt
  buffer_load_dwordx4 a[44:47], v1, s[8:11], s26 offen offset:3072 nt
  s_add_u32 s27, s20, 0x54000
  buffer_load_dwordx4 a[48:51], v1, s[8:11], s27 offen nt
  buffer_load_dwordx4 a[52:55], v1, s[8:11], s27 offen offset:1024 nt
  buffer_load_dwordx4 a[56:59], v1, s[8:11], s27 offen offset:2048 nt
  s_lshl_b32 s48, s19, 11
  s_sub_u32 s48, s47, s48
  s_add_u32 s48, s48, 0x400
  v_and_b32 v7, 7, v0
  v_min_u32 v7, 6, v7
  v_lshlrev_b32 v7, 11, v7
  s_mov_b32 s29, 0x2000
  s_nop 0
L_grt_8:
  buffer_load_dwordx2 v[28:29], v7, s[4:7], s48 offen sc1
  s_waitcnt vmcnt(0)
  v_cmp_ne_u32 vcc, s16, v29
  s_nop 4
  s_cbranch_vccz L_gok_7
  s_sleep 4
  s_sub_u32 s29, s29, 1
  s_cbranch_scc0 L_grt_8
L_gok_7:
  buffer_load_dwordx4 a[60:63], v1, s[8:11], s27 offen offset:3072 nt
  s_add_u32 s24, s20, 0x70000
  buffer_load_dwordx4 a[64:67], v1, s[8:11], s24 offen nt
  buffer_load_dwordx4 a[68:71], v1, s[8:11], s24 offen offset:1024 nt
  buffer_load_dwordx4 a[72:75], v1, s[8:11], s24 offen offset:2048 nt
  buffer_load_dwordx4 a[76:79], v1, s[8:11], s24 offen offset:3072 nt
  s_add_u32 s25, s20, 0x8c000
  buffer_load_dwordx4 a[80:83], v1, s[8:11], s25 offen nt
  buffer_load_dwordx4 a[84:87], v1, s[8:11], s25 offen offset:1024 nt
  buffer_load_dwordx4 a[88:91], v1, s[8:11], s25 offen offset:2048 nt
  buffer_load_dwordx4 a[92:95], v1, s[8:11], s25 offen offset:3072 nt
  s_add_u32 s26, s20, 0xa8000
  buffer_load_dwordx4 a[96:99], v1, s[8:11], s26 offen nt
  buffer_load_dwordx4 a[100:103], v1, s[8:11], s26 offen offset:1024 nt
  buffer_load_dwordx4 a[104:107], v1, s[8:11], s26 offen offset:2048 nt
  buffer_load_dwordx4 a[108:111], v1, s[8:11], s26 offen offset:3072 nt
  s_add_u32 s27, s20, 0xc4000
  buffer_load_dwordx4 a[112:115], v1, s[8:11], s27 offen nt
  buffer_load_dwordx4 a[116:119], v1, s[8:11], s27 offen offset:1024 nt
  buffer_load_dwordx4 a[120:123], v1, s[8:11], s27 offen offset:2048 nt
  s_waitcnt vmcnt(14)
  buffer_load_dwordx4 a[124:127], v1, s[8:11], s27 offen offset:3072 nt
  s_add_u32 s24, s20, 0xe0000
  buffer_load_dwordx4 a[128:131], v1, s[8:11], s24 offen nt
  s_waitcnt vmcnt(14)
  buffer_load_dwordx4 a[132:135], v1, s[8:11], s24 offen offset:1024 nt
  buffer_load_dwordx4 a[136:139], v1, s[8:11], s24 offen offset:2048 nt
  s_waitcnt vmcnt(14)
  buffer_load_dwordx4 a[140:143], v1, s[8:11], s24 offen offset:3072 nt
  s_add_u32 s25, s20, 0xfc000
  buffer_load_dwordx4 a[144:147], v1, s[8:11], s25 offen nt
  s_waitcnt vmcnt(14)
  buffer_load_dwordx4 a[148:151], v1, s[8:11], s25 offen offset:1024 nt
  buffer_load_dwordx4 a[152:155], v1, s[8:11], s25 offen offset:2048 nt
  s_waitcnt vmcnt(14)
  buffer_load_dwordx4 a[156:159], v1, s[8:11], s25 offen offset:3072 nt
  s_add_u32 s26, s20, 0x118000
  buffer_load_dwordx4 a[160:163], v1, s[8:11], s26 offen nt
  s_waitcnt vmcnt(14)
  buffer_load_dwordx4 a[164:167], v1, s[8:11], s26 offen offset:1024 nt
  buffer_load_dwordx4 a[168:171], v1, s[8:11], s26 offen offset:2048 nt
  s_waitcnt vmcnt(14)
  buffer_load_dwordx4 a[172:175], v1, s[8:11], s26 offen offset:3072 nt
  s_add_u32 s27, s20, 0x134000
  buffer_load_dwordx4 a[176:179], v1, s[8:11], s27 offen nt
  s_waitcnt vmcnt(14)
  buffer_load_dwordx4 a[180:183], v1, s[8:11], s27 offen offset:1024 nt
  buffer_load_dwordx4 a[184:187], v1, s[8:11], s27 offen offset:2048 nt
  s_waitcnt vmcnt(14)
  buffer_load_dwordx4 a[188:191], v1, s[8:11], s27 offen offset:3072 nt
  s_add_u32 s24, s20, 0x150000
  buffer_load_dwordx4 a[192:195], v1, s[8:11], s24 offen nt
  s_waitcnt vmcnt(14)
  buffer_load_dwordx4 a[196:199], v1, s[8:11], s24 offen offset:1024 nt
  buffer_load_dwordx4 a[200:203], v1, s[8:11], s24 offen offset:2048 nt
  s_waitcnt vmcnt(14)
  buffer_load_dwordx4 a[204:207], v1, s[8:11], s24 offen offset:3072 nt
  s_add_u32 s25, s20, 0x16c000
  buffer_load_dwordx4 a[208:211], v1, s[8:11], s25 offen nt
  s_waitcnt vmcnt(14)
  buffer_load_dwordx4 a[212:215], v1, s[8:11], s25 offen offset:1024 nt
  buffer_load_dwordx4 a[216:219], v1, s[8:11], s25 offen offset:2048 nt
  s_waitcnt vmcnt(14)
  buffer_load_dwordx4 a[220:223], v1, s[8:11], s25 offen offset:3072 nt
  s_add_u32 s26, s20, 0x188000
  buffer_load_dwordx4 a[224:227], v1, s[8:11], s26 offen nt
  s_waitcnt vmcnt(14)
  buffer_load_dwordx4 a[228:231], v1, s[8:11], s26 offen offset:1024 nt
  buffer_load_dwordx4 a[232:235], v1, s[8:11], s26 offen offset:2048 nt
  s_waitcnt vmcnt(14)
  buffer_load_dwordx4 a[236:239], v1, s[8:11], s26 offen offset:3072 nt
  s_add_u32 s27, s20, 0x1a4000
  buffer_load_dwordx4 a[248:251], v1, s[8:11], s27 offen nt
  s_waitcnt vmcnt(14)
  buffer_load_dwordx4 a[252:255], v1, s[8:11], s27 offen offset:1024 nt
  buffer_load_dwordx4 v[200:203], v1, s[8:11], s27 offen offset:2048 nt
  s_waitcnt vmcnt(14)
  buffer_load_dwordx4 v[204:207], v1, s[8:11], s27 offen offset:3072 nt
  s_add_u32 m0, s52, 0x0
  s_add_u32 s24, s20, 0x1c0000
  buffer_load_dwordx4 v1, s[8:11], s24 offen nt lds
  s_waitcnt vmcnt(14)
  s_add_u32 m0, s52, 0x400
  s_add_u32 s25, s20, 0x1c0400
  buffer_load_dwordx4 v1, s[8:11], s25 offen nt lds
  s_add_u32 m0, s52, 0x800
  s_add_u32 s26, s20, 0x1c0800
  buffer_load_dwordx4 v1, s[8:11], s26 offen nt lds
  s_waitcnt vmcnt(14)
  s_add_u32 m0, s52, 0xc00
  s_add_u32 s27, s20, 0x1c0c00
  buffer_load_dwordx4 v1, s[8:11], s27 offen nt lds
  s_add_u32 m0, s52, 0x1000
  s_add_u32 s24, s20, 0x1dc000
  buffer_load_dwordx4 v1, s[8:11], s24 offen nt lds
  s_waitcnt vmcnt(14)
  s_add_u32 m0, s52, 0x1400
  s_add_u32 s25, s20, 0x1dc400
  buffer_load_dwordx4 v1, s[8:11], s25 offen nt lds
  buffer_load_dwordx4 v[224:227], v1, s[8:11], s24 offen offset:2048 nt
  s_waitcnt vmcnt(14)
  buffer_load_dwordx4 v[228:231], v1, s[8:11], s24 offen offset:3072 nt
  buffer_load_dwordx4 v[232:235], v1, s[8:11], s22 offen nt
  s_waitcnt vmcnt(14)
  buffer_load_dwordx4 v[236:239], v1, s[8:11], s22 offen offset:1024 nt
  buffer_load_dwordx4 v[240:243], v1, s[8:11], s22 offen offset:2048 nt
  s_waitcnt vmcnt(14)
  buffer_load_dwordx4 v[244:247], v1, s[8:11], s22 offen offset:3072 nt
  buffer_load_dwordx4 v[248:251], v3, s[12:15], s22 offen nt
  s_waitcnt vmcnt(14)
  buffer_load_dwordx4 v[252:255], v3, s[12:15], s22 offen offset:128 nt
  v_and_b32 v7, 0xff, v1
  v_lshlrev_b32 v7, 1, v7
  s_add_u32 s48, s46, 0x8000
  buffer_load_dwordx4 v[28:31], v7, s[4:7], s48 offen sc1
  buffer_load_dwordx4 v[32:35], v7, s[4:7], s48 offen offset:16 sc1
  s_waitcnt vmcnt(0)
  v_min3_u32 v62, v29, v31, v33
  v_max3_u32 v63, v29, v31, v33
  v_min_u32 v62, v62, v35
  v_max_u32 v63, v63, v35
  v_cmp_ne_u32 vcc, s16, v62
  v_cmp_ne_u32 s[50:51], s16, v63
  s_nop 0
  s_or_b64 vcc, vcc, s[50:51]
  s_nop 2
  s_cbranch_vccz L_qok_9
  s_mov_b32 s29, 0x2000
L_qretry_10:
  s_sleep 2
  v_and_b32 v7, 0xff, v1
  v_lshlrev_b32 v7, 1, v7
  s_add_u32 s48, s46, 0x8000
  buffer_load_dwordx4 v[28:31], v7, s[4:7], s48 offen sc1
  buffer_load_dwordx4 v[32:35], v7, s[4:7], s48 offen offset:16 sc1
  s_waitcnt vmcnt(0)
  v_min3_u32 v62, v29, v31, v33
  v_max3_u32 v63, v29, v31, v33
  v_min_u32 v62, v62, v35
  v_max_u32 v63, v63, v35
  v_cmp_ne_u32 vcc, s16, v62
  v_cmp_ne_u32 s[50:51], s16, v63
  s_nop 0
  s_or_b64 vcc, vcc, s[50:51]
  s_sub_u32 s29, s29, 1
  s_nop 1
  s_cbranch_scc1 L_qok_9
  s_cbranch_vccnz L_qretry_10
L_qok_9:
  v_cndmask_b32_e64 v8, 0, v28, s[54:55]
  v_cndmask_b32_e64 v9, 0, v30, s[54:55]
  v_cndmask_b32_e64 v10, 0, v32, s[54:55]
  v_cndmask_b32_e64 v11, 0, v34, s[54:55]
  v_cndmask_b32_e64 v12, 0, v28, s[56:57]
  v_cndmask_b32_e64 v13, 0, v30, s[56:57]
  v_cndmask_b32_e64 v14, 0, v32, s[56:57]
  v_cndmask_b32_e64 v15, 0, v34, s[56:57]
  v_cndmask_b32_e64 v16, 0, v28, s[58:59]
  v_cndmask_b32_e64 v17, 0, v30, s[58:59]
  v_cndmask_b32_e64 v18, 0, v32, s[58:59]
  v_cndmask_b32_e64 v19, 0, v34, s[58:59]
  v_cndmask_b32_e64 v20, 0, v28, s[60:61]
  v_cndmask_b32_e64 v21, 0, v30, s[60:61]
  v_cndmask_b32_e64 v22, 0, v32, s[60:61]
  v_cndmask_b32_e64 v23, 0, v34, s[60:61]
  v_mov_b32 v45, 0xff800000
  v_mfma_f32_16x16x32_bf16 v[24:27], a[0:3], v[8:11], 0
  buffer_load_dwordx4 a[0:3], v3, s[12:15], s22 offen offset:1024 nt
  v_mfma_f32_16x16x32_bf16 v[24:27], a[4:7], v[12:15], v[24:27]
  buffer_load_dwordx4 a[4:7], v3, s[12:15], s22 offen offset:1152 nt
  v_mfma_f32_16x16x32_bf16 v[24:27], a[8:11], v[16:19], v[24:27]
  buffer_load_dwordx4 a[8:11], v3, s[12:15], s22 offen offset:2048 nt
  v_mfma_f32_16x16x32_bf16 v[24:27], a[12:15], v[20:23], v[24:27]
  buffer_load_dwordx4 a[12:15], v3, s[12:15], s22 offen offset:2176 nt
  v_mfma_f32_16x16x32_bf16 v[28:31], a[16:19], v[8:11], 0
  buffer_load_dwordx4 a[16:19], v3, s[12:15], s22 offen offset:3072 nt
  v_mfma_f32_16x16x32_bf16 v[28:31], a[20:23], v[12:15], v[28:31]
  buffer_load_dwordx4 a[20:23], v3, s[12:15], s22 offen offset:3200 nt
  v_mfma_f32_16x16x32_bf16 v[28:31], a[24:27], v[16:19], v[28:31]
  v_mfma_f32_16x16x32_bf16 v[28:31], a[28:31], v[20:23], v[28:31]
  v_mfma_f32_16x16x32_bf16 v[32:35], a[32:35], v[8:11], 0
  v_add_f32_dpp v62, v25, v24 quad_perm:[1,1,1,1] row_mask:0xf bank_mask:0xf
  v_add_f32_dpp v63, v26, v27 quad_perm:[2,2,2,2] row_mask:0xf bank_mask:0xf
  v_mfma_f32_16x16x32_bf16 v[32:35], a[36:39], v[12:15], v[32:35]
  v_mfma_f32_16x16x32_bf16 v[32:35], a[40:43], v[16:19], v[32:35]
  v_add_f32_dpp v41, v63, v62 quad_perm:[3,3,3,3] row_mask:0xf bank_mask:0xf
  v_mfma_f32_16x16x32_bf16 v[32:35], a[44:47], v[20:23], v[32:35]
  v_mfma_f32_16x16x32_bf16 v[24:27], a[48:51], v[8:11], 0
  v_add_f32_dpp v62, v28, v29 quad_perm:[0,0,0,0] row_mask:0xf bank_mask:0xf
  v_add_f32_dpp v63, v30, v31 quad_perm:[2,2,2,2] row_mask:0xf bank_mask:0xf
  v_mfma_f32_16x16x32_bf16 v[24:27], a[52:55], v[12:15], v[24:27]
  v_mfma_f32_16x16x32_bf16 v[24:27], a[56:59], v[16:19], v[24:27]
  v_add_f32_dpp v62, v63, v62 quad_perm:[3,3,3,3] row_mask:0xf bank_mask:0xf
  v_mfma_f32_16x16x32_bf16 v[24:27], a[60:63], v[20:23], v[24:27]
  v_cndmask_b32_e64 v41, v41, v62, s[32:33]
  v_mfma_f32_16x16x32_bf16 v[28:31], a[64:67], v[8:11], 0
  v_add_f32_dpp v62, v32, v33 quad_perm:[0,0,0,0] row_mask:0xf bank_mask:0xf
  v_add_f32_dpp v63, v35, v34 quad_perm:[3,3,3,3] row_mask:0xf bank_mask:0xf
  v_mfma_f32_16x16x32_bf16 v[28:31], a[68:71], v[12:15], v[28:31]
  v_mfma_f32_16x16x32_bf16 v[28:31], a[72:75], v[16:19], v[28:31]
  v_add_f32_dpp v62, v62, v63 quad_perm:[1,1,1,1] row_mask:0xf bank_mask:0xf
  v_mfma_f32_16x16x32_bf16 v[28:31], a[76:79], v[20:23], v[28:31]
  v_cndmask_b32_e64 v41, v41, v62, s[34:35]
  v_mfma_f32_16x16x32_bf16 v[32:35], a[80:83], v[8:11], 0
  v_add_f32_dpp v62, v24, v25 quad_perm:[0,0,0,0] row_mask:0xf bank_mask:0xf
  v_add_f32_dpp v63, v26, v27 quad_perm:[2,2,2,2] row_mask:0xf bank_mask:0xf
  v_mfma_f32_16x16x32_bf16 v[32:35], a[84:87], v[12:15], v[32:35]
  v_mfma_f32_16x16x32_bf16 v[32:35], a[88:91], v[16:19], v[32:35]
  v_add_f32_dpp v62, v62, v63 quad_perm:[1,1,1,1] row_mask:0xf bank_mask:0xf
  v_mfma_f32_16x16x32_bf16 v[32:35], a[92:95], v[20:23], v[32:35]
  v_cndmask_b32_e64 v41, v41, v62, s[36:37]
  v_mfma_f32_16x16x32_bf16 v[24:27], a[96:99], v[8:11], 0
  v_add_f32_dpp v62, v29, v28 quad_perm:[1,1,1,1] row_mask:0xf bank_mask:0xf
  v_add_f32_dpp v63, v30, v31 quad_perm:[2,2,2,2] row_mask:0xf bank_mask:0xf
  v_mfma_f32_16x16x32_bf16 v[24:27], a[100:103], v[12:15], v[24:27]
  v_mfma_f32_16x16x32_bf16 v[24:27], a[104:107], v[16:19], v[24:27]
  v_add_f32_dpp v42, v63, v62 quad_perm:[3,3,3,3] row_mask:0xf bank_mask:0xf
  v_mfma_f32_16x16x32_bf16 v[24:27], a[108:111], v[20:23], v[24:27]
  v_mfma_f32_16x16x32_bf16 v[28:31], a[112:115], v[8:11], 0
  v_add_f32_dpp v62, v32, v33 quad_perm:[0,0,0,0] row_mask:0xf bank_mask:0xf
  v_add_f32_dpp v63, v34, v35 quad_perm:[2,2,2,2] row_mask:0xf bank_mask:0xf
  v_mfma_f32_16x16x32_bf16 v[28:31], a[116:119], v[12:15], v[28:31]
  v_mfma_f32_16x16x32_bf16 v[28:31], a[120:123], v[16:19], v[28:31]
  v_add_f32_dpp v62, v63, v62 quad_perm:[3,3,3,3] row_mask:0xf bank_mask:0xf
  v_mfma_f32_16x16x32_bf16 v[28:31], a[124:127], v[20:23], v[28:31]
  v_cndmask_b32_e64 v42, v42, v62, s[32:33]
  v_mfma_f32_16x16x32_bf16 v[32:35], a[128:131], v[8:11], 0
  v_add_f32_dpp v62, v24, v25 quad_perm:[0,0,0,0] row_mask:0xf bank_mask:0xf
  v_add_f32_dpp v63, v27, v26 quad_perm:[3,3,3,3] row_mask:0xf bank_mask:0xf
  v_mfma_f32_16x16x32_bf16 v[32:35], a[132:135], v[12:15], v[32:35]
  v_mfma_f32_16x16x32_bf16 v[32:35], a[136:139], v[16:19], v[32:35]
  v_add_f32_dpp v62, v62, v63 quad_perm:[1,1,1,1] row_mask:0xf bank_mask:0xf
  v_mfma_f32_16x16x32_bf16 v[32:35], a[140:143], v[20:23], v[32:35]
  v_cndmask_b32_e64 v42, v42, v62, s[34:35]
  v_mfma_f32_16x16x32_bf16 v[24:27], a[144:147], v[8:11], 0
  v_add_f32_dpp v62, v28, v29 quad_perm:[0,0,0,0] row_mask:0xf bank_mask:0xf
  v_add_f32_dpp v63, v30, v31 quad_perm:[2,2,2,2] row_mask:0xf bank_mask:0xf
  v_mfma_f32_16x16x32_bf16 v[24:27], a[148:151], v[12:15], v[24:27]
  v_mfma_f32_16x16x32_bf16 v[24:27], a[152:155], v[16:19], v[24:27]
  v_add_f32_dpp v62, v62, v63 quad_perm:[1,1,1,1] row_mask:0xf bank_mask:0xf
  v_mfma_f32_16x16x32_bf16 v[24:27], a[156:159], v[20:23], v[24:27]
  v_cndmask_b32_e64 v42, v42, v62, s[36:37]
  v_mfma_f32_16x16x32_bf16 v[28:31], a[160:163], v[8:11], 0
  v_add_f32_dpp v62, v33, v32 quad_perm:[1,1,1,1] row_mask:0xf bank_mask:0xf
  v_add_f32_dpp v63, v34, v35 quad_perm:[2,2,2,2] row_mask:0xf bank_mask:0xf
  v_mfma_f32_16x16x32_bf16 v[28:31], a[164:167], v[12:15], v[28:31]
  v_mfma_f32_16x16x32_bf16 v[28:31], a[168:171], v[16:19], v[28:31]
  v_add_f32_dpp v43, v63, v62 quad_perm:[3,3,3,3] row_mask:0xf bank_mask:0xf
  v_mfma_f32_16x16x32_bf16 v[28:31], a[172:175], v[20:23], v[28:31]
  v_mfma_f32_16x16x32_bf16 v[32:35], a[176:179], v[8:11], 0
  v_add_f32_dpp v62, v24, v25 quad_perm:[0,0,0,0] row_mask:0xf bank_mask:0xf
  v_add_f32_dpp v63, v26, v27 quad_perm:[2,2,2,2] row_mask:0xf bank_mask:0xf
  v_mfma_f32_16x16x32_bf16 v[32:35], a[180:183], v[12:15], v[32:35]
  v_mfma_f32_16x16x32_bf16 v[32:35], a[184:187], v[16:19], v[32:35]
  v_add_f32_dpp v62, v63, v62 quad_perm:[3,3,3,3] row_mask:0xf bank_mask:0xf
  v_mfma_f32_16x16x32_bf16 v[32:35], a[188:191], v[20:23], v[32:35]
  v_cndmask_b32_e64 v43, v43, v62, s[32:33]
  v_mfma_f32_16x16x32_bf16 v[24:27], a[192:195], v[8:11], 0
  v_add_f32_dpp v62, v28, v29 quad_perm:[0,0,0,0] row_mask:0xf bank_mask:0xf
  v_add_f32_dpp v63, v31, v30 quad_perm:[3,3,3,3] row_mask:0xf bank_mask:0xf
  v_mfma_f32_16x16x32_bf16 v[24:27], a[196:199], v[12:15], v[24:27]
  v_mfma_f32_16x16x32_bf16 v[24:27], a[200:203], v[16:19], v[24:27]
  v_add_f32_dpp v62, v62, v63 quad_perm:[1,1,1,1] row_mask:0xf bank_mask:0xf
  v_mfma_f32_16x16x32_bf16 v[24:27], a[204:207], v[20:23], v[24:27]
  v_cndmask_b32_e64 v43, v43, v62, s[34:35]
  v_mfma_f32_16x16x32_bf16 v[28:31], a[208:211], v[8:11], 0
  v_add_f32_dpp v62, v32, v33 quad_perm:[0,0,0,0] row_mask:0xf bank_mask:0xf
  v_add_f32_dpp v63, v34, v35 quad_perm:[2,2,2,2] row_mask:0xf bank_mask:0xf
  v_mfma_f32_16x16x32_bf16 v[28:31], a[212:215], v[12:15], v[28:31]
  v_mfma_f32_16x16x32_bf16 v[28:31], a[216:219], v[16:19], v[28:31]
  v_add_f32_dpp v62, v62, v63 quad_perm:[1,1,1,1] row_mask:0xf bank_mask:0xf
  v_mfma_f32_16x16x32_bf16 v[28:31], a[220:223], v[20:23], v[28:31]
  v_cndmask_b32_e64 v43, v43, v62, s[36:37]
  v_mfma_f32_16x16x32_bf16 v[32:35], a[224:227], v[8:11], 0
  v_add_f32_dpp v62, v25, v24 quad_perm:[1,1,1,1] row_mask:0xf bank_mask:0xf
  v_add_f32_dpp v63, v26, v27 quad_perm:[2,2,2,2] row_mask:0xf bank_mask:0xf
  ds_read_b128 v[54:57], v5 offset:0
  v_mfma_f32_16x16x32_bf16 v[32:35], a[228:231], v[12:15], v[32:35]
  ds_read_b128 v[58:61], v5 offset:1024
  v_mfma_f32_16x16x32_bf16 v[32:35], a[232:235], v[16:19], v[32:35]
  v_add_f32_dpp v44, v63, v62 quad_perm:[3,3,3,3] row_mask:0xf bank_mask:0xf
  ds_read_b128 v[46:49], v5 offset:2048
  v_mfma_f32_16x16x32_bf16 v[32:35], a[236:239], v[20:23], v[32:35]
  v_mfma_f32_16x16x32_bf16 v[24:27], a[248:251], v[8:11], 0
  v_add_f32_dpp v62, v28, v29 quad_perm:[0,0,0,0] row_mask:0xf bank_mask:0xf
  v_add_f32_dpp v63, v30, v31 quad_perm:[2,2,2,2] row_mask:0xf bank_mask:0xf
  v_mfma_f32_16x16x32_bf16 v[24:27], a[252:255], v[12:15], v[24:27]
  v_mfma_f32_16x16x32_bf16 v[24:27], v[200:203], v[16:19], v[24:27]
  v_add_f32_dpp v62, v63, v62 quad_perm:[3,3,3,3] row_mask:0xf bank_mask:0xf
  v_mfma_f32_16x16x32_bf16 v[24:27], v[204:207], v[20:23], v[24:27]
  v_cndmask_b32_e64 v44, v44, v62, s[32:33]
  s_waitcnt lgkmcnt(2)
  v_mfma_f32_16x16x32_bf16 v[28:31], v[54:57], v[8:11], 0
  v_add_f32_dpp v62, v32, v33 quad_perm:[0,0,0,0] row_mask:0xf bank_mask:0xf
  v_add_f32_dpp v63, v35, v34 quad_perm:[3,3,3,3] row_mask:0xf bank_mask:0xf
  ds_read_b128 v[50:53], v5 offset:3072
  s_waitcnt lgkmcnt(2)
  v_mfma_f32_16x16x32_bf16 v[28:31], v[58:61], v[12:15], v[28:31]
  ds_read_b128 v[54:57], v5 offset:4096
  s_waitcnt lgkmcnt(2)
  v_mfma_f32_16x16x32_bf16 v[28:31], v[46:49], v[16:19], v[28:31]
  v_add_f32_dpp v62, v62, v63 quad_perm:[1,1,1,1] row_mask:0xf bank_mask:0xf
  ds_read_b128 v[58:61], v5 offset:5120
  s_waitcnt lgkmcnt(2)
  v_mfma_f32_16x16x32_bf16 v[28:31], v[50:53], v[20:23], v[28:31]
  v_cndmask_b32_e64 v44, v44, v62, s[34:35]
  s_waitcnt lgkmcnt(1)
  v_mfma_f32_16x16x32_bf16 v[32:35], v[54:57], v[8:11], 0
  v_add_f32_dpp v62, v24, v25 quad_perm:[0,0,0,0] row_mask:0xf bank_mask:0xf
  v_add_f32_dpp v63, v26, v27 quad_perm:[2,2,2,2] row_mask:0xf bank_mask:0xf
  s_waitcnt lgkmcnt(0)
  v_mfma_f32_16x16x32_bf16 v[32:35], v[58:61], v[12:15], v[32:35]
  v_mfma_f32_16x16x32_bf16 v[32:35], v[224:227], v[16:19], v[32:35]
  v_add_f32_dpp v62, v62, v63 quad_perm:[1,1,1,1] row_mask:0xf bank_mask:0xf
  v_mfma_f32_16x16x32_bf16 v[32:35], v[228:231], v[20:23], v[32:35]
  v_cndmask_b32_e64 v44, v44, v62, s[36:37]
  v_mfma_f32_16x16x32_bf16 v[24:27], v[232:235], v[8:11], 0
  v_add_f32_dpp v62, v29, v28 quad_perm:[1,1,1,1] row_mask:0xf bank_mask:0xf
  v_add_f32_dpp v63, v30, v31 quad_perm:[2,2,2,2] row_mask:0xf bank_mask:0xf
  v_mfma_f32_16x16x32_bf16 v[24:27], v[236:239], v[12:15], v[24:27]
  v_mfma_f32_16x16x32_bf16 v[24:27], v[240:243], v[16:19], v[24:27]
  v_add_f32_dpp v62, v63, v62 quad_perm:[3,3,3,3] row_mask:0xf bank_mask:0xf
  v_mfma_f32_16x16x32_bf16 v[24:27], v[244:247], v[20:23], v[24:27]
  v_cndmask_b32_e64 v45, v45, v62, s[30:31]
  v_add_f32_dpp v62, v32, v33 quad_perm:[0,0,0,0] row_mask:0xf bank_mask:0xf
  v_add_f32_dpp v63, v34, v35 quad_perm:[2,2,2,2] row_mask:0xf bank_mask:0xf
  s_nop 1
  v_add_f32_dpp v62, v63, v62 quad_perm:[3,3,3,3] row_mask:0xf bank_mask:0xf
  v_cndmask_b32_e64 v45, v45, v62, s[32:33]
  s_nop 0
  v_add_f32_dpp v62, v24, v25 quad_perm:[0,0,0,0] row_mask:0xf bank_mask:0xf
  v_add_f32_dpp v63, v27, v26 quad_perm:[3,3,3,3] row_mask:0xf bank_mask:0xf
  s_nop 1
  v_add_f32_dpp v62, v62, v63 quad_perm:[1,1,1,1] row_mask:0xf bank_mask:0xf
  v_cndmask_b32_e64 v45, v45, v62, s[38:39]
  v_cvt_pk_bf16_f32 v41, v41, v41
  v_cvt_pk_bf16_f32 v42, v42, v42
  v_cvt_pk_bf16_f32 v43, v43, v43
  v_cvt_pk_bf16_f32 v44, v44, v44
  v_cvt_pk_bf16_f32 v45, v45, v45
  v_and_b32 v41, 0xffff0000, v41
  v_and_b32 v42, 0xffff0000, v42
  v_and_b32 v43, 0xffff0000, v43
  v_and_b32 v44, 0xffff0000, v44
  v_and_b32 v45, 0xffff0000, v45
  v_mul_f32 v41, s53, v41
  v_mul_f32 v42, s53, v42
  v_mul_f32 v43, s53, v43
  v_mul_f32 v44, s53, v44
  v_mul_f32 v45, s53, v45
  v_cvt_pk_bf16_f32 v41, v41, v41
  v_cvt_pk_bf16_f32 v42, v42, v42
  v_cvt_pk_bf16_f32 v43, v43, v43
  v_cvt_pk_bf16_f32 v44, v44, v44
  v_cvt_pk_bf16_f32 v45, v45, v45
  v_and_b32 v41, 0xffff0000, v41
  v_and_b32 v42, 0xffff0000, v42
  v_and_b32 v43, 0xffff0000, v43
  v_and_b32 v44, 0xffff0000, v44
  v_and_b32 v45, 0xffff0000, v45
  v_max3_f32 v62, v41, v42, v43
  v_max3_f32 v62, v62, v44, v45
  s_nop 1
  v_max_f32_dpp v62, v62, v62 row_shr:1 row_mask:0xf bank_mask:0xf
  s_nop 1
  v_max_f32_dpp v62, v62, v62 row_shr:2 row_mask:0xf bank_mask:0xf
  s_nop 1
  v_max_f32_dpp v62, v62, v62 row_shr:4 row_mask:0xf bank_mask:0xf
  s_nop 1
  v_max_f32_dpp v62, v62, v62 row_shr:8 row_mask:0xf bank_mask:0xf
  s_nop 1
  v_max_f32_dpp v62, v62, v62 row_bcast:15 row_mask:0xa bank_mask:0xf
  s_nop 1
  v_max_f32_dpp v62, v62, v62 row_bcast:31 row_mask:0xc bank_mask:0xf
  s_nop 0
  v_readlane_b32 s42, v62, 63
  s_nop 1
  v_mov_b32 v63, s42
  v_mul_f32 v63, s28, v63
  v_fma_f32 v41, v41, s28, -v63
  v_fma_f32 v42, v42, s28, -v63
  v_fma_f32 v43, v43, s28, -v63
  v_fma_f32 v44, v44, s28, -v63
  v_fma_f32 v45, v45, s28, -v63
  v_exp_f32 v41, v41
  v_exp_f32 v42, v42
  v_exp_f32 v43, v43
  v_exp_f32 v44, v44
  v_exp_f32 v45, v45
  v_add_f32 v62, v41, v42
  v_add_f32 v63, v43, v44
  v_add_f32 v62, v62, v45
  v_cvt_pk_bf16_f32 v41, v41, v41
  v_cvt_pk_bf16_f32 v42, v42, v42
  v_cvt_pk_bf16_f32 v43, v43, v43
  v_cvt_pk_bf16_f32 v44, v44, v44
  v_cvt_pk_bf16_f32 v45, v45, v45
  v_add_f32 v62, v62, v63
  v_and_b32_dpp v24, v41, v4 quad_perm:[0,0,1,1] row_mask:0xf bank_mask:0xf
  v_mov_b32 v8, 0
  v_mov_b32 v9, 0
  v_mov_b32 v10, 0
  v_mov_b32 v11, 0
  v_mov_b32 v12, 0
  v_mov_b32 v13, 0
  v_mov_b32 v14, 0
  v_mov_b32 v15, 0
  v_mov_b32_dpp v8, v24 quad_perm:[0,1,2,3] row_mask:0xf bank_mask:0x1
  v_mov_b32_dpp v9, v24 row_ror:4 row_mask:0xf bank_mask:0x2
  v_mov_b32_dpp v10, v24 row_ror:8 row_mask:0xf bank_mask:0x4
  v_mov_b32_dpp v11, v24 row_ror:12 row_mask:0xf bank_mask:0x8
  ds_read_b128 v[46:49], v5 offset:6144
  ds_read_b128 v[50:53], v5 offset:7168
  ds_read_b128 v[54:57], v5 offset:8192
  s_waitcnt lgkmcnt(2)
  v_mfma_f32_16x16x32_bf16 v[16:19], v[46:49], v[8:11], 0
  v_mov_b32_dpp v12, v24 row_ror:12 row_mask:0xf bank_mask:0x1
  v_mov_b32_dpp v13, v24 quad_perm:[0,1,2,3] row_mask:0xf bank_mask:0x2
  ds_read_b128 v[58:61], v5 offset:9216
  s_waitcnt lgkmcnt(2)
  v_mfma_f32_16x16x32_bf16 v[20:23], v[50:53], v[8:11], 0
  v_mov_b32_dpp v14, v24 row_ror:4 row_mask:0xf bank_mask:0x4
  v_mov_b32_dpp v15, v24 row_ror:8 row_mask:0xf bank_mask:0x8
  v_add_f32_dpp v62, v62, v62 row_shr:1 row_mask:0xf bank_mask:0xf
  ds_read_b128 v[46:49], v5 offset:10240
  s_waitcnt lgkmcnt(2)
  v_mfma_f32_16x16x32_bf16 v[16:19], v[54:57], v[12:15], v[16:19]
  v_mov_b32_dpp v8, v24 row_ror:8 row_mask:0xf bank_mask:0x1
  v_mov_b32_dpp v9, v24 row_ror:12 row_mask:0xf bank_mask:0x2
  v_and_b32_dpp v25, v41, v4 quad_perm:[2,2,3,3] row_mask:0xf bank_mask:0xf
  ds_read_b128 v[50:53], v5 offset:11264
  s_waitcnt lgkmcnt(2)
  v_mfma_f32_16x16x32_bf16 v[20:23], v[58:61], v[12:15], v[20:23]
  v_mov_b32_dpp v10, v24 quad_perm:[0,1,2,3] row_mask:0xf bank_mask:0x4
  v_mov_b32_dpp v11, v24 row_ror:4 row_mask:0xf bank_mask:0x8
  v_add_f32_dpp v62, v62, v62 row_shr:2 row_mask:0xf bank_mask:0xf
  ds_read_b128 v[54:57], v5 offset:12288
  s_waitcnt lgkmcnt(2)
  v_mfma_f32_16x16x32_bf16 v[16:19], v[46:49], v[8:11], v[16:19]
  v_mov_b32_dpp v12, v24 row_ror:4 row_mask:0xf bank_mask:0x1
  v_mov_b32_dpp v13, v24 row_ror:8 row_mask:0xf bank_mask:0x2
  ds_read_b128 v[58:61], v5 offset:13312
  s_waitcnt lgkmcnt(2)
  v_mfma_f32_16x16x32_bf16 v[20:23], v[50:53], v[8:11], v[20:23]
  v_mov_b32_dpp v14, v24 row_ror:12 row_mask:0xf bank_mask:0x4
  v_mov_b32_dpp v15, v24 quad_perm:[0,1,2,3] row_mask:0xf bank_mask:0x8
  v_add_f32_dpp v62, v62, v62 row_shr:4 row_mask:0xf bank_mask:0xf
  ds_read_b128 v[46:49], v5 offset:14336
  s_waitcnt lgkmcnt(2)
  v_mfma_f32_16x16x32_bf16 v[16:19], v[54:57], v[12:15], v[16:19]
  v_mov_b32_dpp v8, v25 quad_perm:[0,1,2,3] row_mask:0xf bank_mask:0x1
  v_mov_b32_dpp v9, v25 row_ror:4 row_mask:0xf bank_mask:0x2
  ds_read_b128 v[50:53], v5 offset:15360
  s_waitcnt lgkmcnt(2)
  v_mfma_f32_16x16x32_bf16 v[20:23], v[58:61], v[12:15], v[20:23]
  v_mov_b32_dpp v10, v25 row_ror:8 row_mask:0xf bank_mask:0x4
  v_mov_b32_dpp v11, v25 row_ror:12 row_mask:0xf bank_mask:0x8
  v_add_f32_dpp v62, v62, v62 row_shr:8 row_mask:0xf bank_mask:0xf
  ds_read_b128 v[54:57], v5 offset:16384
  s_waitcnt lgkmcnt(2)
  v_mfma_f32_16x16x32_bf16 v[16:19], v[46:49], v[8:11], v[16:19]
  v_mov_b32_dpp v12, v25 row_ror:12 row_mask:0xf bank_mask:0x1
  v_mov_b32_dpp v13, v25 quad_perm:[0,1,2,3] row_mask:0xf bank_mask:0x2
  ds_read_b128 v[58:61], v5 offset:17408
  s_waitcnt lgkmcnt(2)
  v_mfma_f32_16x16x32_bf16 v[20:23], v[50:53], v[8:11], v[20:23]
  v_mov_b32_dpp v14, v25 row_ror:4 row_mask:0xf bank_mask:0x4
  v_mov_b32_dpp v15, v25 row_ror:8 row_mask:0xf bank_mask:0x8
  v_add_f32_dpp v62, v62, v62 row_bcast:15 row_mask:0xa bank_mask:0xf
  ds_read_b128 v[46:49], v5 offset:18432
  s_waitcnt lgkmcnt(2)
  v_mfma_f32_16x16x32_bf16 v[16:19], v[54:57], v[12:15], v[16:19]
  v_mov_b32_dpp v8, v25 row_ror:8 row_mask:0xf bank_mask:0x1
  v_mov_b32_dpp v9, v25 row_ror:12 row_mask:0xf bank_mask:0x2
  v_and_b32_dpp v24, v42, v4 quad_perm:[0,0,1,1] row_mask:0xf bank_mask:0xf
  ds_read_b128 v[50:53], v5 offset:19456
  s_waitcnt lgkmcnt(2)
  v_mfma_f32_16x16x32_bf16 v[20:23], v[58:61], v[12:15], v[20:23]
  v_mov_b32_dpp v10, v25 quad_perm:[0,1,2,3] row_mask:0xf bank_mask:0x4
  v_mov_b32_dpp v11, v25 row_ror:4 row_mask:0xf bank_mask:0x8
  v_add_f32_dpp v62, v62, v62 row_bcast:31 row_mask:0xc bank_mask:0xf
  ds_read_b128 v[54:57], v5 offset:20480
  s_waitcnt lgkmcnt(2)
  v_mfma_f32_16x16x32_bf16 v[16:19], v[46:49], v[8:11], v[16:19]
  v_mov_b32_dpp v12, v25 row_ror:4 row_mask:0xf bank_mask:0x1
  v_mov_b32_dpp v13, v25 row_ror:8 row_mask:0xf bank_mask:0x2
  ds_read_b128 v[58:61], v5 offset:21504
  s_waitcnt lgkmcnt(2)
  v_mfma_f32_16x16x32_bf16 v[20:23], v[50:53], v[8:11], v[20:23]
  v_mov_b32_dpp v14, v25 row_ror:12 row_mask:0xf bank_mask:0x4
  v_mov_b32_dpp v15, v25 quad_perm:[0,1,2,3] row_mask:0xf bank_mask:0x8
  v_readlane_b32 s44, v62, 63
  ds_read_b128 v[46:49], v5 offset:22528
  s_waitcnt lgkmcnt(2)
  v_mfma_f32_16x16x32_bf16 v[16:19], v[54:57], v[12:15], v[16:19]
  v_mov_b32_dpp v8, v24 quad_perm:[0,1,2,3] row_mask:0xf bank_mask:0x1
  v_mov_b32_dpp v9, v24 row_ror:4 row_mask:0xf bank_mask:0x2
  ds_read_b128 v[50:53], v5 offset:23552
  s_waitcnt lgkmcnt(2)
  v_mfma_f32_16x16x32_bf16 v[20:23], v[58:61], v[12:15], v[20:23]
  v_mov_b32_dpp v10, v24 row_ror:8 row_mask:0xf bank_mask:0x4
  v_mov_b32_dpp v11, v24 row_ror:12 row_mask:0xf bank_mask:0x8
  ds_read_b128 v[54:57], v5 offset:24576
  s_waitcnt lgkmcnt(2)
  v_mfma_f32_16x16x32_bf16 v[16:19], v[46:49], v[8:11], v[16:19]
  v_mov_b32_dpp v12, v24 row_ror:12 row_mask:0xf bank_mask:0x1
  v_mov_b32_dpp v13, v24 quad_perm:[0,1,2,3] row_mask:0xf bank_mask:0x2
  ds_read_b128 v[58:61], v5 offset:25600
  s_waitcnt lgkmcnt(2)
  v_mfma_f32_16x16x32_bf16 v[20:23], v[50:53], v[8:11], v[20:23]
  v_mov_b32_dpp v14, v24 row_ror:4 row_mask:0xf bank_mask:0x4
  v_mov_b32_dpp v15, v24 row_ror:8 row_mask:0xf bank_mask:0x8
  ds_read_b128 v[46:49], v5 offset:26624
  s_waitcnt lgkmcnt(2)
  v_mfma_f32_16x16x32_bf16 v[16:19], v[54:57], v[12:15], v[16:19]
  v_mov_b32_dpp v8, v24 row_ror:8 row_mask:0xf bank_mask:0x1
  v_mov_b32_dpp v9, v24 row_ror:12 row_mask:0xf bank_mask:0x2
  v_and_b32_dpp v25, v42, v4 quad_perm:[2,2,3,3] row_mask:0xf bank_mask:0xf
  ds_read_b128 v[50:53], v5 offset:27648
  s_waitcnt lgkmcnt(2)
  v_mfma_f32_16x16x32_bf16 v[20:23], v[58:61], v[12:15], v[20:23]
  v_mov_b32_dpp v10, v24 quad_perm:[0,1,2,3] row_mask:0xf bank_mask:0x4
  v_mov_b32_dpp v11, v24 row_ror:4 row_mask:0xf bank_mask:0x8
  ds_read_b128 v[54:57], v5 offset:28672
  s_waitcnt lgkmcnt(2)
  v_mfma_f32_16x16x32_bf16 v[16:19], v[46:49], v[8:11], v[16:19]
  v_mov_b32_dpp v12, v24 row_ror:4 row_mask:0xf bank_mask:0x1
  v_mov_b32_dpp v13, v24 row_ror:8 row_mask:0xf bank_mask:0x2
  ds_read_b128 v[58:61], v5 offset:29696
  s_waitcnt lgkmcnt(2)
  v_mfma_f32_16x16x32_bf16 v[20:23], v[50:53], v[8:11], v[20:23]
  v_mov_b32_dpp v14, v24 row_ror:12 row_mask:0xf bank_mask:0x4
  v_mov_b32_dpp v15, v24 quad_perm:[0,1,2,3] row_mask:0xf bank_mask:0x8
  ds_read_b128 v[46:49], v5 offset:30720
  s_waitcnt lgkmcnt(2)
  v_mfma_f32_16x16x32_bf16 v[16:19], v[54:57], v[12:15], v[16:19]
  v_mov_b32_dpp v8, v25 quad_perm:[0,1,2,3] row_mask:0xf bank_mask:0x1
  v_mov_b32_dpp v9, v25 row_ror:4 row_mask:0xf bank_mask:0x2
  ds_read_b128 v[50:53], v5 offset:31744
  s_waitcnt lgkmcnt(2)
  v_mfma_f32_16x16x32_bf16 v[20:23], v[58:61], v[12:15], v[20:23]
  v_mov_b32_dpp v10, v25 row_ror:8 row_mask:0xf bank_mask:0x4
  v_mov_b32_dpp v11, v25 row_ror:12 row_mask:0xf bank_mask:0x8
  ds_read_b128 v[54:57], v5 offset:32768
  s_waitcnt lgkmcnt(2)
  v_mfma_f32_16x16x32_bf16 v[16:19], v[46:49], v[8:11], v[16:19]
  v_mov_b32_dpp v12, v25 row_ror:12 row_mask:0xf bank_mask:0x1
  v_mov_b32_dpp v13, v25 quad_perm:[0,1,2,3] row_mask:0xf bank_mask:0x2
  ds_read_b128 v[58:61], v5 offset:33792
  s_waitcnt lgkmcnt(2)
  v_mfma_f32_16x16x32_bf16 v[20:23], v[50:53], v[8:11], v[20:23]
  v_mov_b32_dpp v14, v25 row_ror:4 row_mask:0xf bank_mask:0x4
  v_mov_b32_dpp v15, v25 row_ror:8 row_mask:0xf bank_mask:0x8
  ds_read_b128 v[46:49], v5 offset:34816
  s_waitcnt lgkmcnt(2)
  v_mfma_f32_16x16x32_bf16 v[16:19], v[54:57], v[12:15], v[16:19]
  v_mov_b32_dpp v8, v25 row_ror:8 row_mask:0xf bank_mask:0x1
  v_mov_b32_dpp v9, v25 row_ror:12 row_mask:0xf bank_mask:0x2
  v_and_b32_dpp v24, v43, v4 quad_perm:[0,0,1,1] row_mask:0xf bank_mask:0xf
  ds_read_b128 v[50:53], v5 offset:35840
  s_waitcnt lgkmcnt(2)
  v_mfma_f32_16x16x32_bf16 v[20:23], v[58:61], v[12:15], v[20:23]
  v_mov_b32_dpp v10, v25 quad_perm:[0,1,2,3] row_mask:0xf bank_mask:0x4
  v_mov_b32_dpp v11, v25 row_ror:4 row_mask:0xf bank_mask:0x8
  ds_read_b128 v[54:57], v5 offset:36864
  s_waitcnt lgkmcnt(2)
  v_mfma_f32_16x16x32_bf16 v[16:19], v[46:49], v[8:11], v[16:19]
  v_mov_b32_dpp v12, v25 row_ror:4 row_mask:0xf bank_mask:0x1
  v_mov_b32_dpp v13, v25 row_ror:8 row_mask:0xf bank_mask:0x2
  ds_read_b128 v[58:61], v5 offset:37888
  s_waitcnt lgkmcnt(2)
  v_mfma_f32_16x16x32_bf16 v[20:23], v[50:53], v[8:11], v[20:23]
  v_mov_b32_dpp v14, v25 row_ror:12 row_mask:0xf bank_mask:0x4
  v_mov_b32_dpp v15, v25 quad_perm:[0,1,2,3] row_mask:0xf bank_mask:0x8
  s_waitcnt lgkmcnt(1)
  s_nop 0
  v_mfma_f32_16x16x32_bf16 v[16:19], v[54:57], v[12:15], v[16:19]
  v_mov_b32_dpp v8, v24 quad_perm:[0,1,2,3] row_mask:0xf bank_mask:0x1
  v_mov_b32_dpp v9, v24 row_ror:4 row_mask:0xf bank_mask:0x2
  s_waitcnt lgkmcnt(0)
  v_mfma_f32_16x16x32_bf16 v[20:23], v[58:61], v[12:15], v[20:23]
  v_mov_b32_dpp v10, v24 row_ror:8 row_mask:0xf bank_mask:0x4
  v_mov_b32_dpp v11, v24 row_ror:12 row_mask:0xf bank_mask:0x8
  s_nop 1
  v_mfma_f32_16x16x32_bf16 v[16:19], v[64:67], v[8:11], v[16:19]
  v_mov_b32_dpp v12, v24 row_ror:12 row_mask:0xf bank_mask:0x1
  v_mov_b32_dpp v13, v24 quad_perm:[0,1,2,3] row_mask:0xf bank_mask:0x2
  v_mfma_f32_16x16x32_bf16 v[20:23], v[68:71], v[8:11], v[20:23]
  v_mov_b32_dpp v14, v24 row_ror:4 row_mask:0xf bank_mask:0x4
  v_mov_b32_dpp v15, v24 row_ror:8 row_mask:0xf bank_mask:0x8
  s_nop 1
  v_mfma_f32_16x16x32_bf16 v[16:19], v[72:75], v[12:15], v[16:19]
  v_mov_b32_dpp v8, v24 row_ror:8 row_mask:0xf bank_mask:0x1
  v_mov_b32_dpp v9, v24 row_ror:12 row_mask:0xf bank_mask:0x2
  v_and_b32_dpp v25, v43, v4 quad_perm:[2,2,3,3] row_mask:0xf bank_mask:0xf
  v_mfma_f32_16x16x32_bf16 v[20:23], v[76:79], v[12:15], v[20:23]
  v_mov_b32_dpp v10, v24 quad_perm:[0,1,2,3] row_mask:0xf bank_mask:0x4
  v_mov_b32_dpp v11, v24 row_ror:4 row_mask:0xf bank_mask:0x8
  s_nop 1
  v_mfma_f32_16x16x32_bf16 v[16:19], v[80:83], v[8:11], v[16:19]
  v_mov_b32_dpp v12, v24 row_ror:4 row_mask:0xf bank_mask:0x1
  v_mov_b32_dpp v13, v24 row_ror:8 row_mask:0xf bank_mask:0x2
  v_mfma_f32_16x16x32_bf16 v[20:23], v[84:87], v[8:11], v[20:23]
  v_mov_b32_dpp v14, v24 row_ror:12 row_mask:0xf bank_mask:0x4
  v_mov_b32_dpp v15, v24 quad_perm:[0,1,2,3] row_mask:0xf bank_mask:0x8
  s_nop 1
  v_mfma_f32_16x16x32_bf16 v[16:19], v[88:91], v[12:15], v[16:19]
  v_mov_b32_dpp v8, v25 quad_perm:[0,1,2,3] row_mask:0xf bank_mask:0x1
  v_mov_b32_dpp v9, v25 row_ror:4 row_mask:0xf bank_mask:0x2
  v_mfma_f32_16x16x32_bf16 v[20:23], v[92:95], v[12:15], v[20:23]
  v_mov_b32_dpp v10, v25 row_ror:8 row_mask:0xf bank_mask:0x4
  v_mov_b32_dpp v11, v25 row_ror:12 row_mask:0xf bank_mask:0x8
  s_nop 1
  v_mfma_f32_16x16x32_bf16 v[16:19], v[96:99], v[8:11], v[16:19]
  v_mov_b32_dpp v12, v25 row_ror:12 row_mask:0xf bank_mask:0x1
  v_mov_b32_dpp v13, v25 quad_perm:[0,1,2,3] row_mask:0xf bank_mask:0x2
  v_mfma_f32_16x16x32_bf16 v[20:23], v[100:103], v[8:11], v[20:23]
  v_mov_b32_dpp v14, v25 row_ror:4 row_mask:0xf bank_mask:0x4
  v_mov_b32_dpp v15, v25 row_ror:8 row_mask:0xf bank_mask:0x8
  s_nop 1
  v_mfma_f32_16x16x32_bf16 v[16:19], v[104:107], v[12:15], v[16:19]
  v_mov_b32_dpp v8, v25 row_ror:8 row_mask:0xf bank_mask:0x1
  v_mov_b32_dpp v9, v25 row_ror:12 row_mask:0xf bank_mask:0x2
  v_and_b32_dpp v24, v44, v4 quad_perm:[0,0,1,1] row_mask:0xf bank_mask:0xf
  v_mfma_f32_16x16x32_bf16 v[20:23], v[108:111], v[12:15], v[20:23]
  v_mov_b32_dpp v10, v25 quad_perm:[0,1,2,3] row_mask:0xf bank_mask:0x4
  v_mov_b32_dpp v11, v25 row_ror:4 row_mask:0xf bank_mask:0x8
  s_nop 1
  v_mfma_f32_16x16x32_bf16 v[16:19], v[112:115], v[8:11], v[16:19]
  v_mov_b32_dpp v12, v25 row_ror:4 row_mask:0xf bank_mask:0x1
  v_mov_b32_dpp v13, v25 row_ror:8 row_mask:0xf bank_mask:0x2
  v_mfma_f32_16x16x32_bf16 v[20:23], v[116:119], v[8:11], v[20:23]
  v_mov_b32_dpp v14, v25 row_ror:12 row_mask:0xf bank_mask:0x4
  v_mov_b32_dpp v15, v25 quad_perm:[0,1,2,3] row_mask:0xf bank_mask:0x8
  s_nop 1
  v_mfma_f32_16x16x32_bf16 v[16:19], v[120:123], v[12:15], v[16:19]
  v_mov_b32_dpp v8, v24 quad_perm:[0,1,2,3] row_mask:0xf bank_mask:0x1
  v_mov_b32_dpp v9, v24 row_ror:4 row_mask:0xf bank_mask:0x2
  v_mfma_f32_16x16x32_bf16 v[20:23], v[124:127], v[12:15], v[20:23]
  v_mov_b32_dpp v10, v24 row_ror:8 row_mask:0xf bank_mask:0x4
  v_mov_b32_dpp v11, v24 row_ror:12 row_mask:0xf bank_mask:0x8
  s_nop 1
  v_mfma_f32_16x16x32_bf16 v[16:19], v[128:131], v[8:11], v[16:19]
  v_mov_b32_dpp v12, v24 row_ror:12 row_mask:0xf bank_mask:0x1
  v_mov_b32_dpp v13, v24 quad_perm:[0,1,2,3] row_mask:0xf bank_mask:0x2
  v_mfma_f32_16x16x32_bf16 v[20:23], v[132:135], v[8:11], v[20:23]
  v_mov_b32_dpp v14, v24 row_ror:4 row_mask:0xf bank_mask:0x4
  v_mov_b32_dpp v15, v24 row_ror:8 row_mask:0xf bank_mask:0x8
  s_nop 1
  v_mfma_f32_16x16x32_bf16 v[16:19], v[136:139], v[12:15], v[16:19]
  v_mov_b32_dpp v8, v24 row_ror:8 row_mask:0xf bank_mask:0x1
  v_mov_b32_dpp v9, v24 row_ror:12 row_mask:0xf bank_mask:0x2
  v_and_b32_dpp v25, v44, v4 quad_perm:[2,2,3,3] row_mask:0xf bank_mask:0xf
  v_mfma_f32_16x16x32_bf16 v[20:23], v[140:143], v[12:15], v[20:23]
  v_mov_b32_dpp v10, v24 quad_perm:[0,1,2,3] row_mask:0xf bank_mask:0x4
  v_mov_b32_dpp v11, v24 row_ror:4 row_mask:0xf bank_mask:0x8
  s_nop 1
  v_mfma_f32_16x16x32_bf16 v[16:19], v[144:147], v[8:11], v[16:19]
  v_mov_b32_dpp v12, v24 row_ror:4 row_mask:0xf bank_mask:0x1
  v_mov_b32_dpp v13, v24 row_ror:8 row_mask:0xf bank_mask:0x2
  v_mfma_f32_16x16x32_bf16 v[20:23], v[148:151], v[8:11], v[20:23]
  v_mov_b32_dpp v14, v24 row_ror:12 row_mask:0xf bank_mask:0x4
  v_mov_b32_dpp v15, v24 quad_perm:[0,1,2,3] row_mask:0xf bank_mask:0x8
  s_nop 1
  v_mfma_f32_16x16x32_bf16 v[16:19], v[152:155], v[12:15], v[16:19]
  v_mov_b32_dpp v8, v25 quad_perm:[0,1,2,3] row_mask:0xf bank_mask:0x1
  v_mov_b32_dpp v9, v25 row_ror:4 row_mask:0xf bank_mask:0x2
  v_mfma_f32_16x16x32_bf16 v[20:23], v[156:159], v[12:15], v[20:23]
  v_mov_b32_dpp v10, v25 row_ror:8 row_mask:0xf bank_mask:0x4
  v_mov_b32_dpp v11, v25 row_ror:12 row_mask:0xf bank_mask:0x8
  s_nop 1
  v_mfma_f32_16x16x32_bf16 v[16:19], v[160:163], v[8:11], v[16:19]
  v_mov_b32_dpp v12, v25 row_ror:12 row_mask:0xf bank_mask:0x1
  v_mov_b32_dpp v13, v25 quad_perm:[0,1,2,3] row_mask:0xf bank_mask:0x2
  v_mfma_f32_16x16x32_bf16 v[20:23], v[164:167], v[8:11], v[20:23]
  v_mov_b32_dpp v14, v25 row_ror:4 row_mask:0xf bank_mask:0x4
  v_mov_b32_dpp v15, v25 row_ror:8 row_mask:0xf bank_mask:0x8
  s_nop 1
  v_mfma_f32_16x16x32_bf16 v[16:19], v[168:171], v[12:15], v[16:19]
  v_mov_b32_dpp v8, v25 row_ror:8 row_mask:0xf bank_mask:0x1
  v_mov_b32_dpp v9, v25 row_ror:12 row_mask:0xf bank_mask:0x2
  v_and_b32_dpp v24, v45, v4 quad_perm:[0,0,1,1] row_mask:0xf bank_mask:0xf
  v_mfma_f32_16x16x32_bf16 v[20:23], v[172:175], v[12:15], v[20:23]
  v_mov_b32_dpp v10, v25 quad_perm:[0,1,2,3] row_mask:0xf bank_mask:0x4
  v_mov_b32_dpp v11, v25 row_ror:4 row_mask:0xf bank_mask:0x8
  s_nop 1
  v_mfma_f32_16x16x32_bf16 v[16:19], v[176:179], v[8:11], v[16:19]
  v_mov_b32_dpp v12, v25 row_ror:4 row_mask:0xf bank_mask:0x1
  v_mov_b32_dpp v13, v25 row_ror:8 row_mask:0xf bank_mask:0x2
  v_mfma_f32_16x16x32_bf16 v[20:23], v[180:183], v[8:11], v[20:23]
  v_mov_b32_dpp v14, v25 row_ror:12 row_mask:0xf bank_mask:0x4
  v_mov_b32_dpp v15, v25 quad_perm:[0,1,2,3] row_mask:0xf bank_mask:0x8
  s_nop 1
  v_mfma_f32_16x16x32_bf16 v[16:19], v[184:187], v[12:15], v[16:19]
  v_mov_b32_dpp v8, v24 quad_perm:[0,1,2,3] row_mask:0xf bank_mask:0x1
  v_mov_b32_dpp v9, v24 row_ror:4 row_mask:0xf bank_mask:0x2
  v_mfma_f32_16x16x32_bf16 v[20:23], v[188:191], v[12:15], v[20:23]
  v_mov_b32_dpp v10, v24 row_ror:8 row_mask:0xf bank_mask:0x4
  v_mov_b32_dpp v11, v24 row_ror:12 row_mask:0xf bank_mask:0x8
  s_nop 1
  v_mfma_f32_16x16x32_bf16 v[16:19], v[192:195], v[8:11], v[16:19]
  v_mov_b32_dpp v12, v24 row_ror:12 row_mask:0xf bank_mask:0x1
  v_mov_b32_dpp v13, v24 quad_perm:[0,1,2,3] row_mask:0xf bank_mask:0x2
  v_mfma_f32_16x16x32_bf16 v[20:23], v[196:199], v[8:11], v[20:23]
  v_mov_b32_dpp v14, v24 row_ror:4 row_mask:0xf bank_mask:0x4
  v_mov_b32_dpp v15, v24 row_ror:8 row_mask:0xf bank_mask:0x8
  s_nop 1
  v_mfma_f32_16x16x32_bf16 v[16:19], v[208:211], v[12:15], v[16:19]
  v_mov_b32_dpp v8, v24 row_ror:8 row_mask:0xf bank_mask:0x1
  v_mov_b32_dpp v9, v24 row_ror:12 row_mask:0xf bank_mask:0x2
  v_and_b32_dpp v25, v45, v4 quad_perm:[2,2,3,3] row_mask:0xf bank_mask:0xf
  v_mfma_f32_16x16x32_bf16 v[20:23], v[212:215], v[12:15], v[20:23]
  v_mov_b32_dpp v10, v24 quad_perm:[0,1,2,3] row_mask:0xf bank_mask:0x4
  v_mov_b32_dpp v11, v24 row_ror:4 row_mask:0xf bank_mask:0x8
  s_nop 1
  v_mfma_f32_16x16x32_bf16 v[16:19], a[240:243], v[8:11], v[16:19]
  v_mov_b32_dpp v12, v24 row_ror:4 row_mask:0xf bank_mask:0x1
  v_mov_b32_dpp v13, v24 row_ror:8 row_mask:0xf bank_mask:0x2
  v_mfma_f32_16x16x32_bf16 v[20:23], a[244:247], v[8:11], v[20:23]
  v_mov_b32_dpp v14, v24 row_ror:12 row_mask:0xf bank_mask:0x4
  v_mov_b32_dpp v15, v24 quad_perm:[0,1,2,3] row_mask:0xf bank_mask:0x8
  s_nop 1
  v_mfma_f32_16x16x32_bf16 v[16:19], v[216:219], v[12:15], v[16:19]
  v_mov_b32_dpp v8, v25 quad_perm:[0,1,2,3] row_mask:0xf bank_mask:0x1
  v_mov_b32_dpp v9, v25 row_ror:4 row_mask:0xf bank_mask:0x2
  v_mfma_f32_16x16x32_bf16 v[20:23], v[220:223], v[12:15], v[20:23]
  v_mov_b32_dpp v10, v25 row_ror:8 row_mask:0xf bank_mask:0x4
  v_mov_b32_dpp v11, v25 row_ror:12 row_mask:0xf bank_mask:0x8
  s_nop 1
  v_mfma_f32_16x16x32_bf16 v[16:19], v[248:251], v[8:11], v[16:19]
  v_mov_b32_dpp v12, v25 row_ror:12 row_mask:0xf bank_mask:0x1
  v_mov_b32_dpp v13, v25 quad_perm:[0,1,2,3] row_mask:0xf bank_mask:0x2
  v_mfma_f32_16x16x32_bf16 v[20:23], v[252:255], v[8:11], v[20:23]
  v_mov_b32_dpp v14, v25 row_ror:4 row_mask:0xf bank_mask:0x4
  v_mov_b32_dpp v15, v25 row_ror:8 row_mask:0xf bank_mask:0x8
  s_waitcnt vmcnt(5)
  s_nop 0
  v_mfma_f32_16x16x32_bf16 v[16:19], a[0:3], v[12:15], v[16:19]
  v_mov_b32_dpp v8, v25 row_ror:8 row_mask:0xf bank_mask:0x1
  v_mov_b32_dpp v9, v25 row_ror:12 row_mask:0xf bank_mask:0x2
  s_waitcnt vmcnt(4)
  v_mfma_f32_16x16x32_bf16 v[20:23], a[4:7], v[12:15], v[20:23]
  v_mov_b32_dpp v10, v25 quad_perm:[0,1,2,3] row_mask:0xf bank_mask:0x4
  v_mov_b32_dpp v11, v25 row_ror:4 row_mask:0xf bank_mask:0x8
  s_waitcnt vmcnt(3)
  s_nop 0
  v_mfma_f32_16x16x32_bf16 v[16:19], a[8:11], v[8:11], v[16:19]
  v_mov_b32_dpp v12, v25 row_ror:4 row_mask:0xf bank_mask:0x1
  v_mov_b32_dpp v13, v25 row_ror:8 row_mask:0xf bank_mask:0x2
  s_waitcnt vmcnt(2)
  v_mfma_f32_16x16x32_bf16 v[20:23], a[12:15], v[8:11], v[20:23]
  v_mov_b32_dpp v14, v25 row_ror:12 row_mask:0xf bank_mask:0x4
  v_mov_b32_dpp v15, v25 quad_perm:[0,1,2,3] row_mask:0xf bank_mask:0x8
  s_waitcnt vmcnt(1)
  s_nop 0
  v_mfma_f32_16x16x32_bf16 v[16:19], a[16:19], v[12:15], v[16:19]
  s_waitcnt vmcnt(0)
  v_mfma_f32_16x16x32_bf16 v[20:23], a[20:23], v[12:15], v[20:23]
  s_nop 5
  v_permlane32_swap_b32 v16, v17
  v_permlane32_swap_b32 v18, v19
  s_nop 0
  v_add_f32_dpp v8, v17, v16 quad_perm:[2,3,2,3] row_mask:0xf bank_mask:0xf
  v_add_f32_dpp v9, v18, v19 quad_perm:[0,1,0,1] row_mask:0xf bank_mask:0xf
  v_cndmask_b32_e64 v10, v8, v9, s[40:41]
  v_permlane32_swap_b32 v20, v21
  v_permlane32_swap_b32 v22, v23
  s_nop 0
  v_add_f32_dpp v11, v21, v20 quad_perm:[2,3,2,3] row_mask:0xf bank_mask:0xf
  v_add_f32_dpp v12, v22, v23 quad_perm:[0,1,0,1] row_mask:0xf bank_mask:0xf
  v_cndmask_b32_e64 v13, v11, v12, s[40:41]
  s_lshl_b32 s48, s17, 9
  s_add_u32 m0, s48, 0
  s_nop 0
  ds_write_addtid_b32 v10 offset:0
  ds_write_addtid_b32 v13 offset:256
  v_mov_b32 v8, s42
  v_mov_b32 v9, s44
  s_lshl_b32 s48, s17, 3
  s_add_u32 s48, s48, 2048
  v_mov_b32 v11, s48
  ds_write_b64 v11, v[8:9]
  s_waitcnt lgkmcnt(0)
  s_barrier
  v_mov_b32 v11, 2048
  ds_read_b128 v[16:19], v11
  ds_read_b128 v[20:23], v11 offset:16
  s_and_b32 s48, s17, 1
  s_lshl_b32 s48, s48, 8
  s_add_u32 m0, s48, 0
  s_nop 0
  ds_read_addtid_b32 v12 offset:0
  ds_read_addtid_b32 v13 offset:512
  ds_read_addtid_b32 v14 offset:1024
  ds_read_addtid_b32 v15 offset:1536
  s_waitcnt lgkmcnt(4)
  v_max3_f32 v8, v16, v18, v20
  v_max_f32 v8, v8, v22
  v_sub_f32 v16, v16, v8
  v_mul_f32 v16, s28, v16
  v_sub_f32 v18, v18, v8
  v_mul_f32 v18, s28, v18
  v_sub_f32 v20, v20, v8
  v_mul_f32 v20, s28, v20
  v_sub_f32 v22, v22, v8
  v_mul_f32 v22, s28, v22
  v_exp_f32 v16, v16
  v_exp_f32 v18, v18
  v_exp_f32 v20, v20
  v_exp_f32 v22, v22
  v_mul_f32 v9, v16, v17
  v_fmac_f32 v9, v18, v19
  v_fmac_f32 v9, v20, v21
  v_fmac_f32 v9, v22, v23
  v_mul_f32 v8, s28, v8
  s_waitcnt lgkmcnt(0)
  v_mul_f32 v10, v16, v12
  v_fmac_f32 v10, v18, v13
  v_fmac_f32 v10, v20, v14
  v_fmac_f32 v10, v22, v15
  v_cndmask_b32_e64 v8, v8, v9, s[62:63]
  s_cmp_lt_u32 s17, 2
  s_cselect_b64 vcc, -1, 0
  v_cndmask_b32 v10, v8, v10, vcc
  v_mov_b32 v11, s16
  s_add_u32 s48, s47, 0x100000
  buffer_store_dwordx2 v[10:11], v6, s[4:7], s48 offen sc1
  s_barrier
  s_waitcnt vmcnt(0)
  s_branch L_end
L_chain:
  s_lshr_b32 s18, s2, 3
  s_load_dwordx2 s[60:61], s[0:1], 0
  s_load_dwordx2 s[62:63], s[0:1], 24
  s_load_dwordx2 s[64:65], s[0:1], 32
  s_load_dwordx2 s[66:67], s[0:1], 48
  s_load_dwordx2 s[68:69], s[0:1], 56
  s_load_dwordx2 s[70:71], s[0:1], 64
  s_load_dwordx2 s[72:73], s[0:1], 72
  s_load_dwordx2 s[74:75], s[0:1], 80
  v_bfe_u32 v30, v0, 2, 2
  v_lshlrev_b32 v2, 3, v30
  v_lshrrev_b32 v30, 4, v0
  v_lshl_add_u32 v2, v30, 1, v2
  v_bfe_u32 v30, v0, 1, 1
  v_add_u32 v2, v2, v30
  v_lshlrev_b32 v2, 3, v2
  s_mul_i32 s49, s17, 1179648
  s_lshl_b32 s40, s18, 8
  s_add_u32 s49, s49, s40
  s_mul_i32 s54, s17, 28672
  s_add_u32 s54, s54, 10240
  s_waitcnt lgkmcnt(0)
  s_mov_b32 s12, s60
  s_and_b32 s13, s61, 0xffff
  s_mov_b32 s14, 0x900
  s_mov_b32 s15, 0x00020000
  v_lshlrev_b32 v20, 2, v0
  v_lshrrev_b32 v21, 2, v2
  s_mul_i32 s41, s17, 288
  buffer_load_dword v30, v20, s[12:15], 0 offen offset:1152
  buffer_load_dword v31, v20, s[12:15], 0 offen offset:1408
  buffer_load_dword v32, v20, s[12:15], 0 offen offset:1664
  buffer_load_dword v33, v20, s[12:15], 0 offen offset:1920
  buffer_load_dword v34, v20, s[12:15], 0 offen offset:2176
  buffer_load_ushort v10, v21, s[12:15], s41 offen offset:1152
  buffer_load_ushort v11, v21, s[12:15], s41 offen offset:1216
  buffer_load_ushort v12, v21, s[12:15], s41 offen offset:1280
  buffer_load_ushort v13, v21, s[12:15], s41 offen offset:1344
  buffer_load_ushort v14, v21, s[12:15], s41 offen offset:1408
  buffer_load_dword v35, v20, s[12:15], 0 offen offset:0
  buffer_load_dword v36, v20, s[12:15], 0 offen offset:256
  buffer_load_dword v37, v20, s[12:15], 0 offen offset:512
  buffer_load_dword v38, v20, s[12:15], 0 offen offset:768
  buffer_load_dword v39, v20, s[12:15], 0 offen offset:1024
  buffer_load_ushort v15, v21, s[12:15], s41 offen offset:0
  buffer_load_ushort v16, v21, s[12:15], s41 offen offset:64
  buffer_load_ushort v17, v21, s[12:15], s41 offen offset:128
  buffer_load_ushort v18, v21, s[12:15], s41 offen offset:192
  buffer_load_ushort v19, v21, s[12:15], s41 offen offset:256
  s_mov_b32 s8, s62
  s_and_b32 s9, s63, 0xffff
  s_mov_b32 s10, 0x480000
  s_mov_b32 s11, 0x00020000
  v_lshrrev_b32 v27, 4, v0
  v_bfe_u32 v28, v0, 3, 1
  v_lshl_add_u32 v27, v27, 1, v28
  v_mul_u32_u24 v26, 8192, v27
  v_and_b32 v28, 7, v0
  v_lshl_add_u32 v26, v28, 4, v26
  s_add_u32 m0, s54, 0x0
  s_add_u32 s48, s49, 0x0
  buffer_load_dwordx4 v26, s[8:11], s48 offen nt lds
  s_add_u32 m0, s54, 0x400
  s_add_u32 s48, s49, 0x80
  buffer_load_dwordx4 v26, s[8:11], s48 offen nt lds
  s_add_u32 m0, s54, 0x800
  s_add_u32 s48, s49, 0x10000
  buffer_load_dwordx4 v26, s[8:11], s48 offen nt lds
  s_add_u32 m0, s54, 0xc00
  s_add_u32 s48, s49, 0x10080
  buffer_load_dwordx4 v26, s[8:11], s48 offen nt lds
  s_add_u32 m0, s54, 0x1000
  s_add_u32 s48, s49, 0x20000
  buffer_load_dwordx4 v26, s[8:11], s48 offen nt lds
  s_add_u32 m0, s54, 0x1400
  s_add_u32 s48, s49, 0x20080
  buffer_load_dwordx4 v26, s[8:11], s48 offen nt lds
  s_add_u32 m0, s54, 0x1800
  s_add_u32 s48, s49, 0x30000
  buffer_load_dwordx4 v26, s[8:11], s48 offen nt lds
  s_add_u32 m0, s54, 0x1c00
  s_add_u32 s48, s49, 0x30080
  buffer_load_dwordx4 v26, s[8:11], s48 offen nt lds
  s_add_u32 m0, s54, 0x2000
  s_add_u32 s48, s49, 0x40000
  buffer_load_dwordx4 v26, s[8:11], s48 offen nt lds
  s_add_u32 m0, s54, 0x2400
  s_add_u32 s48, s49, 0x40080
  buffer_load_dwordx4 v26, s[8:11], s48 offen nt lds
  s_add_u32 m0, s54, 0x2800
  s_add_u32 s48, s49, 0x50000
  buffer_load_dwordx4 v26, s[8:11], s48 offen nt lds
  s_add_u32 m0, s54, 0x2c00
  s_add_u32 s48, s49, 0x50080
  buffer_load_dwordx4 v26, s[8:11], s48 offen nt lds
  s_add_u32 m0, s54, 0x3000
  s_add_u32 s48, s49, 0x60000
  buffer_load_dwordx4 v26, s[8:11], s48 offen nt lds
  s_add_u32 m0, s54, 0x3400
  s_add_u32 s48, s49, 0x60080
  buffer_load_dwordx4 v26, s[8:11], s48 offen nt lds
  s_add_u32 m0, s54, 0x3800
  s_add_u32 s48, s49, 0x70000
  buffer_load_dwordx4 v26, s[8:11], s48 offen nt lds
  s_add_u32 m0, s54, 0x3c00
  s_add_u32 s48, s49, 0x70080
  buffer_load_dwordx4 v26, s[8:11], s48 offen nt lds
  s_add_u32 m0, s54, 0x4000
  s_add_u32 s48, s49, 0x80000
  buffer_load_dwordx4 v26, s[8:11], s48 offen nt lds
  s_add_u32 m0, s54, 0x4400
  s_add_u32 s48, s49, 0x80080
  buffer_load_dwordx4 v26, s[8:11], s48 offen nt lds
  s_add_u32 m0, s54, 0x4800
  s_add_u32 s48, s49, 0x90000
  buffer_load_dwordx4 v26, s[8:11], s48 offen nt lds
  s_add_u32 m0, s54, 0x4c00
  s_add_u32 s48, s49, 0x90080
  buffer_load_dwordx4 v26, s[8:11], s48 offen nt lds
  s_add_u32 m0, s54, 0x5000
  s_add_u32 s48, s49, 0xa0000
  buffer_load_dwordx4 v26, s[8:11], s48 offen nt lds
  s_add_u32 m0, s54, 0x5400
  s_add_u32 s48, s49, 0xa0080
  buffer_load_dwordx4 v26, s[8:11], s48 offen nt lds
  s_add_u32 m0, s54, 0x5800
  s_add_u32 s48, s49, 0xb0000
  buffer_load_dwordx4 v26, s[8:11], s48 offen nt lds
  s_add_u32 m0, s54, 0x5c00
  s_add_u32 s48, s49, 0xb0080
  buffer_load_dwordx4 v26, s[8:11], s48 offen nt lds
  s_add_u32 m0, s54, 0x6000
  s_add_u32 s48, s49, 0xc0000
  buffer_load_dwordx4 v26, s[8:11], s48 offen nt lds
  s_add_u32 m0, s54, 0x6400
  s_add_u32 s48, s49, 0xc0080
  buffer_load_dwordx4 v26, s[8:11], s48 offen nt lds
  s_add_u32 m0, s54, 0x6800
  s_add_u32 s48, s49, 0xd0000
  buffer_load_dwordx4 v26, s[8:11], s48 offen nt lds
  s_add_u32 m0, s54, 0x6c00
  s_add_u32 s48, s49, 0xd0080
  buffer_load_dwordx4 v26, s[8:11], s48 offen nt lds
  s_add_u32 s48, s49, 0xe0000
  buffer_load_dwordx4 v[48:51], v26, s[8:11], s48 offen nt
  s_add_u32 s48, s49, 0xe0080
  buffer_load_dwordx4 v[52:55], v26, s[8:11], s48 offen nt
  s_add_u32 s48, s49, 0xf0000
  buffer_load_dwordx4 v[56:59], v26, s[8:11], s48 offen nt
  s_add_u32 s48, s49, 0xf0080
  buffer_load_dwordx4 v[60:63], v26, s[8:11], s48 offen nt
  s_add_u32 s48, s49, 0x100000
  buffer_load_dwordx4 v[64:67], v26, s[8:11], s48 offen nt
  s_add_u32 s48, s49, 0x100080
  buffer_load_dwordx4 v[68:71], v26, s[8:11], s48 offen nt
  s_add_u32 s48, s49, 0x110000
  buffer_load_dwordx4 v[72:75], v26, s[8:11], s48 offen nt
  s_add_u32 s48, s49, 0x110080
  buffer_load_dwordx4 v[76:79], v26, s[8:11], s48 offen nt
  s_getpc_b64 s[92:93]
L_pc_L_chain:
  v_lshlrev_b32 v20, 4, v0
  s_lshl_b32 s94, s17, 10
  v_add_u32 v20, s94, v20
  v_min_u32 v21, L_end-L_pc_L_chain-16, v20
  global_load_dwordx4 a[252:255], v21, s[92:93]
  v_add_u32 v20, 0x1000, v20
  v_min_u32 v21, L_end-L_pc_L_chain-16, v20
  global_load_dwordx4 a[252:255], v21, s[92:93]
  v_add_u32 v20, 0x1000, v20
  v_min_u32 v21, L_end-L_pc_L_chain-16, v20
  global_load_dwordx4 a[252:255], v21, s[92:93]
  v_add_u32 v20, 0x1000, v20
  v_min_u32 v21, L_end-L_pc_L_chain-16, v20
  global_load_dwordx4 a[252:255], v21, s[92:93]
  v_add_u32 v20, 0x1000, v20
  v_min_u32 v21, L_end-L_pc_L_chain-16, v20
  global_load_dwordx4 a[252:255], v21, s[92:93]
  v_add_u32 v20, 0x1000, v20
  s_mov_b32 s30, 0xcccccccc
  s_mov_b32 s31, 0xcccccccc
  s_mov_b32 s32, 0xaaaaaaaa
  s_mov_b32 s33, 0xaaaaaaaa
  s_mov_b32 s34, 0xffffffff
  s_mov_b32 s35, 0xf
  s_mov_b32 s36, 0xff00ff
  s_mov_b32 s37, 0xff00ff
  s_mov_b32 s76, 0x80808080
  s_mov_b32 s77, 0x80808080
  s_mov_b32 s100, 0xffffffff
  s_mov_b32 s101, 0x0
  s_and_b32 s40, s17, 1
  s_cmp_eq_u32 s40, 1
  s_mov_b32 s38, 0x33333333
  s_cselect_b32 s38, 0xcccccccc, s38
  s_mov_b32 s39, s38
  s_mov_b32 s28, 0
  s_mov_b32 s58, s17
  s_mul_i32 s50, s18, 147456
  s_mul_i32 s40, s17, 36864
  s_add_u32 s50, s50, s40
  s_mul_i32 s51, s17, 1327104
  s_lshl_b32 s41, s18, 5
  s_add_u32 s96, s51, s41
  s_add_u32 s96, s96, 8192
  s_lshl_b32 s41, s18, 8
  s_add_u32 s51, s51, s41
  s_mul_i32 s52, s18, 147456
  s_lshr_b32 s41, s17, 1
  s_mul_i32 s53, s41, 9216
  s_mul_i32 s42, s18, 18432
  s_add_u32 s53, s53, s42
  s_add_u32 s53, s53, 4718592
  s_add_u32 s52, s52, s40
  s_mul_i32 s55, s17, 5120
  s_add_u32 s55, s55, 124928
  s_mul_i32 s78, s41, 9216
  s_add_u32 s78, s78, 145408
  s_and_b32 s41, s17, 1
  s_mul_i32 s42, s41, 5120
  s_add_u32 s78, s78, s42
  s_mul_i32 s42, s41, 640
  s_add_u32 s53, s53, s42
  v_and_b32 v22, 1, v0
  v_lshlrev_b32 v22, 4, v22
  v_mov_b32 v23, 0xffff
  v_lshlrev_b32 v1, v22, v23
  v_bfe_u32 v22, v0, 4, 1
  v_lshlrev_b32 v3, 5, v22
  v_bfe_u32 v22, v0, 1, 1
  v_lshl_add_u32 v3, v22, 4, v3
  v_lshrrev_b32 v22, 5, v0
  v_lshl_add_u32 v3, v22, 3, v3
  v_bfe_u32 v22, v0, 2, 2
  v_lshl_add_u32 v3, v22, 1, v3
  v_and_b32 v22, 1, v0
  v_add_u32 v3, v3, v22
  v_lshlrev_b32 v3, 3, v3
  s_mov_b32 s99, s16
  s_mul_i32 s16, s16, 0x9e3779b1
  s_add_u32 s16, s16, 0x85ebca6b
  s_getreg_b32 s40, hwreg(HW_REG_XCC_ID)
  s_and_b32 s40, s40, 15
  s_mov_b32 s79, s40
  v_mov_b32 v22, s40
  v_mov_b32 v23, s16
  s_lshl_b32 s40, s18, 3
  s_add_u32 s40, s40, 0x100
  v_mov_b32 v24, 0
  buffer_store_dwordx2 v[22:23], v24, s[4:7], s40 offen sc1
  s_waitcnt vmcnt(42)
  v_cndmask_b32_e64 v34, 0, v34, s[100:101]
  v_lshlrev_b32 v47, 16, v30
  v_and_b32 v30, 0xffff0000, v30
  v_add_f32 v40, v47, v30
  v_mul_f32 v41, v47, v47
  v_fmac_f32 v41, v30, v30
  v_lshlrev_b32 v47, 16, v31
  v_and_b32 v31, 0xffff0000, v31
  v_add_f32 v40, v40, v47
  v_fmac_f32 v41, v47, v47
  v_add_f32 v40, v40, v31
  v_fmac_f32 v41, v31, v31
  v_lshlrev_b32 v47, 16, v32
  v_and_b32 v32, 0xffff0000, v32
  v_add_f32 v40, v40, v47
  v_fmac_f32 v41, v47, v47
  v_add_f32 v40, v40, v32
  v_fmac_f32 v41, v32, v32
  v_lshlrev_b32 v47, 16, v33
  v_and_b32 v33, 0xffff0000, v33
  v_add_f32 v40, v40, v47
  v_fmac_f32 v41, v47, v47
  v_add_f32 v40, v40, v33
  v_fmac_f32 v41, v33, v33
  v_lshlrev_b32 v47, 16, v34
  v_and_b32 v34, 0xffff0000, v34
  v_add_f32 v40, v40, v47
  v_fmac_f32 v41, v47, v47
  v_add_f32 v40, v40, v34
  v_fmac_f32 v41, v34, v34
  s_nop 0
  v_add_f32_dpp v40, v40, v40 quad_perm:[1,0,3,2] row_mask:0xf bank_mask:0xf
  v_add_f32_dpp v41, v41, v41 quad_perm:[1,0,3,2] row_mask:0xf bank_mask:0xf
  v_cndmask_b32_e64 v40, v40, v41, s[32:33]
  s_nop 1
  v_add_f32_dpp v40, v40, v40 row_ror:2 row_mask:0xf bank_mask:0xf
  s_nop 1
  v_add_f32_dpp v40, v40, v40 row_ror:4 row_mask:0xf bank_mask:0xf
  s_nop 1
  v_add_f32_dpp v40, v40, v40 row_ror:8 row_mask:0xf bank_mask:0xf
  v_mov_b32 v47, v40
  s_nop 1
  v_permlane16_swap_b32 v40, v47
  v_add_f32 v40, v40, v47
  v_mov_b32 v47, v40
  s_nop 1
  v_permlane32_swap_b32 v40, v47
  v_add_f32 v40, v40, v47
  v_lshlrev_b32 v10, 16, v10
  v_lshlrev_b32 v11, 16, v11
  v_lshlrev_b32 v12, 16, v12
  v_lshlrev_b32 v13, 16, v13
  v_lshlrev_b32 v14, 16, v14
  v_mov_b32_dpp v41, v40 quad_perm:[0,0,2,2] row_mask:0xf bank_mask:0xf
  v_mov_b32_dpp v47, v40 quad_perm:[1,1,3,3] row_mask:0xf bank_mask:0xf
  v_mul_f32 v41, 0x3ae38e39, v41
  v_mul_f32 v47, 0x3ae38e39, v47
  v_fma_f32 v47, -v41, v41, v47
  v_max_f32 v47, 0, v47
  v_cvt_pk_bf16_f32 v41, v41, v41
  v_and_b32 v41, 0xffff0000, v41
  v_cvt_pk_bf16_f32 v47, v47, v47
  v_sub_f32 v10, v10, v41
  v_sub_f32 v11, v11, v41
  v_and_b32 v47, 0xffff0000, v47
  v_sub_f32 v12, v12, v41
  v_sub_f32 v13, v13, v41
  v_add_f32 v47, 0x3727c5ac, v47
  v_sub_f32 v14, v14, v41
  v_cvt_pk_bf16_f32 v10, v10, v10
  v_cvt_pk_bf16_f32 v47, v47, v47
  v_cvt_pk_bf16_f32 v11, v11, v11
  v_cvt_pk_bf16_f32 v12, v12, v12
  v_and_b32 v47, 0xffff0000, v47
  v_cvt_pk_bf16_f32 v13, v13, v13
  v_cvt_pk_bf16_f32 v14, v14, v14
  v_sqrt_f32 v47, v47
  v_and_b32 v10, 0xffff0000, v10
  v_and_b32 v11, 0xffff0000, v11
  v_cvt_pk_bf16_f32 v47, v47, v47
  v_and_b32 v12, 0xffff0000, v12
  v_and_b32 v13, 0xffff0000, v13
  v_and_b32 v47, 0xffff0000, v47
  v_and_b32 v14, 0xffff0000, v14
  v_rcp_f32 v47, v47
  s_nop 0
  v_mul_f32 v10, v10, v47
  v_mul_f32 v11, v11, v47
  v_mul_f32 v12, v12, v47
  v_mul_f32 v13, v13, v47
  v_mul_f32 v14, v14, v47
  v_cvt_pk_bf16_f32 v10, v10, v10
  v_cvt_pk_bf16_f32 v11, v11, v11
  v_cvt_pk_bf16_f32 v12, v12, v12
  v_cvt_pk_bf16_f32 v13, v13, v13
  v_cvt_pk_bf16_f32 v14, v14, v14
  v_and_b32 v42, v10, v1
  v_and_b32 v43, v11, v1
  v_and_b32 v44, v12, v1
  v_and_b32 v45, v13, v1
  v_and_b32 v46, v14, v1
  v_cndmask_b32_e64 v39, 0, v39, s[100:101]
  v_lshlrev_b32 v47, 16, v35
  v_and_b32 v35, 0xffff0000, v35
  v_add_f32 v40, v47, v35
  v_mul_f32 v41, v47, v47
  v_fmac_f32 v41, v35, v35
  v_lshlrev_b32 v47, 16, v36
  v_and_b32 v36, 0xffff0000, v36
  v_add_f32 v40, v40, v47
  v_fmac_f32 v41, v47, v47
  v_add_f32 v40, v40, v36
  v_fmac_f32 v41, v36, v36
  v_lshlrev_b32 v47, 16, v37
  v_and_b32 v37, 0xffff0000, v37
  v_add_f32 v40, v40, v47
  v_fmac_f32 v41, v47, v47
  v_add_f32 v40, v40, v37
  v_fmac_f32 v41, v37, v37
  v_lshlrev_b32 v47, 16, v38
  v_and_b32 v38, 0xffff0000, v38
  v_add_f32 v40, v40, v47
  v_fmac_f32 v41, v47, v47
  v_add_f32 v40, v40, v38
  v_fmac_f32 v41, v38, v38
  v_lshlrev_b32 v47, 16, v39
  v_and_b32 v39, 0xffff0000, v39
  v_add_f32 v40, v40, v47
  v_fmac_f32 v41, v47, v47
  v_add_f32 v40, v40, v39
  v_fmac_f32 v41, v39, v39
  s_nop 0
  v_add_f32_dpp v40, v40, v40 quad_perm:[1,0,3,2] row_mask:0xf bank_mask:0xf
  v_add_f32_dpp v41, v41, v41 quad_perm:[1,0,3,2] row_mask:0xf bank_mask:0xf
  v_cndmask_b32_e64 v40, v40, v41, s[32:33]
  s_nop 1
  v_add_f32_dpp v40, v40, v40 row_ror:2 row_mask:0xf bank_mask:0xf
  s_nop 1
  v_add_f32_dpp v40, v40, v40 row_ror:4 row_mask:0xf bank_mask:0xf
  s_nop 1
  v_add_f32_dpp v40, v40, v40 row_ror:8 row_mask:0xf bank_mask:0xf
  v_mov_b32 v47, v40
  s_nop 1
  v_permlane16_swap_b32 v40, v47
  v_add_f32 v40, v40, v47
  v_mov_b32 v47, v40
  s_nop 1
  v_permlane32_swap_b32 v40, v47
  v_add_f32 v40, v40, v47
  v_lshlrev_b32 v15, 16, v15
  v_lshlrev_b32 v16, 16, v16
  v_lshlrev_b32 v17, 16, v17
  v_lshlrev_b32 v18, 16, v18
  v_lshlrev_b32 v19, 16, v19
  v_mov_b32_dpp v41, v40 quad_perm:[0,0,2,2] row_mask:0xf bank_mask:0xf
  v_mov_b32_dpp v47, v40 quad_perm:[1,1,3,3] row_mask:0xf bank_mask:0xf
  v_mul_f32 v41, 0x3ae38e39, v41
  v_mul_f32 v47, 0x3ae38e39, v47
  v_fma_f32 v47, -v41, v41, v47
  v_max_f32 v47, 0, v47
  v_cvt_pk_bf16_f32 v41, v41, v41
  v_and_b32 v41, 0xffff0000, v41
  v_cvt_pk_bf16_f32 v47, v47, v47
  v_sub_f32 v15, v15, v41
  v_sub_f32 v16, v16, v41
  v_and_b32 v47, 0xffff0000, v47
  v_sub_f32 v17, v17, v41
  v_sub_f32 v18, v18, v41
  v_add_f32 v47, 0x3727c5ac, v47
  v_sub_f32 v19, v19, v41
  v_cvt_pk_bf16_f32 v15, v15, v15
  v_cvt_pk_bf16_f32 v47, v47, v47
  v_cvt_pk_bf16_f32 v16, v16, v16
  v_cvt_pk_bf16_f32 v17, v17, v17
  v_and_b32 v47, 0xffff0000, v47
  v_cvt_pk_bf16_f32 v18, v18, v18
  v_cvt_pk_bf16_f32 v19, v19, v19
  v_sqrt_f32 v47, v47
  v_and_b32 v15, 0xffff0000, v15
  v_and_b32 v16, 0xffff0000, v16
  v_cvt_pk_bf16_f32 v47, v47, v47
  v_and_b32 v17, 0xffff0000, v17
  v_and_b32 v18, 0xffff0000, v18
  v_and_b32 v47, 0xffff0000, v47
  v_and_b32 v19, 0xffff0000, v19
  v_rcp_f32 v47, v47
  s_nop 0
  v_mul_f32 v15, v15, v47
  v_mul_f32 v16, v16, v47
  v_mul_f32 v17, v17, v47
  v_mul_f32 v18, v18, v47
  v_mul_f32 v19, v19, v47
  v_cvt_pk_bf16_f32 v15, v15, v15
  v_cvt_pk_bf16_f32 v16, v16, v16
  v_cvt_pk_bf16_f32 v17, v17, v17
  v_cvt_pk_bf16_f32 v18, v18, v18
  v_cvt_pk_bf16_f32 v19, v19, v19
  v_and_b32 v5, v15, v1
  v_and_b32 v6, v16, v1
  v_and_b32 v7, v17, v1
  v_and_b32 v8, v18, v1
  v_and_b32 v9, v19, v1
  s_mov_b32 s8, s64
  s_and_b32 s9, s65, 0xffff
  s_mov_b32 s10, 0x480000
  s_mov_b32 s11, 0x00020000
  v_lshrrev_b32 v27, 4, v0
  v_bfe_u32 v28, v0, 3, 1
  v_lshl_add_u32 v27, v27, 1, v28
  v_mul_u32_u24 v26, 1152, v27
  v_and_b32 v28, 7, v0
  v_lshl_add_u32 v26, v28, 4, v26
  s_add_u32 s48, s50, 0x0
  buffer_load_dwordx4 v[80:83], v26, s[8:11], s48 offen nt
  s_add_u32 s48, s50, 0x80
  buffer_load_dwordx4 v[84:87], v26, s[8:11], s48 offen nt
  s_add_u32 s48, s50, 0x100
  buffer_load_dwordx4 v[88:91], v26, s[8:11], s48 offen nt
  s_add_u32 s48, s50, 0x180
  buffer_load_dwordx4 v[92:95], v26, s[8:11], s48 offen nt
  s_add_u32 s48, s50, 0x200
  buffer_load_dwordx4 v[96:99], v26, s[8:11], s48 offen nt
  s_add_u32 s48, s50, 0x280
  buffer_load_dwordx4 v[100:103], v26, s[8:11], s48 offen nt
  s_add_u32 s48, s50, 0x300
  buffer_load_dwordx4 v[104:107], v26, s[8:11], s48 offen nt
  s_add_u32 s48, s50, 0x380
  buffer_load_dwordx4 v[108:111], v26, s[8:11], s48 offen nt
  s_add_u32 s48, s50, 0x400
  buffer_load_dwordx4 v[112:115], v26, s[8:11], s48 offen nt
  s_add_u32 s48, s50, 0x2400
  buffer_load_dwordx4 v[116:119], v26, s[8:11], s48 offen nt
  s_add_u32 s48, s50, 0x2480
  buffer_load_dwordx4 v[120:123], v26, s[8:11], s48 offen nt
  s_add_u32 s48, s50, 0x2500
  buffer_load_dwordx4 v[124:127], v26, s[8:11], s48 offen nt
  s_add_u32 s48, s50, 0x2580
  buffer_load_dwordx4 v[128:131], v26, s[8:11], s48 offen nt
  s_add_u32 s48, s50, 0x2600
  buffer_load_dwordx4 v[132:135], v26, s[8:11], s48 offen nt
  s_add_u32 s48, s50, 0x2680
  buffer_load_dwordx4 v[136:139], v26, s[8:11], s48 offen nt
  s_add_u32 s48, s50, 0x2700
  buffer_load_dwordx4 v[140:143], v26, s[8:11], s48 offen nt
  s_add_u32 s48, s50, 0x2780
  buffer_load_dwordx4 v[144:147], v26, s[8:11], s48 offen nt
  s_add_u32 s48, s50, 0x2800
  buffer_load_dwordx4 v[148:151], v26, s[8:11], s48 offen nt
  s_add_u32 s48, s50, 0x4800
  buffer_load_dwordx4 v[152:155], v26, s[8:11], s48 offen nt
  s_add_u32 s48, s50, 0x4880
  buffer_load_dwordx4 v[156:159], v26, s[8:11], s48 offen nt
  v_mov_b32 v10, 0
  v_mov_b32 v11, 0
  v_mov_b32 v12, 0
  v_mov_b32 v13, 0
  v_mov_b32 v14, 0
  v_mov_b32 v15, 0
  v_mov_b32 v16, 0
  v_mov_b32 v17, 0
  s_waitcnt vmcnt(26)
  s_lshl_b32 s25, s18, 9
  s_add_u32 s25, s25, 0x5000
  s_mul_i32 s40, s17, 28672
  s_add_u32 s40, s40, 10240
  v_lshlrev_b32 v47, 4, v0
  v_add_u32 v47, s40, v47
  ds_read_b128 v[18:21], v47 offset:0
  ds_read_b128 v[22:25], v47 offset:1024
  ds_read_b128 v[26:29], v47 offset:2048
  v_mov_b32_dpp v10, v42 quad_perm:[0,1,2,3] row_mask:0xf bank_mask:0x1
  v_mov_b32_dpp v11, v42 row_ror:4 row_mask:0xf bank_mask:0x2
  v_mov_b32_dpp v12, v42 row_ror:8 row_mask:0xf bank_mask:0x4
  v_mov_b32_dpp v13, v42 row_ror:12 row_mask:0xf bank_mask:0x8
  s_waitcnt lgkmcnt(2)
  s_nop 0
  v_mfma_f32_16x16x32_bf16 v[30:33], v[18:21], v[10:13], 0
  ds_read_b128 v[18:21], v47 offset:3072
  v_mov_b32_dpp v14, v42 row_ror:12 row_mask:0xf bank_mask:0x1
  v_mov_b32_dpp v15, v42 quad_perm:[0,1,2,3] row_mask:0xf bank_mask:0x2
  s_waitcnt lgkmcnt(2)
  v_mfma_f32_16x16x32_bf16 v[34:37], v[22:25], v[10:13], 0
  ds_read_b128 v[22:25], v47 offset:4096
  v_mov_b32_dpp v16, v42 row_ror:4 row_mask:0xf bank_mask:0x4
  v_mov_b32_dpp v17, v42 row_ror:8 row_mask:0xf bank_mask:0x8
  s_waitcnt lgkmcnt(2)
  s_nop 0
  v_mfma_f32_16x16x32_bf16 v[30:33], v[26:29], v[14:17], v[30:33]
  ds_read_b128 v[26:29], v47 offset:5120
  v_mov_b32_dpp v10, v42 row_ror:8 row_mask:0xf bank_mask:0x1
  v_mov_b32_dpp v11, v42 row_ror:12 row_mask:0xf bank_mask:0x2
  s_waitcnt lgkmcnt(2)
  v_mfma_f32_16x16x32_bf16 v[34:37], v[18:21], v[14:17], v[34:37]
  ds_read_b128 v[18:21], v47 offset:6144
  v_mov_b32_dpp v12, v42 quad_perm:[0,1,2,3] row_mask:0xf bank_mask:0x4
  v_mov_b32_dpp v13, v42 row_ror:4 row_mask:0xf bank_mask:0x8
  s_waitcnt lgkmcnt(2)
  s_nop 0
  v_mfma_f32_16x16x32_bf16 v[30:33], v[22:25], v[10:13], v[30:33]
  ds_read_b128 v[22:25], v47 offset:7168
  v_mov_b32_dpp v14, v42 row_ror:4 row_mask:0xf bank_mask:0x1
  v_mov_b32_dpp v15, v42 row_ror:8 row_mask:0xf bank_mask:0x2
  s_waitcnt lgkmcnt(2)
  v_mfma_f32_16x16x32_bf16 v[34:37], v[26:29], v[10:13], v[34:37]
  ds_read_b128 v[26:29], v47 offset:8192
  v_mov_b32_dpp v16, v42 row_ror:12 row_mask:0xf bank_mask:0x4
  v_mov_b32_dpp v17, v42 quad_perm:[0,1,2,3] row_mask:0xf bank_mask:0x8
  s_waitcnt lgkmcnt(2)
  s_nop 0
  v_mfma_f32_16x16x32_bf16 v[30:33], v[18:21], v[14:17], v[30:33]
  ds_read_b128 v[18:21], v47 offset:9216
  v_mov_b32_dpp v10, v43 quad_perm:[0,1,2,3] row_mask:0xf bank_mask:0x1
  v_mov_b32_dpp v11, v43 row_ror:4 row_mask:0xf bank_mask:0x2
  s_waitcnt lgkmcnt(2)
  v_mfma_f32_16x16x32_bf16 v[34:37], v[22:25], v[14:17], v[34:37]
  ds_read_b128 v[22:25], v47 offset:10240
  v_mov_b32_dpp v12, v43 row_ror:8 row_mask:0xf bank_mask:0x4
  v_mov_b32_dpp v13, v43 row_ror:12 row_mask:0xf bank_mask:0x8
  s_waitcnt lgkmcnt(2)
  s_nop 0
  v_mfma_f32_16x16x32_bf16 v[30:33], v[26:29], v[10:13], v[30:33]
  ds_read_b128 v[26:29], v47 offset:11264
  v_mov_b32_dpp v14, v43 row_ror:12 row_mask:0xf bank_mask:0x1
  v_mov_b32_dpp v15, v43 quad_perm:[0,1,2,3] row_mask:0xf bank_mask:0x2
  s_waitcnt lgkmcnt(2)
  v_mfma_f32_16x16x32_bf16 v[34:37], v[18:21], v[10:13], v[34:37]
  ds_read_b128 v[18:21], v47 offset:12288
  v_mov_b32_dpp v16, v43 row_ror:4 row_mask:0xf bank_mask:0x4
  v_mov_b32_dpp v17, v43 row_ror:8 row_mask:0xf bank_mask:0x8
  s_waitcnt lgkmcnt(2)
  s_nop 0
  v_mfma_f32_16x16x32_bf16 v[30:33], v[22:25], v[14:17], v[30:33]
  ds_read_b128 v[22:25], v47 offset:13312
  v_mov_b32_dpp v10, v43 row_ror:8 row_mask:0xf bank_mask:0x1
  v_mov_b32_dpp v11, v43 row_ror:12 row_mask:0xf bank_mask:0x2
  s_waitcnt lgkmcnt(2)
  v_mfma_f32_16x16x32_bf16 v[34:37], v[26:29], v[14:17], v[34:37]
  ds_read_b128 v[26:29], v47 offset:14336
  v_mov_b32_dpp v12, v43 quad_perm:[0,1,2,3] row_mask:0xf bank_mask:0x4
  v_mov_b32_dpp v13, v43 row_ror:4 row_mask:0xf bank_mask:0x8
  s_waitcnt lgkmcnt(2)
  s_nop 0
  v_mfma_f32_16x16x32_bf16 v[30:33], v[18:21], v[10:13], v[30:33]
  ds_read_b128 v[18:21], v47 offset:15360
  v_mov_b32_dpp v14, v43 row_ror:4 row_mask:0xf bank_mask:0x1
  v_mov_b32_dpp v15, v43 row_ror:8 row_mask:0xf bank_mask:0x2
  s_waitcnt lgkmcnt(2)
  v_mfma_f32_16x16x32_bf16 v[34:37], v[22:25], v[10:13], v[34:37]
  ds_read_b128 v[22:25], v47 offset:16384
  v_mov_b32_dpp v16, v43 row_ror:12 row_mask:0xf bank_mask:0x4
  v_mov_b32_dpp v17, v43 quad_perm:[0,1,2,3] row_mask:0xf bank_mask:0x8
  s_waitcnt lgkmcnt(2)
  s_nop 0
  v_mfma_f32_16x16x32_bf16 v[30:33], v[26:29], v[14:17], v[30:33]
  ds_read_b128 v[26:29], v47 offset:17408
  v_mov_b32_dpp v10, v44 quad_perm:[0,1,2,3] row_mask:0xf bank_mask:0x1
  v_mov_b32_dpp v11, v44 row_ror:4 row_mask:0xf bank_mask:0x2
  s_waitcnt lgkmcnt(2)
  v_mfma_f32_16x16x32_bf16 v[34:37], v[18:21], v[14:17], v[34:37]
  ds_read_b128 v[18:21], v47 offset:18432
  v_mov_b32_dpp v12, v44 row_ror:8 row_mask:0xf bank_mask:0x4
  v_mov_b32_dpp v13, v44 row_ror:12 row_mask:0xf bank_mask:0x8
  s_waitcnt lgkmcnt(2)
  s_nop 0
  v_mfma_f32_16x16x32_bf16 v[30:33], v[22:25], v[10:13], v[30:33]
  ds_read_b128 v[22:25], v47 offset:19456
  v_mov_b32_dpp v14, v44 row_ror:12 row_mask:0xf bank_mask:0x1
  v_mov_b32_dpp v15, v44 quad_perm:[0,1,2,3] row_mask:0xf bank_mask:0x2
  s_waitcnt lgkmcnt(2)
  v_mfma_f32_16x16x32_bf16 v[34:37], v[26:29], v[10:13], v[34:37]
  ds_read_b128 v[26:29], v47 offset:20480
  v_mov_b32_dpp v16, v44 row_ror:4 row_mask:0xf bank_mask:0x4
  v_mov_b32_dpp v17, v44 row_ror:8 row_mask:0xf bank_mask:0x8
  s_waitcnt lgkmcnt(2)
  s_nop 0
  v_mfma_f32_16x16x32_bf16 v[30:33], v[18:21], v[14:17], v[30:33]
  ds_read_b128 v[18:21], v47 offset:21504
  v_mov_b32_dpp v10, v44 row_ror:8 row_mask:0xf bank_mask:0x1
  v_mov_b32_dpp v11, v44 row_ror:12 row_mask:0xf bank_mask:0x2
  s_waitcnt lgkmcnt(2)
  v_mfma_f32_16x16x32_bf16 v[34:37], v[22:25], v[14:17], v[34:37]
  ds_read_b128 v[22:25], v47 offset:22528
  v_mov_b32_dpp v12, v44 quad_perm:[0,1,2,3] row_mask:0xf bank_mask:0x4
  v_mov_b32_dpp v13, v44 row_ror:4 row_mask:0xf bank_mask:0x8
  s_waitcnt lgkmcnt(2)
  s_nop 0
  v_mfma_f32_16x16x32_bf16 v[30:33], v[26:29], v[10:13], v[30:33]
  ds_read_b128 v[26:29], v47 offset:23552
  v_mov_b32_dpp v14, v44 row_ror:4 row_mask:0xf bank_mask:0x1
  v_mov_b32_dpp v15, v44 row_ror:8 row_mask:0xf bank_mask:0x2
  s_waitcnt lgkmcnt(2)
  v_mfma_f32_16x16x32_bf16 v[34:37], v[18:21], v[10:13], v[34:37]
  ds_read_b128 v[18:21], v47 offset:24576
  v_mov_b32_dpp v16, v44 row_ror:12 row_mask:0xf bank_mask:0x4
  v_mov_b32_dpp v17, v44 quad_perm:[0,1,2,3] row_mask:0xf bank_mask:0x8
  s_waitcnt lgkmcnt(2)
  s_nop 0
  v_mfma_f32_16x16x32_bf16 v[30:33], v[22:25], v[14:17], v[30:33]
  ds_read_b128 v[22:25], v47 offset:25600
  v_mov_b32_dpp v10, v45 quad_perm:[0,1,2,3] row_mask:0xf bank_mask:0x1
  v_mov_b32_dpp v11, v45 row_ror:4 row_mask:0xf bank_mask:0x2
  s_waitcnt lgkmcnt(2)
  v_mfma_f32_16x16x32_bf16 v[34:37], v[26:29], v[14:17], v[34:37]
  ds_read_b128 v[26:29], v47 offset:26624
  v_mov_b32_dpp v12, v45 row_ror:8 row_mask:0xf bank_mask:0x4
  v_mov_b32_dpp v13, v45 row_ror:12 row_mask:0xf bank_mask:0x8
  s_waitcnt lgkmcnt(2)
  s_nop 0
  v_mfma_f32_16x16x32_bf16 v[30:33], v[18:21], v[10:13], v[30:33]
  ds_read_b128 v[18:21], v47 offset:27648
  v_mov_b32_dpp v14, v45 row_ror:12 row_mask:0xf bank_mask:0x1
  v_mov_b32_dpp v15, v45 quad_perm:[0,1,2,3] row_mask:0xf bank_mask:0x2
  s_waitcnt lgkmcnt(2)
  v_mfma_f32_16x16x32_bf16 v[34:37], v[22:25], v[10:13], v[34:37]
  v_mov_b32_dpp v16, v45 row_ror:4 row_mask:0xf bank_mask:0x4
  v_mov_b32_dpp v17, v45 row_ror:8 row_mask:0xf bank_mask:0x8
  s_waitcnt lgkmcnt(1)
  s_nop 0
  v_mfma_f32_16x16x32_bf16 v[30:33], v[26:29], v[14:17], v[30:33]
  v_mov_b32_dpp v10, v45 row_ror:8 row_mask:0xf bank_mask:0x1
  v_mov_b32_dpp v11, v45 row_ror:12 row_mask:0xf bank_mask:0x2
  s_waitcnt lgkmcnt(0)
  v_mfma_f32_16x16x32_bf16 v[34:37], v[18:21], v[14:17], v[34:37]
  v_mov_b32_dpp v12, v45 quad_perm:[0,1,2,3] row_mask:0xf bank_mask:0x4
  v_mov_b32_dpp v13, v45 row_ror:4 row_mask:0xf bank_mask:0x8
  s_nop 1
  v_mfma_f32_16x16x32_bf16 v[30:33], v[48:51], v[10:13], v[30:33]
  v_mov_b32_dpp v14, v45 row_ror:4 row_mask:0xf bank_mask:0x1
  v_mov_b32_dpp v15, v45 row_ror:8 row_mask:0xf bank_mask:0x2
  v_mfma_f32_16x16x32_bf16 v[34:37], v[52:55], v[10:13], v[34:37]
  v_mov_b32_dpp v16, v45 row_ror:12 row_mask:0xf bank_mask:0x4
  v_mov_b32_dpp v17, v45 quad_perm:[0,1,2,3] row_mask:0xf bank_mask:0x8
  s_nop 1
  v_mfma_f32_16x16x32_bf16 v[30:33], v[56:59], v[14:17], v[30:33]
  v_mov_b32_dpp v10, v46 quad_perm:[0,1,2,3] row_mask:0xf bank_mask:0x1
  v_mov_b32_dpp v11, v46 row_ror:4 row_mask:0xf bank_mask:0x2
  v_mfma_f32_16x16x32_bf16 v[34:37], v[60:63], v[14:17], v[34:37]
  v_mov_b32_dpp v12, v46 row_ror:8 row_mask:0xf bank_mask:0x4
  v_mov_b32_dpp v13, v46 row_ror:12 row_mask:0xf bank_mask:0x8
  s_nop 1
  v_mfma_f32_16x16x32_bf16 v[30:33], v[64:67], v[10:13], v[30:33]
  v_mov_b32_dpp v14, v46 row_ror:12 row_mask:0xf bank_mask:0x1
  v_mov_b32_dpp v15, v46 quad_perm:[0,1,2,3] row_mask:0xf bank_mask:0x2
  v_mfma_f32_16x16x32_bf16 v[34:37], v[68:71], v[10:13], v[34:37]
  v_mov_b32_dpp v16, v46 row_ror:4 row_mask:0xf bank_mask:0x4
  v_mov_b32_dpp v17, v46 row_ror:8 row_mask:0xf bank_mask:0x8
  s_nop 1
  v_mfma_f32_16x16x32_bf16 v[30:33], v[72:75], v[14:17], v[30:33]
  v_mfma_f32_16x16x32_bf16 v[34:37], v[76:79], v[14:17], v[34:37]
  v_lshrrev_b32 v47, 1, v3
  s_lshl_b32 s40, s17, 9
  v_add_u32 v47, s40, v47
  s_nop 3
  v_permlane32_swap_b32 v30, v31
  v_permlane32_swap_b32 v34, v35
  v_permlane32_swap_b32 v32, v33
  v_permlane32_swap_b32 v36, v37
  v_add_f32_dpp v30, v31, v30 quad_perm:[2,3,2,3] row_mask:0xf bank_mask:0xf
  v_add_f32_dpp v34, v35, v34 quad_perm:[2,3,2,3] row_mask:0xf bank_mask:0xf
  v_add_f32_dpp v33, v32, v33 quad_perm:[0,1,0,1] row_mask:0xf bank_mask:0xf
  v_add_f32_dpp v37, v36, v37 quad_perm:[0,1,0,1] row_mask:0xf bank_mask:0xf
  v_cndmask_b32_e64 v30, v30, v33, s[30:31]
  v_cndmask_b32_e64 v34, v34, v37, s[30:31]
  ds_write_b32 v47, v30 offset:0
  ds_write_b32 v47, v34 offset:256
  v_lshlrev_b32 v47, 3, v0
  v_mov_b32 v39, s16
  s_waitcnt lgkmcnt(0)
  s_barrier
  s_cmp_lg_u32 s58, 0
  s_cbranch_scc1 L_q_skip_11
  ds_read_b64 v[30:31], v47 offset:0
  ds_read_b64 v[32:33], v47 offset:512
  ds_read_b64 v[34:35], v47 offset:1024
  ds_read_b64 v[36:37], v47 offset:1536
  s_waitcnt lgkmcnt(2)
  v_add_f32 v30, v30, v32
  v_add_f32 v31, v31, v33
  s_waitcnt lgkmcnt(0)
  v_add_f32 v34, v34, v36
  v_add_f32 v35, v35, v37
  v_add_f32 v30, v30, v34
  v_add_f32 v31, v31, v35
  v_cvt_pk_bf16_f32 v38, v30, v31
  buffer_store_dwordx2 v[38:39], v47, s[4:7], s25 offen sc1
  s_nop 0
L_q_skip_11:
  s_waitcnt vmcnt(20)
  v_lshrrev_b32 v27, 4, v0
  v_bfe_u32 v28, v0, 3, 1
  v_lshl_add_u32 v27, v27, 1, v28
  v_mul_u32_u24 v26, 1152, v27
  v_and_b32 v28, 7, v0
  v_lshl_add_u32 v26, v28, 4, v26
  s_add_u32 s48, s50, 0x4900
  buffer_load_dwordx4 v[160:163], v26, s[8:11], s48 offen nt
  s_add_u32 s48, s50, 0x4980
  buffer_load_dwordx4 v[164:167], v26, s[8:11], s48 offen nt
  s_add_u32 s48, s50, 0x4a00
  buffer_load_dwordx4 v[168:171], v26, s[8:11], s48 offen nt
  s_add_u32 s48, s50, 0x4a80
  buffer_load_dwordx4 v[172:175], v26, s[8:11], s48 offen nt
  s_add_u32 s48, s50, 0x4b00
  buffer_load_dwordx4 v[176:179], v26, s[8:11], s48 offen nt
  s_add_u32 s48, s50, 0x4b80
  buffer_load_dwordx4 v[180:183], v26, s[8:11], s48 offen nt
  s_add_u32 s48, s50, 0x4c00
  buffer_load_dwordx4 v[184:187], v26, s[8:11], s48 offen nt
  s_add_u32 s48, s50, 0x6c00
  buffer_load_dwordx4 v[188:191], v26, s[8:11], s48 offen nt
  s_add_u32 s48, s50, 0x6c80
  buffer_load_dwordx4 v[192:195], v26, s[8:11], s48 offen nt
  s_add_u32 s48, s50, 0x6d00
  buffer_load_dwordx4 v[196:199], v26, s[8:11], s48 offen nt
  s_add_u32 s48, s50, 0x6d80
  buffer_load_dwordx4 v[200:203], v26, s[8:11], s48 offen nt
  s_add_u32 s48, s50, 0x6e00
  buffer_load_dwordx4 v[204:207], v26, s[8:11], s48 offen nt
  s_add_u32 s48, s50, 0x6e80
  buffer_load_dwordx4 v[208:211], v26, s[8:11], s48 offen nt
  s_add_u32 s48, s50, 0x6f00
  buffer_load_dwordx4 v[212:215], v26, s[8:11], s48 offen nt
  s_add_u32 s48, s50, 0x6f80
  buffer_load_dwordx4 v[216:219], v26, s[8:11], s48 offen nt
  s_add_u32 s48, s50, 0x7000
  buffer_load_dwordx4 v[220:223], v26, s[8:11], s48 offen nt
  s_mov_b32 s8, s66
  s_and_b32 s9, s67, 0xffff
  s_mov_b32 s10, 0x510000
  s_mov_b32 s11, 0x00020000
  v_lshrrev_b32 v27, 4, v0
  v_bfe_u32 v28, v0, 3, 1
  v_lshl_add_u32 v27, v27, 1, v28
  v_mul_u32_u24 v26, 9216, v27
  v_and_b32 v28, 7, v0
  v_lshl_add_u32 v26, v28, 4, v26
  s_add_u32 s48, s51, 0x0
  buffer_load_dwordx4 v[224:227], v26, s[8:11], s48 offen nt
  s_add_u32 s48, s51, 0x80
  buffer_load_dwordx4 v[228:231], v26, s[8:11], s48 offen nt
  s_add_u32 s48, s51, 0x12000
  buffer_load_dwordx4 v[232:235], v26, s[8:11], s48 offen nt
  s_add_u32 s48, s51, 0x12080
  buffer_load_dwordx4 v[236:239], v26, s[8:11], s48 offen nt
  s_add_u32 s48, s51, 0x24000
  buffer_load_dwordx4 v[240:243], v26, s[8:11], s48 offen nt
  s_add_u32 s48, s51, 0x24080
  buffer_load_dwordx4 v[244:247], v26, s[8:11], s48 offen nt
  s_add_u32 s48, s51, 0x36000
  buffer_load_dwordx4 v[248:251], v26, s[8:11], s48 offen nt
  s_add_u32 s48, s51, 0x36080
  buffer_load_dwordx4 v[252:255], v26, s[8:11], s48 offen nt
  s_add_u32 s48, s51, 0x48000
  buffer_load_dwordx4 a[0:3], v26, s[8:11], s48 offen nt
  s_add_u32 s48, s51, 0x48080
  buffer_load_dwordx4 a[4:7], v26, s[8:11], s48 offen nt
  s_add_u32 s48, s51, 0x5a000
  buffer_load_dwordx4 a[8:11], v26, s[8:11], s48 offen nt
  s_add_u32 s48, s51, 0x5a080
  buffer_load_dwordx4 a[12:15], v26, s[8:11], s48 offen nt
  s_add_u32 s48, s51, 0x6c000
  buffer_load_dwordx4 a[16:19], v26, s[8:11], s48 offen nt
  s_add_u32 s48, s51, 0x6c080
  buffer_load_dwordx4 a[20:23], v26, s[8:11], s48 offen nt
  s_lshl_b32 s25, s18, 9
  s_add_u32 s25, s25, 0x1000
  s_barrier
  s_mul_i32 s40, s17, 28672
  s_add_u32 s40, s40, 10240
  v_lshlrev_b32 v47, 4, v0
  v_add_u32 v47, s40, v47
  ds_read_b128 v[18:21], v47 offset:0
  ds_read_b128 v[22:25], v47 offset:1024
  ds_read_b128 v[26:29], v47 offset:2048
  v_mov_b32_dpp v10, v5 quad_perm:[0,1,2,3] row_mask:0xf bank_mask:0x1
  v_mov_b32_dpp v11, v5 row_ror:4 row_mask:0xf bank_mask:0x2
  v_mov_b32_dpp v12, v5 row_ror:8 row_mask:0xf bank_mask:0x4
  v_mov_b32_dpp v13, v5 row_ror:12 row_mask:0xf bank_mask:0x8
  s_waitcnt lgkmcnt(2)
  s_nop 0
  v_mfma_f32_16x16x32_bf16 v[30:33], v[18:21], v[10:13], 0
  ds_read_b128 v[18:21], v47 offset:3072
  v_mov_b32_dpp v14, v5 row_ror:12 row_mask:0xf bank_mask:0x1
  v_mov_b32_dpp v15, v5 quad_perm:[0,1,2,3] row_mask:0xf bank_mask:0x2
  s_waitcnt lgkmcnt(2)
  v_mfma_f32_16x16x32_bf16 v[34:37], v[22:25], v[10:13], 0
  ds_read_b128 v[22:25], v47 offset:4096
  v_mov_b32_dpp v16, v5 row_ror:4 row_mask:0xf bank_mask:0x4
  v_mov_b32_dpp v17, v5 row_ror:8 row_mask:0xf bank_mask:0x8
  s_waitcnt lgkmcnt(2)
  s_nop 0
  v_mfma_f32_16x16x32_bf16 v[30:33], v[26:29], v[14:17], v[30:33]
  ds_read_b128 v[26:29], v47 offset:5120
  v_mov_b32_dpp v10, v5 row_ror:8 row_mask:0xf bank_mask:0x1
  v_mov_b32_dpp v11, v5 row_ror:12 row_mask:0xf bank_mask:0x2
  s_waitcnt lgkmcnt(2)
  v_mfma_f32_16x16x32_bf16 v[34:37], v[18:21], v[14:17], v[34:37]
  ds_read_b128 v[18:21], v47 offset:6144
  v_mov_b32_dpp v12, v5 quad_perm:[0,1,2,3] row_mask:0xf bank_mask:0x4
  v_mov_b32_dpp v13, v5 row_ror:4 row_mask:0xf bank_mask:0x8
  s_waitcnt lgkmcnt(2)
  s_nop 0
  v_mfma_f32_16x16x32_bf16 v[30:33], v[22:25], v[10:13], v[30:33]
  ds_read_b128 v[22:25], v47 offset:7168
  v_mov_b32_dpp v14, v5 row_ror:4 row_mask:0xf bank_mask:0x1
  v_mov_b32_dpp v15, v5 row_ror:8 row_mask:0xf bank_mask:0x2
  s_waitcnt lgkmcnt(2)
  v_mfma_f32_16x16x32_bf16 v[34:37], v[26:29], v[10:13], v[34:37]
  ds_read_b128 v[26:29], v47 offset:8192
  v_mov_b32_dpp v16, v5 row_ror:12 row_mask:0xf bank_mask:0x4
  v_mov_b32_dpp v17, v5 quad_perm:[0,1,2,3] row_mask:0xf bank_mask:0x8
  s_waitcnt lgkmcnt(2)
  s_nop 0
  v_mfma_f32_16x16x32_bf16 v[30:33], v[18:21], v[14:17], v[30:33]
  ds_read_b128 v[18:21], v47 offset:9216
  v_mov_b32_dpp v10, v6 quad_perm:[0,1,2,3] row_mask:0xf bank_mask:0x1
  v_mov_b32_dpp v11, v6 row_ror:4 row_mask:0xf bank_mask:0x2
  s_waitcnt lgkmcnt(2)
  v_mfma_f32_16x16x32_bf16 v[34:37], v[22:25], v[14:17], v[34:37]
  ds_read_b128 v[22:25], v47 offset:10240
  v_mov_b32_dpp v12, v6 row_ror:8 row_mask:0xf bank_mask:0x4
  v_mov_b32_dpp v13, v6 row_ror:12 row_mask:0xf bank_mask:0x8
  s_waitcnt lgkmcnt(2)
  s_nop 0
  v_mfma_f32_16x16x32_bf16 v[30:33], v[26:29], v[10:13], v[30:33]
  ds_read_b128 v[26:29], v47 offset:11264
  v_mov_b32_dpp v14, v6 row_ror:12 row_mask:0xf bank_mask:0x1
  v_mov_b32_dpp v15, v6 quad_perm:[0,1,2,3] row_mask:0xf bank_mask:0x2
  s_waitcnt lgkmcnt(2)
  v_mfma_f32_16x16x32_bf16 v[34:37], v[18:21], v[10:13], v[34:37]
  ds_read_b128 v[18:21], v47 offset:12288
  v_mov_b32_dpp v16, v6 row_ror:4 row_mask:0xf bank_mask:0x4
  v_mov_b32_dpp v17, v6 row_ror:8 row_mask:0xf bank_mask:0x8
  s_waitcnt lgkmcnt(2)
  s_nop 0
  v_mfma_f32_16x16x32_bf16 v[30:33], v[22:25], v[14:17], v[30:33]
  ds_read_b128 v[22:25], v47 offset:13312
  v_mov_b32_dpp v10, v6 row_ror:8 row_mask:0xf bank_mask:0x1
  v_mov_b32_dpp v11, v6 row_ror:12 row_mask:0xf bank_mask:0x2
  s_waitcnt lgkmcnt(2)
  v_mfma_f32_16x16x32_bf16 v[34:37], v[26:29], v[14:17], v[34:37]
  ds_read_b128 v[26:29], v47 offset:14336
  v_mov_b32_dpp v12, v6 quad_perm:[0,1,2,3] row_mask:0xf bank_mask:0x4
  v_mov_b32_dpp v13, v6 row_ror:4 row_mask:0xf bank_mask:0x8
  s_waitcnt lgkmcnt(2)
  s_nop 0
  v_mfma_f32_16x16x32_bf16 v[30:33], v[18:21], v[10:13], v[30:33]
  ds_read_b128 v[18:21], v47 offset:15360
  v_mov_b32_dpp v14, v6 row_ror:4 row_mask:0xf bank_mask:0x1
  v_mov_b32_dpp v15, v6 row_ror:8 row_mask:0xf bank_mask:0x2
  s_waitcnt lgkmcnt(2)
  v_mfma_f32_16x16x32_bf16 v[34:37], v[22:25], v[10:13], v[34:37]
  ds_read_b128 v[22:25], v47 offset:16384
  v_mov_b32_dpp v16, v6 row_ror:12 row_mask:0xf bank_mask:0x4
  v_mov_b32_dpp v17, v6 quad_perm:[0,1,2,3] row_mask:0xf bank_mask:0x8
  s_waitcnt lgkmcnt(2)
  s_nop 0
  v_mfma_f32_16x16x32_bf16 v[30:33], v[26:29], v[14:17], v[30:33]
  ds_read_b128 v[26:29], v47 offset:17408
  v_mov_b32_dpp v10, v7 quad_perm:[0,1,2,3] row_mask:0xf bank_mask:0x1
  v_mov_b32_dpp v11, v7 row_ror:4 row_mask:0xf bank_mask:0x2
  s_waitcnt lgkmcnt(2)
  v_mfma_f32_16x16x32_bf16 v[34:37], v[18:21], v[14:17], v[34:37]
  ds_read_b128 v[18:21], v47 offset:18432
  v_mov_b32_dpp v12, v7 row_ror:8 row_mask:0xf bank_mask:0x4
  v_mov_b32_dpp v13, v7 row_ror:12 row_mask:0xf bank_mask:0x8
  s_waitcnt lgkmcnt(2)
  s_nop 0
  v_mfma_f32_16x16x32_bf16 v[30:33], v[22:25], v[10:13], v[30:33]
  ds_read_b128 v[22:25], v47 offset:19456
  v_mov_b32_dpp v14, v7 row_ror:12 row_mask:0xf bank_mask:0x1
  v_mov_b32_dpp v15, v7 quad_perm:[0,1,2,3] row_mask:0xf bank_mask:0x2
  s_waitcnt lgkmcnt(2)
  v_mfma_f32_16x16x32_bf16 v[34:37], v[26:29], v[10:13], v[34:37]
  ds_read_b128 v[26:29], v47 offset:20480
  v_mov_b32_dpp v16, v7 row_ror:4 row_mask:0xf bank_mask:0x4
  v_mov_b32_dpp v17, v7 row_ror:8 row_mask:0xf bank_mask:0x8
  s_waitcnt lgkmcnt(2)
  s_nop 0
  v_mfma_f32_16x16x32_bf16 v[30:33], v[18:21], v[14:17], v[30:33]
  ds_read_b128 v[18:21], v47 offset:21504
  v_mov_b32_dpp v10, v7 row_ror:8 row_mask:0xf bank_mask:0x1
  v_mov_b32_dpp v11, v7 row_ror:12 row_mask:0xf bank_mask:0x2
  s_waitcnt lgkmcnt(2)
  v_mfma_f32_16x16x32_bf16 v[34:37], v[22:25], v[14:17], v[34:37]
  ds_read_b128 v[22:25], v47 offset:22528
  v_mov_b32_dpp v12, v7 quad_perm:[0,1,2,3] row_mask:0xf bank_mask:0x4
  v_mov_b32_dpp v13, v7 row_ror:4 row_mask:0xf bank_mask:0x8
  s_waitcnt lgkmcnt(2)
  s_nop 0
  v_mfma_f32_16x16x32_bf16 v[30:33], v[26:29], v[10:13], v[30:33]
  ds_read_b128 v[26:29], v47 offset:23552
  v_mov_b32_dpp v14, v7 row_ror:4 row_mask:0xf bank_mask:0x1
  v_mov_b32_dpp v15, v7 row_ror:8 row_mask:0xf bank_mask:0x2
  s_waitcnt lgkmcnt(2)
  v_mfma_f32_16x16x32_bf16 v[34:37], v[18:21], v[10:13], v[34:37]
  ds_read_b128 v[18:21], v47 offset:24576
  v_mov_b32_dpp v16, v7 row_ror:12 row_mask:0xf bank_mask:0x4
  v_mov_b32_dpp v17, v7 quad_perm:[0,1,2,3] row_mask:0xf bank_mask:0x8
  s_waitcnt lgkmcnt(2)
  s_nop 0
  v_mfma_f32_16x16x32_bf16 v[30:33], v[22:25], v[14:17], v[30:33]
  ds_read_b128 v[22:25], v47 offset:25600
  v_mov_b32_dpp v10, v8 quad_perm:[0,1,2,3] row_mask:0xf bank_mask:0x1
  v_mov_b32_dpp v11, v8 row_ror:4 row_mask:0xf bank_mask:0x2
  s_waitcnt lgkmcnt(2)
  v_mfma_f32_16x16x32_bf16 v[34:37], v[26:29], v[14:17], v[34:37]
  ds_read_b128 v[26:29], v47 offset:26624
  v_mov_b32_dpp v12, v8 row_ror:8 row_mask:0xf bank_mask:0x4
  v_mov_b32_dpp v13, v8 row_ror:12 row_mask:0xf bank_mask:0x8
  s_waitcnt lgkmcnt(2)
  s_nop 0
  v_mfma_f32_16x16x32_bf16 v[30:33], v[18:21], v[10:13], v[30:33]
  ds_read_b128 v[18:21], v47 offset:27648
  v_mov_b32_dpp v14, v8 row_ror:12 row_mask:0xf bank_mask:0x1
  v_mov_b32_dpp v15, v8 quad_perm:[0,1,2,3] row_mask:0xf bank_mask:0x2
  s_waitcnt lgkmcnt(2)
  v_mfma_f32_16x16x32_bf16 v[34:37], v[22:25], v[10:13], v[34:37]
  v_mov_b32_dpp v16, v8 row_ror:4 row_mask:0xf bank_mask:0x4
  v_mov_b32_dpp v17, v8 row_ror:8 row_mask:0xf bank_mask:0x8
  s_waitcnt lgkmcnt(1)
  s_nop 0
  v_mfma_f32_16x16x32_bf16 v[30:33], v[26:29], v[14:17], v[30:33]
  v_mov_b32_dpp v10, v8 row_ror:8 row_mask:0xf bank_mask:0x1
  v_mov_b32_dpp v11, v8 row_ror:12 row_mask:0xf bank_mask:0x2
  s_waitcnt lgkmcnt(0)
  v_mfma_f32_16x16x32_bf16 v[34:37], v[18:21], v[14:17], v[34:37]
  v_mov_b32_dpp v12, v8 quad_perm:[0,1,2,3] row_mask:0xf bank_mask:0x4
  v_mov_b32_dpp v13, v8 row_ror:4 row_mask:0xf bank_mask:0x8
  s_nop 1
  v_mfma_f32_16x16x32_bf16 v[30:33], v[48:51], v[10:13], v[30:33]
  v_mov_b32_dpp v14, v8 row_ror:4 row_mask:0xf bank_mask:0x1
  v_mov_b32_dpp v15, v8 row_ror:8 row_mask:0xf bank_mask:0x2
  v_mfma_f32_16x16x32_bf16 v[34:37], v[52:55], v[10:13], v[34:37]
  v_mov_b32_dpp v16, v8 row_ror:12 row_mask:0xf bank_mask:0x4
  v_mov_b32_dpp v17, v8 quad_perm:[0,1,2,3] row_mask:0xf bank_mask:0x8
  s_nop 1
  v_mfma_f32_16x16x32_bf16 v[30:33], v[56:59], v[14:17], v[30:33]
  v_mov_b32_dpp v10, v9 quad_perm:[0,1,2,3] row_mask:0xf bank_mask:0x1
  v_mov_b32_dpp v11, v9 row_ror:4 row_mask:0xf bank_mask:0x2
  v_mfma_f32_16x16x32_bf16 v[34:37], v[60:63], v[14:17], v[34:37]
  v_mov_b32_dpp v12, v9 row_ror:8 row_mask:0xf bank_mask:0x4
  v_mov_b32_dpp v13, v9 row_ror:12 row_mask:0xf bank_mask:0x8
  s_nop 1
  v_mfma_f32_16x16x32_bf16 v[30:33], v[64:67], v[10:13], v[30:33]
  v_mov_b32_dpp v14, v9 row_ror:12 row_mask:0xf bank_mask:0x1
  v_mov_b32_dpp v15, v9 quad_perm:[0,1,2,3] row_mask:0xf bank_mask:0x2
  v_mfma_f32_16x16x32_bf16 v[34:37], v[68:71], v[10:13], v[34:37]
  v_mov_b32_dpp v16, v9 row_ror:4 row_mask:0xf bank_mask:0x4
  v_mov_b32_dpp v17, v9 row_ror:8 row_mask:0xf bank_mask:0x8
  s_nop 1
  v_mfma_f32_16x16x32_bf16 v[30:33], v[72:75], v[14:17], v[30:33]
  v_mfma_f32_16x16x32_bf16 v[34:37], v[76:79], v[14:17], v[34:37]
  v_lshrrev_b32 v47, 1, v3
  s_lshl_b32 s40, s17, 9
  v_add_u32 v47, s40, v47
  s_nop 3
  v_permlane32_swap_b32 v30, v31
  v_permlane32_swap_b32 v34, v35
  v_permlane32_swap_b32 v32, v33
  v_permlane32_swap_b32 v36, v37
  v_add_f32_dpp v30, v31, v30 quad_perm:[2,3,2,3] row_mask:0xf bank_mask:0xf
  v_add_f32_dpp v34, v35, v34 quad_perm:[2,3,2,3] row_mask:0xf bank_mask:0xf
  v_add_f32_dpp v33, v32, v33 quad_perm:[0,1,0,1] row_mask:0xf bank_mask:0xf
  v_add_f32_dpp v37, v36, v37 quad_perm:[0,1,0,1] row_mask:0xf bank_mask:0xf
  v_cndmask_b32_e64 v30, v30, v33, s[30:31]
  v_cndmask_b32_e64 v34, v34, v37, s[30:31]
  ds_write_b32 v47, v30 offset:0
  ds_write_b32 v47, v34 offset:256
  v_lshlrev_b32 v47, 3, v0
  v_mov_b32 v39, s16
  s_waitcnt lgkmcnt(0)
  s_barrier
  s_cmp_lg_u32 s58, 0
  s_cbranch_scc1 L_q_skip_12
  ds_read_b64 v[30:31], v47 offset:0
  ds_read_b64 v[32:33], v47 offset:512
  ds_read_b64 v[34:35], v47 offset:1024
  ds_read_b64 v[36:37], v47 offset:1536
  s_waitcnt lgkmcnt(2)
  v_add_f32 v30, v30, v32
  v_add_f32 v31, v31, v33
  s_waitcnt lgkmcnt(0)
  v_add_f32 v34, v34, v36
  v_add_f32 v35, v35, v37
  v_add_f32 v30, v30, v34
  v_add_f32 v31, v31, v35
  v_cvt_pk_bf16_f32 v38, v30, v31
  buffer_store_dwordx2 v[38:39], v47, s[4:7], s25 offen sc1
  s_nop 0
L_q_skip_12:
  s_mov_b32 s12, s60
  s_and_b32 s13, s61, 0xffff
  s_mov_b32 s14, 0x900
  s_mov_b32 s15, 0x00020000
  v_lshrrev_b32 v30, 1, v0
  s_mul_i32 s41, s18, 18
  v_add_u32 v30, s41, v30
  v_lshlrev_b32 v30, 1, v30
  buffer_load_ushort v5, v30, s[12:15], 0 offen offset:1152
  buffer_load_ushort v6, v30, s[12:15], 0 offen
  s_mov_b32 s8, s72
  s_and_b32 s9, s73, 0xffff
  s_mov_b32 s10, 0x480
  s_mov_b32 s11, 0x00020000
  buffer_load_ushort v8, v30, s[8:11], 0 offen
  v_lshrrev_b32 v31, 2, v2
  s_lshl_b32 s41, s18, 8
  s_lshl_b32 s42, s17, 6
  s_add_u32 s41, s41, s42
  s_lshl_b32 s42, s18, 5
  s_lshr_b32 s43, s17, 1
  s_lshl_b32 s43, s43, 4
  s_add_u32 s42, s42, s43
  s_add_u32 s42, s42, 8192
  s_mov_b32 s8, s68
  s_and_b32 s9, s69, 0xffff
  s_mov_b32 s10, 0x2400
  s_mov_b32 s11, 0x00020000
  buffer_load_ushort v7, v31, s[8:11], s41 offen
  buffer_load_ushort v9, v31, s[8:11], s42 offen
  v_lshlrev_b32 v4, 2, v30
  v_mov_b32 v32, 0x7f000000
  v_cndmask_b32_e64 v4, v4, v32, s[32:33]
  v_cndmask_b32_e64 v4, v32, v4, s[34:35]
  v_and_b32 v33, 1, v0
  s_lshl_b32 s41, s18, 1
  v_add_u32 v33, s41, v33
  v_lshlrev_b32 v33, 3, v33
  v_add_u32 v33, 4608, v33
  v_and_b32 v32, 62, v0
  v_cmp_eq_u32 vcc, 40, v32
  s_nop 1
  v_cndmask_b32 v4, v4, v33, vcc
  v_and_b32 v34, 31, v0
  v_lshlrev_b32 v34, 3, v34
  s_mov_b32 s40, 0x100
  buffer_load_dwordx2 v[36:37], v34, s[4:7], s40 offen sc1
  s_lshl_b32 s40, s18, 2
  s_add_u32 s40, s40, s17
  s_mul_i32 s41, s40, 2560
  s_add_u32 s41, s41, 0x400000
  v_lshlrev_b32 v35, 4, v0
  buffer_load_dwordx4 v[38:41], v35, s[4:7], s41 offen offset:0
  buffer_load_dwordx4 v[38:41], v35, s[4:7], s41 offen offset:1024
  buffer_load_dwordx4 v[38:41], v35, s[4:7], s41 offen offset:1536
  s_and_b32 s40, s40, 15
  s_lshl_b32 s40, s40, 10
  s_add_u32 s40, s40, 0x600000
  buffer_load_dwordx4 v[38:41], v35, s[4:7], s40 offen
  s_waitcnt vmcnt(16)
  s_mov_b32 s8, s66
  s_and_b32 s9, s67, 0xffff
  s_mov_b32 s10, 0x510000
  s_mov_b32 s11, 0x00020000
  v_lshrrev_b32 v27, 4, v0
  v_bfe_u32 v28, v0, 3, 1
  v_lshl_add_u32 v27, v27, 1, v28
  v_mul_u32_u24 v26, 9216, v27
  v_and_b32 v28, 7, v0
  v_lshl_add_u32 v26, v28, 4, v26
  s_add_u32 s48, s51, 0x7e000
  buffer_load_dwordx4 a[24:27], v26, s[8:11], s48 offen nt
  s_add_u32 s48, s51, 0x7e080
  buffer_load_dwordx4 a[28:31], v26, s[8:11], s48 offen nt
  s_add_u32 s48, s51, 0x90000
  buffer_load_dwordx4 a[32:35], v26, s[8:11], s48 offen nt
  s_add_u32 s48, s51, 0x90080
  buffer_load_dwordx4 a[36:39], v26, s[8:11], s48 offen nt
  s_add_u32 s48, s51, 0xa2000
  buffer_load_dwordx4 a[40:43], v26, s[8:11], s48 offen nt
  s_add_u32 s48, s51, 0xa2080
  buffer_load_dwordx4 a[44:47], v26, s[8:11], s48 offen nt
  s_add_u32 s48, s51, 0xb4000
  buffer_load_dwordx4 a[48:51], v26, s[8:11], s48 offen nt
  s_add_u32 s48, s51, 0xb4080
  buffer_load_dwordx4 a[52:55], v26, s[8:11], s48 offen nt
  s_waitcnt vmcnt(16)
  v_lshrrev_b32 v27, 4, v0
  v_bfe_u32 v28, v0, 3, 1
  v_lshl_add_u32 v27, v27, 1, v28
  v_mul_u32_u24 v26, 9216, v27
  v_and_b32 v28, 7, v0
  v_lshl_add_u32 v26, v28, 4, v26
  s_add_u32 s48, s51, 0xc6000
  buffer_load_dwordx4 a[56:59], v26, s[8:11], s48 offen nt
  s_add_u32 s48, s51, 0xc6080
  buffer_load_dwordx4 a[60:63], v26, s[8:11], s48 offen nt
  s_add_u32 s48, s51, 0xd8000
  buffer_load_dwordx4 a[64:67], v26, s[8:11], s48 offen nt
  s_add_u32 s48, s51, 0xd8080
  buffer_load_dwordx4 a[68:71], v26, s[8:11], s48 offen nt
  s_add_u32 s48, s51, 0xea000
  buffer_load_dwordx4 a[72:75], v26, s[8:11], s48 offen nt
  s_add_u32 s48, s51, 0xea080
  buffer_load_dwordx4 a[76:79], v26, s[8:11], s48 offen nt
  s_add_u32 s48, s51, 0xfc000
  buffer_load_dwordx4 a[80:83], v26, s[8:11], s48 offen nt
  s_add_u32 s48, s51, 0xfc080
  buffer_load_dwordx4 a[84:87], v26, s[8:11], s48 offen nt
  s_waitcnt vmcnt(16)
  v_lshrrev_b32 v27, 4, v0
  v_bfe_u32 v28, v0, 3, 1
  v_lshl_add_u32 v27, v27, 1, v28
  v_mul_u32_u24 v26, 9216, v27
  v_and_b32 v28, 7, v0
  v_lshl_add_u32 v26, v28, 4, v26
  s_add_u32 s48, s51, 0x10e000
  buffer_load_dwordx4 a[88:91], v26, s[8:11], s48 offen nt
  s_add_u32 s48, s51, 0x10e080
  buffer_load_dwordx4 a[92:95], v26, s[8:11], s48 offen nt
  s_add_u32 s48, s51, 0x120000
  buffer_load_dwordx4 a[96:99], v26, s[8:11], s48 offen nt
  s_add_u32 s48, s51, 0x120080
  buffer_load_dwordx4 a[100:103], v26, s[8:11], s48 offen nt
  s_add_u32 s48, s51, 0x132000
  buffer_load_dwordx4 a[104:107], v26, s[8:11], s48 offen nt
  s_add_u32 s48, s51, 0x132080
  buffer_load_dwordx4 a[108:111], v26, s[8:11], s48 offen nt
  v_bfe_u32 v27, v0, 2, 2
  v_lshlrev_b32 v27, 3, v27
  v_lshrrev_b32 v28, 4, v0
  v_lshl_add_u32 v27, v28, 1, v27
  v_bfe_u32 v28, v0, 1, 1
  v_add_u32 v27, v27, v28
  v_mul_u32_u24 v26, 9216, v27
  v_and_b32 v28, 1, v0
  v_lshl_add_u32 v26, v28, 4, v26
  s_add_u32 m0, s55, 0x0
  s_add_u32 s48, s96, 0x0
  buffer_load_dwordx4 v26, s[8:11], s48 offen lds
  s_add_u32 m0, s55, 0x400
  s_add_u32 s48, s96, 0x48000
  buffer_load_dwordx4 v26, s[8:11], s48 offen lds
  s_waitcnt vmcnt(16)
  v_bfe_u32 v27, v0, 2, 2
  v_lshlrev_b32 v27, 3, v27
  v_lshrrev_b32 v28, 4, v0
  v_lshl_add_u32 v27, v28, 1, v27
  v_bfe_u32 v28, v0, 1, 1
  v_add_u32 v27, v27, v28
  v_mul_u32_u24 v26, 9216, v27
  v_and_b32 v28, 1, v0
  v_lshl_add_u32 v26, v28, 4, v26
  s_add_u32 m0, s55, 0x800
  s_add_u32 s48, s96, 0x90000
  buffer_load_dwordx4 v26, s[8:11], s48 offen lds
  s_add_u32 m0, s55, 0xc00
  s_add_u32 s48, s96, 0xd8000
  buffer_load_dwordx4 v26, s[8:11], s48 offen lds
  s_add_u32 m0, s55, 0x1000
  s_add_u32 s48, s96, 0x120000
  buffer_load_dwordx4 v26, s[8:11], s48 offen lds
  s_mov_b32 s8, s70
  s_and_b32 s9, s71, 0xffff
  s_mov_b32 s10, 0x510000
  s_mov_b32 s11, 0x00020000
  v_lshrrev_b32 v27, 4, v0
  v_bfe_u32 v28, v0, 3, 1
  v_lshl_add_u32 v27, v27, 1, v28
  v_mul_u32_u24 v26, 1152, v27
  v_and_b32 v28, 7, v0
  v_lshl_add_u32 v26, v28, 4, v26
  s_add_u32 s48, s52, 0x0
  buffer_load_dwordx4 a[112:115], v26, s[8:11], s48 offen nt
  s_add_u32 s48, s52, 0x80
  buffer_load_dwordx4 a[116:119], v26, s[8:11], s48 offen nt
  s_add_u32 s48, s52, 0x100
  buffer_load_dwordx4 a[120:123], v26, s[8:11], s48 offen nt
  s_add_u32 s48, s52, 0x180
  buffer_load_dwordx4 a[124:127], v26, s[8:11], s48 offen nt
  s_add_u32 s48, s52, 0x200
  buffer_load_dwordx4 a[128:131], v26, s[8:11], s48 offen nt
  s_waitcnt vmcnt(16)
  v_lshrrev_b32 v27, 4, v0
  v_bfe_u32 v28, v0, 3, 1
  v_lshl_add_u32 v27, v27, 1, v28
  v_mul_u32_u24 v26, 1152, v27
  v_and_b32 v28, 7, v0
  v_lshl_add_u32 v26, v28, 4, v26
  s_add_u32 s48, s52, 0x280
  buffer_load_dwordx4 a[132:135], v26, s[8:11], s48 offen nt
  s_add_u32 s48, s52, 0x300
  buffer_load_dwordx4 a[136:139], v26, s[8:11], s48 offen nt
  s_add_u32 s48, s52, 0x380
  buffer_load_dwordx4 a[140:143], v26, s[8:11], s48 offen nt
  s_add_u32 s48, s52, 0x400
  buffer_load_dwordx4 a[144:147], v26, s[8:11], s48 offen nt
  s_add_u32 s48, s52, 0x2400
  buffer_load_dwordx4 a[148:151], v26, s[8:11], s48 offen nt
  s_add_u32 s48, s52, 0x2480
  buffer_load_dwordx4 a[152:155], v26, s[8:11], s48 offen nt
  s_add_u32 s48, s52, 0x2500
  buffer_load_dwordx4 a[156:159], v26, s[8:11], s48 offen nt
  s_add_u32 s48, s52, 0x2580
  buffer_load_dwordx4 a[160:163], v26, s[8:11], s48 offen nt
  s_waitcnt vmcnt(16)
  v_lshrrev_b32 v27, 4, v0
  v_bfe_u32 v28, v0, 3, 1
  v_lshl_add_u32 v27, v27, 1, v28
  v_mul_u32_u24 v26, 1152, v27
  v_and_b32 v28, 7, v0
  v_lshl_add_u32 v26, v28, 4, v26
  s_add_u32 s48, s52, 0x2600
  buffer_load_dwordx4 a[164:167], v26, s[8:11], s48 offen nt
  s_add_u32 s48, s52, 0x2680
  buffer_load_dwordx4 a[168:171], v26, s[8:11], s48 offen nt
  s_add_u32 s48, s52, 0x2700
  buffer_load_dwordx4 a[172:175], v26, s[8:11], s48 offen nt
  s_add_u32 s48, s52, 0x2780
  buffer_load_dwordx4 a[176:179], v26, s[8:11], s48 offen nt
  s_add_u32 s48, s52, 0x2800
  buffer_load_dwordx4 a[180:183], v26, s[8:11], s48 offen nt
  s_add_u32 s48, s52, 0x4800
  buffer_load_dwordx4 a[184:187], v26, s[8:11], s48 offen nt
  s_add_u32 s48, s52, 0x4880
  buffer_load_dwordx4 a[188:191], v26, s[8:11], s48 offen nt
  s_add_u32 s48, s52, 0x4900
  buffer_load_dwordx4 a[192:195], v26, s[8:11], s48 offen nt
  s_waitcnt vmcnt(16)
  v_lshrrev_b32 v27, 4, v0
  v_bfe_u32 v28, v0, 3, 1
  v_lshl_add_u32 v27, v27, 1, v28
  v_mul_u32_u24 v26, 1152, v27
  v_and_b32 v28, 7, v0
  v_lshl_add_u32 v26, v28, 4, v26
  s_add_u32 s48, s52, 0x4980
  buffer_load_dwordx4 a[196:199], v26, s[8:11], s48 offen nt
  s_add_u32 s48, s52, 0x4a00
  buffer_load_dwordx4 a[200:203], v26, s[8:11], s48 offen nt
  s_add_u32 s48, s52, 0x4a80
  buffer_load_dwordx4 a[204:207], v26, s[8:11], s48 offen nt
  s_add_u32 s48, s52, 0x4b00
  buffer_load_dwordx4 a[208:211], v26, s[8:11], s48 offen nt
  s_add_u32 s48, s52, 0x4b80
  buffer_load_dwordx4 a[212:215], v26, s[8:11], s48 offen nt
  s_add_u32 s48, s52, 0x4c00
  buffer_load_dwordx4 a[216:219], v26, s[8:11], s48 offen nt
  s_add_u32 s48, s52, 0x6c00
  buffer_load_dwordx4 a[220:223], v26, s[8:11], s48 offen nt
  s_add_u32 s48, s52, 0x6c80
  buffer_load_dwordx4 a[224:227], v26, s[8:11], s48 offen nt
  s_waitcnt vmcnt(16)
  v_lshrrev_b32 v27, 4, v0
  v_bfe_u32 v28, v0, 3, 1
  v_lshl_add_u32 v27, v27, 1, v28
  v_mul_u32_u24 v26, 1152, v27
  v_and_b32 v28, 7, v0
  v_lshl_add_u32 v26, v28, 4, v26
  s_add_u32 s48, s52, 0x6d00
  buffer_load_dwordx4 a[228:231], v26, s[8:11], s48 offen nt
  s_add_u32 s48, s52, 0x6d80
  buffer_load_dwordx4 a[232:235], v26, s[8:11], s48 offen nt
  s_add_u32 s48, s52, 0x6e00
  buffer_load_dwordx4 a[236:239], v26, s[8:11], s48 offen nt
  s_add_u32 s48, s52, 0x6e80
  buffer_load_dwordx4 a[240:243], v26, s[8:11], s48 offen nt
  s_add_u32 s48, s52, 0x6f00
  buffer_load_dwordx4 a[244:247], v26, s[8:11], s48 offen nt
  s_add_u32 s48, s52, 0x6f80
  buffer_load_dwordx4 a[248:251], v26, s[8:11], s48 offen nt
  s_add_u32 s48, s52, 0x7000
  buffer_load_dwordx4 a[252:255], v26, s[8:11], s48 offen nt
  s_add_u32 m0, s78, 0x0
  s_add_u32 s48, s53, 0x0
  buffer_load_dwordx4 v26, s[8:11], s48 offen nt lds
  s_waitcnt vmcnt(16)
  v_lshrrev_b32 v27, 4, v0
  v_bfe_u32 v28, v0, 3, 1
  v_lshl_add_u32 v27, v27, 1, v28
  v_mul_u32_u24 v26, 1152, v27
  v_and_b32 v28, 7, v0
  v_lshl_add_u32 v26, v28, 4, v26
  s_add_u32 m0, s78, 0x400
  s_add_u32 s48, s53, 0x80
  buffer_load_dwordx4 v26, s[8:11], s48 offen nt lds
  s_add_u32 m0, s78, 0x800
  s_add_u32 s48, s53, 0x100
  buffer_load_dwordx4 v26, s[8:11], s48 offen nt lds
  s_add_u32 m0, s78, 0xc00
  s_add_u32 s48, s53, 0x180
  buffer_load_dwordx4 v26, s[8:11], s48 offen nt lds
  s_waitcnt vmcnt(40)
  v_lshrrev_b32 v27, 4, v0
  v_bfe_u32 v28, v0, 3, 1
  v_lshl_add_u32 v27, v27, 1, v28
  v_mul_u32_u24 v26, 1152, v27
  v_and_b32 v28, 7, v0
  v_lshl_add_u32 v26, v28, 4, v26
  s_and_b32 s40, s17, 1
  s_cmp_eq_u32 s40, 1
  s_cbranch_scc1 L_w2x_13
  s_add_u32 m0, s78, 0x1000
  s_add_u32 s48, s53, 0x200
  buffer_load_dwordx4 v26, s[8:11], s48 offen nt lds
L_w2x_13:
  s_waitcnt vmcnt(0)
  v_lshlrev_b32 v5, 16, v5
  v_lshlrev_b32 v6, 16, v6
  v_lshlrev_b32 v7, 16, v7
  v_lshlrev_b32 v8, 16, v8
  v_lshlrev_b32 v9, 16, v9
  s_mov_b32 s12, s74
  s_and_b32 s13, s75, 0xffff
  s_mov_b32 s14, 0x900
  s_mov_b32 s15, 0x00020000
  v_cmp_ne_u32 vcc, s16, v37
  s_nop 4
  s_cbranch_vccz L_xok_14
  s_mov_b32 s29, 0x2000
L_xrt_15:
  s_sleep 2
  v_and_b32 v34, 31, v0
  v_lshlrev_b32 v34, 3, v34
  s_mov_b32 s40, 0x100
  buffer_load_dwordx2 v[36:37], v34, s[4:7], s40 offen sc1
  s_waitcnt vmcnt(0)
  v_cmp_ne_u32 vcc, s16, v37
  s_sub_u32 s29, s29, 1
  s_nop 3
  s_cbranch_scc1 L_xok_14
  s_cbranch_vccnz L_xrt_15
L_xok_14:
  v_cmp_ne_u32 vcc, s79, v36
  s_nop 0
  s_cmp_eq_u64 vcc, 0
  s_cselect_b32 s28, 1, 0
  s_mov_b32 s21, 0x400000
  s_mov_b32 s22, 0x428000
  s_mov_b32 s23, 0x600000
  s_mov_b32 s24, 0x602000
  s_mov_b32 s19, 2
L_ch_loop:
  s_lshr_b32 s26, 0xd, s19
  s_and_b32 s26, s26, 1
  s_lshr_b32 s27, 0x28, s19
  s_and_b32 s27, s27, 1
  s_lshl_b32 s40, s27, 1
  s_add_u32 s40, s40, s26
  s_lshl_b32 s20, s40, 5
  s_add_u32 s20, s20, s18
  s_lshl_b32 s20, s20, 14
  s_add_u32 s20, s20, 0x100000
  s_add_u32 s97, s16, s19
  s_lshl_b32 s25, s26, 14
  s_lshl_b32 s41, s18, 9
  s_add_u32 s25, s25, s41
  s_add_u32 s25, s25, 0x9000
  s_barrier
  v_mov_b32 v18, 0
  v_mov_b32 v19, 0
  v_mov_b32 v20, 0
  v_mov_b32 v21, 0
  v_mov_b32 v22, 0
  v_mov_b32 v23, 0
  v_mov_b32 v24, 0
  v_mov_b32 v25, 0
  s_lshl_b32 s40, s17, 8
  s_add_u32 s40, s40, s20
  s_add_u32 s41, s40, 4096
  s_add_u32 s42, s40, 8192
  s_add_u32 s43, s40, 12288
  v_and_b32 v29, 7, v0
  v_min_u32 v29, 6, v29
  v_lshlrev_b32 v29, 11, v29
  buffer_load_dwordx4 v[44:47], v29, s[4:7], s20 offen offset:1024 sc1
  buffer_load_dwordx2 v[30:31], v2, s[4:7], s40 offen sc1
  buffer_load_dwordx2 v[32:33], v2, s[4:7], s40 offen offset:2048 sc1
  buffer_load_dwordx2 v[34:35], v2, s[4:7], s41 offen sc1
  buffer_load_dwordx2 v[36:37], v2, s[4:7], s41 offen offset:2048 sc1
  buffer_load_dwordx2 v[38:39], v2, s[4:7], s42 offen sc1
  buffer_load_dwordx2 v[40:41], v2, s[4:7], s42 offen offset:2048 sc1
  buffer_load_dwordx2 v[42:43], v2, s[4:7], s43 offen sc1
  s_waitcnt vmcnt(0)
  v_min3_u32 v26, v31, v33, v35
  v_max3_u32 v27, v31, v33, v35
  v_min3_u32 v26, v26, v37, v39
  v_max3_u32 v27, v27, v37, v39
  v_min3_u32 v26, v26, v41, v43
  v_max3_u32 v27, v27, v41, v43
  v_min3_u32 v26, v26, v45, v47
  v_max3_u32 v27, v27, v45, v47
  v_cmp_ne_u32 vcc, s16, v26
  v_cmp_ne_u32 s[56:57], s16, v27
  s_nop 0
  s_or_b64 vcc, vcc, s[56:57]
  s_nop 2
  s_cbranch_vccz L_ok_16
  s_mov_b32 s29, 0x2000
L_rt_17:
  s_sleep 4
  buffer_load_dwordx4 v[44:47], v29, s[4:7], s20 offen offset:1024 sc1
  buffer_load_dwordx2 v[30:31], v2, s[4:7], s40 offen sc1
  buffer_load_dwordx2 v[32:33], v2, s[4:7], s40 offen offset:2048 sc1
  buffer_load_dwordx2 v[34:35], v2, s[4:7], s41 offen sc1
  buffer_load_dwordx2 v[36:37], v2, s[4:7], s41 offen offset:2048 sc1
  buffer_load_dwordx2 v[38:39], v2, s[4:7], s42 offen sc1
  buffer_load_dwordx2 v[40:41], v2, s[4:7], s42 offen offset:2048 sc1
  buffer_load_dwordx2 v[42:43], v2, s[4:7], s43 offen sc1
  s_waitcnt vmcnt(0)
  v_min3_u32 v26, v31, v33, v35
  v_max3_u32 v27, v31, v33, v35
  v_min3_u32 v26, v26, v37, v39
  v_max3_u32 v27, v27, v37, v39
  v_min3_u32 v26, v26, v41, v43
  v_max3_u32 v27, v27, v41, v43
  v_min3_u32 v26, v26, v45, v47
  v_max3_u32 v27, v27, v45, v47
  v_cmp_ne_u32 vcc, s16, v26
  v_cmp_ne_u32 s[56:57], s16, v27
  s_nop 0
  s_or_b64 vcc, vcc, s[56:57]
  s_sub_u32 s29, s29, 1
  s_nop 1
  s_cbranch_scc1 L_ok_16
  s_cbranch_vccnz L_rt_17
L_ok_16:
  v_mov_b32 v26, 0xff800000
  v_cndmask_b32_e64 v44, v44, v26, s[76:77]
  s_nop 1
  v_max_f32_dpp v27, v44, v44 row_ror:1 row_mask:0xf bank_mask:0xf
  s_nop 1
  v_max_f32_dpp v27, v27, v27 row_ror:2 row_mask:0xf bank_mask:0xf
  s_nop 1
  v_max_f32_dpp v27, v27, v27 row_ror:4 row_mask:0xf bank_mask:0xf
  v_sub_f32 v44, v44, v27
  v_exp_f32 v44, v44
  s_nop 0
  v_mul_f32 v46, v44, v46
  s_nop 1
  v_add_f32_dpp v46, v46, v46 row_ror:1 row_mask:0xf bank_mask:0xf
  v_mul_f32_dpp v28, v44, v30 row_newbcast:0 row_mask:0xf bank_mask:0xf
  v_mul_f32_dpp v26, v44, v32 row_newbcast:1 row_mask:0xf bank_mask:0xf
  v_add_f32_dpp v46, v46, v46 row_ror:2 row_mask:0xf bank_mask:0xf
  v_fmac_f32_dpp v28, v44, v34 row_newbcast:2 row_mask:0xf bank_mask:0xf
  v_fmac_f32_dpp v26, v44, v36 row_newbcast:3 row_mask:0xf bank_mask:0xf
  v_add_f32_dpp v46, v46, v46 row_ror:4 row_mask:0xf bank_mask:0xf
  v_fmac_f32_dpp v28, v44, v38 row_newbcast:4 row_mask:0xf bank_mask:0xf
  v_fmac_f32_dpp v26, v44, v40 row_newbcast:5 row_mask:0xf bank_mask:0xf
  v_rcp_f32 v46, v46
  v_fmac_f32_dpp v28, v44, v42 row_newbcast:6 row_mask:0xf bank_mask:0xf
  v_add_f32 v28, v28, v26
  v_mul_f32 v28, v28, v46
  v_cvt_pk_bf16_f32 v28, v28, v28
  v_and_b32 v28, v28, v1
  s_nop 1
  v_mov_b32_dpp v10, v28 quad_perm:[0,1,2,3] row_mask:0xf bank_mask:0x1
  v_mov_b32_dpp v11, v28 row_ror:4 row_mask:0xf bank_mask:0x2
  v_mov_b32_dpp v12, v28 row_ror:8 row_mask:0xf bank_mask:0x4
  v_mov_b32_dpp v13, v28 row_ror:12 row_mask:0xf bank_mask:0x8
  s_lshl_b32 s40, s17, 8
  s_add_u32 m0, s40, 0
  v_mfma_f32_16x16x32_bf16 v[30:33], v[80:83], v[10:13], 0
  v_mov_b32_dpp v14, v28 row_ror:12 row_mask:0xf bank_mask:0x1
  v_mov_b32_dpp v15, v28 quad_perm:[0,1,2,3] row_mask:0xf bank_mask:0x2
  v_mov_b32_dpp v16, v28 row_ror:4 row_mask:0xf bank_mask:0x4
  v_mov_b32_dpp v17, v28 row_ror:8 row_mask:0xf bank_mask:0x8
  s_nop 1
  v_mfma_f32_16x16x32_bf16 v[30:33], v[116:119], v[14:17], v[30:33]
  v_mov_b32_dpp v18, v28 row_ror:8 row_mask:0xf bank_mask:0x1
  v_mov_b32_dpp v19, v28 row_ror:12 row_mask:0xf bank_mask:0x2
  v_mov_b32_dpp v20, v28 quad_perm:[0,1,2,3] row_mask:0xf bank_mask:0x4
  v_mov_b32_dpp v21, v28 row_ror:4 row_mask:0xf bank_mask:0x8
  s_nop 1
  v_mfma_f32_16x16x32_bf16 v[30:33], v[152:155], v[18:21], v[30:33]
  v_mov_b32_dpp v22, v28 row_ror:4 row_mask:0xf bank_mask:0x1
  v_mov_b32_dpp v23, v28 row_ror:8 row_mask:0xf bank_mask:0x2
  v_mov_b32_dpp v24, v28 row_ror:12 row_mask:0xf bank_mask:0x4
  v_mov_b32_dpp v25, v28 quad_perm:[0,1,2,3] row_mask:0xf bank_mask:0x8
  s_nop 1
  v_mfma_f32_16x16x32_bf16 v[30:33], v[188:191], v[22:25], v[30:33]
  v_mfma_f32_16x16x32_bf16 v[34:37], v[84:87], v[10:13], 0
  v_mfma_f32_16x16x32_bf16 v[34:37], v[120:123], v[14:17], v[34:37]
  v_mfma_f32_16x16x32_bf16 v[34:37], v[156:159], v[18:21], v[34:37]
  v_mfma_f32_16x16x32_bf16 v[34:37], v[192:195], v[22:25], v[34:37]
  v_mfma_f32_16x16x32_bf16 v[38:41], v[88:91], v[10:13], 0
  s_nop 2
  v_permlane32_swap_b32 v30, v31
  v_permlane32_swap_b32 v32, v33
  v_mfma_f32_16x16x32_bf16 v[38:41], v[124:127], v[14:17], v[38:41]
  v_add_f32_dpp v30, v31, v30 quad_perm:[2,3,2,3] row_mask:0xf bank_mask:0xf
  v_add_f32_dpp v33, v32, v33 quad_perm:[0,1,0,1] row_mask:0xf bank_mask:0xf
  v_mfma_f32_16x16x32_bf16 v[38:41], v[160:163], v[18:21], v[38:41]
  v_cndmask_b32_e64 v30, v30, v33, s[30:31]
  v_mfma_f32_16x16x32_bf16 v[38:41], v[196:199], v[22:25], v[38:41]
  ds_write_addtid_b32 v30 offset:0
  v_mfma_f32_16x16x32_bf16 v[30:33], v[92:95], v[10:13], 0
  v_permlane32_swap_b32 v34, v35
  v_permlane32_swap_b32 v36, v37
  v_mfma_f32_16x16x32_bf16 v[30:33], v[128:131], v[14:17], v[30:33]
  v_add_f32_dpp v34, v35, v34 quad_perm:[2,3,2,3] row_mask:0xf bank_mask:0xf
  v_add_f32_dpp v37, v36, v37 quad_perm:[0,1,0,1] row_mask:0xf bank_mask:0xf
  v_mfma_f32_16x16x32_bf16 v[30:33], v[164:167], v[18:21], v[30:33]
  v_cndmask_b32_e64 v34, v34, v37, s[30:31]
  v_mfma_f32_16x16x32_bf16 v[30:33], v[200:203], v[22:25], v[30:33]
  ds_write_addtid_b32 v34 offset:1024
  v_mfma_f32_16x16x32_bf16 v[34:37], v[96:99], v[10:13], 0
  v_permlane32_swap_b32 v38, v39
  v_permlane32_swap_b32 v40, v41
  v_mfma_f32_16x16x32_bf16 v[34:37], v[132:135], v[14:17], v[34:37]
  v_add_f32_dpp v38, v39, v38 quad_perm:[2,3,2,3] row_mask:0xf bank_mask:0xf
  v_add_f32_dpp v41, v40, v41 quad_perm:[0,1,0,1] row_mask:0xf bank_mask:0xf
  v_mfma_f32_16x16x32_bf16 v[34:37], v[168:171], v[18:21], v[34:37]
  v_cndmask_b32_e64 v38, v38, v41, s[30:31]
  v_mfma_f32_16x16x32_bf16 v[34:37], v[204:207], v[22:25], v[34:37]
  ds_write_addtid_b32 v38 offset:2048
  v_mfma_f32_16x16x32_bf16 v[38:41], v[100:103], v[10:13], 0
  v_permlane32_swap_b32 v30, v31
  v_permlane32_swap_b32 v32, v33
  v_mfma_f32_16x16x32_bf16 v[38:41], v[136:139], v[14:17], v[38:41]
  v_add_f32_dpp v30, v31, v30 quad_perm:[2,3,2,3] row_mask:0xf bank_mask:0xf
  v_add_f32_dpp v33, v32, v33 quad_perm:[0,1,0,1] row_mask:0xf bank_mask:0xf
  v_mfma_f32_16x16x32_bf16 v[38:41], v[172:175], v[18:21], v[38:41]
  v_cndmask_b32_e64 v30, v30, v33, s[30:31]
  v_mfma_f32_16x16x32_bf16 v[38:41], v[208:211], v[22:25], v[38:41]
  ds_write_addtid_b32 v30 offset:3072
  v_mfma_f32_16x16x32_bf16 v[30:33], v[104:107], v[10:13], 0
  v_permlane32_swap_b32 v34, v35
  v_permlane32_swap_b32 v36, v37
  v_mfma_f32_16x16x32_bf16 v[30:33], v[140:143], v[14:17], v[30:33]
  v_add_f32_dpp v34, v35, v34 quad_perm:[2,3,2,3] row_mask:0xf bank_mask:0xf
  v_add_f32_dpp v37, v36, v37 quad_perm:[0,1,0,1] row_mask:0xf bank_mask:0xf
  v_mfma_f32_16x16x32_bf16 v[30:33], v[176:179], v[18:21], v[30:33]
  v_cndmask_b32_e64 v34, v34, v37, s[30:31]
  v_mfma_f32_16x16x32_bf16 v[30:33], v[212:215], v[22:25], v[30:33]
  ds_write_addtid_b32 v34 offset:4096
  v_mfma_f32_16x16x32_bf16 v[34:37], v[108:111], v[10:13], 0
  v_permlane32_swap_b32 v38, v39
  v_permlane32_swap_b32 v40, v41
  v_mfma_f32_16x16x32_bf16 v[34:37], v[144:147], v[14:17], v[34:37]
  v_add_f32_dpp v38, v39, v38 quad_perm:[2,3,2,3] row_mask:0xf bank_mask:0xf
  v_add_f32_dpp v41, v40, v41 quad_perm:[0,1,0,1] row_mask:0xf bank_mask:0xf
  v_mfma_f32_16x16x32_bf16 v[34:37], v[180:183], v[18:21], v[34:37]
  v_cndmask_b32_e64 v38, v38, v41, s[30:31]
  v_mfma_f32_16x16x32_bf16 v[34:37], v[216:219], v[22:25], v[34:37]
  ds_write_addtid_b32 v38 offset:5120
  v_mfma_f32_16x16x32_bf16 v[38:41], v[112:115], v[10:13], 0
  v_permlane32_swap_b32 v30, v31
  v_permlane32_swap_b32 v32, v33
  v_mfma_f32_16x16x32_bf16 v[38:41], v[148:151], v[14:17], v[38:41]
  v_add_f32_dpp v30, v31, v30 quad_perm:[2,3,2,3] row_mask:0xf bank_mask:0xf
  v_add_f32_dpp v33, v32, v33 quad_perm:[0,1,0,1] row_mask:0xf bank_mask:0xf
  v_mfma_f32_16x16x32_bf16 v[38:41], v[184:187], v[18:21], v[38:41]
  v_cndmask_b32_e64 v30, v30, v33, s[30:31]
  v_mfma_f32_16x16x32_bf16 v[38:41], v[220:223], v[22:25], v[38:41]
  ds_write_addtid_b32 v30 offset:6144
  v_permlane32_swap_b32 v34, v35
  v_permlane32_swap_b32 v36, v37
  s_nop 0
  v_add_f32_dpp v34, v35, v34 quad_perm:[2,3,2,3] row_mask:0xf bank_mask:0xf
  v_add_f32_dpp v37, v36, v37 quad_perm:[0,1,0,1] row_mask:0xf bank_mask:0xf
  v_cndmask_b32_e64 v34, v34, v37, s[30:31]
  ds_write_addtid_b32 v34 offset:7168
  v_permlane32_swap_b32 v38, v39
  v_permlane32_swap_b32 v40, v41
  s_nop 0
  v_add_f32_dpp v38, v39, v38 quad_perm:[2,3,2,3] row_mask:0xf bank_mask:0xf
  v_add_f32_dpp v41, v40, v41 quad_perm:[0,1,0,1] row_mask:0xf bank_mask:0xf
  v_cndmask_b32_e64 v38, v38, v41, s[30:31]
  ds_write_addtid_b32 v38 offset:8192
  s_mul_i32 s41, s18, 4608
  s_add_u32 s41, s41, s21
  s_lshl_b32 s42, s17, 9
  s_add_u32 s41, s41, s42
  s_add_u32 s42, s41, 4096
  s_cmp_eq_u32 s17, 0
  s_cselect_b32 s42, s42, 0x7f000000
  s_lshl_b32 s40, s17, 10
  s_waitcnt lgkmcnt(0)
  s_barrier
  s_add_u32 m0, s40, 0
  s_nop 0
  ds_read_addtid_b32 v30 offset:0
  ds_read_addtid_b32 v31 offset:256
  ds_read_addtid_b32 v32 offset:512
  ds_read_addtid_b32 v33 offset:768
  ds_read_addtid_b32 v34 offset:4096
  ds_read_addtid_b32 v35 offset:4352
  ds_read_addtid_b32 v36 offset:4608
  ds_read_addtid_b32 v37 offset:4864
  ds_read_addtid_b32 v38 offset:8192
  ds_read_addtid_b32 v39 offset:8448
  ds_read_addtid_b32 v40 offset:8704
  ds_read_addtid_b32 v41 offset:8960
  s_waitcnt lgkmcnt(8)
  v_add_f32 v30, v30, v31
  v_add_f32 v32, v32, v33
  v_mov_b32 v31, s97
  v_add_f32 v30, v30, v32
  s_waitcnt lgkmcnt(4)
  v_add_f32 v34, v34, v35
  v_add_f32 v36, v36, v37
  v_mov_b32 v35, s97
  v_add_f32 v34, v34, v36
  s_waitcnt lgkmcnt(0)
  v_add_f32 v38, v38, v39
  v_add_f32 v40, v40, v41
  v_mov_b32 v39, s97
  v_add_f32 v38, v38, v40
  s_cmp_eq_u32 s28, 1
  s_cbranch_scc0 L_slow_18
  buffer_store_dwordx2 v[30:31], v3, s[4:7], s41 offen
  buffer_store_dwordx2 v[34:35], v3, s[4:7], s41 offen offset:2048
  buffer_store_dwordx2 v[38:39], v3, s[4:7], s42 offen
  s_branch L_sdone_19
L_slow_18:
  buffer_store_dwordx2 v[30:31], v3, s[4:7], s41 offen sc1
  buffer_store_dwordx2 v[34:35], v3, s[4:7], s41 offen offset:2048 sc1
  buffer_store_dwordx2 v[38:39], v3, s[4:7], s42 offen sc1
L_sdone_19:
  s_mul_i32 s40, s17, 36864
  s_add_u32 s40, s40, s21
  s_mul_i32 s41, s18, 144
  s_add_u32 s40, s40, s41
  v_lshrrev_b32 v40, 3, v0
  v_mul_u32_u24 v37, 4608, v40
  v_and_b32 v41, 7, v0
  v_lshl_add_u32 v36, v41, 4, v37
  v_and_b32 v47, 1, v0
  v_lshl_add_u32 v37, v47, 3, v37
  buffer_load_dwordx4 v[30:33], v36, s[4:7], s40 offen sc1
  buffer_load_dwordx2 v[34:35], v37, s[4:7], s40 offen offset:128 sc1
  s_lshl_b32 s41, s17, 5
  v_lshlrev_b32 v40, 2, v40
  v_add_u32 v40, s41, v40
  v_mul_u32_u24 v38, 288, v41
  v_add_u32 v38, v38, v40
  v_mul_u32_u24 v39, 144, v47
  v_add_u32 v39, v39, v40
  v_lshrrev_b32 v46, 1, v0
  v_mul_u32_u24 v46, 144, v46
  v_lshl_add_u32 v46, v47, 6, v46
  s_barrier
  s_waitcnt vmcnt(0)
  v_min3_u32 v42, v31, v33, v35
  v_max3_u32 v43, v31, v33, v35
  v_cmp_ne_u32 vcc, s97, v42
  v_cmp_ne_u32 s[56:57], s97, v43
  s_nop 0
  s_or_b64 vcc, vcc, s[56:57]
  s_nop 2
  s_cbranch_vccz L_ok_20
  s_mov_b32 s29, 0x2000
L_rt_21:
  buffer_load_dwordx4 v[30:33], v36, s[4:7], s40 offen sc1
  buffer_load_dwordx2 v[34:35], v37, s[4:7], s40 offen offset:128 sc1
  s_waitcnt vmcnt(0)
  v_min3_u32 v42, v31, v33, v35
  v_max3_u32 v43, v31, v33, v35
  v_cmp_ne_u32 vcc, s97, v42
  v_cmp_ne_u32 s[56:57], s97, v43
  s_nop 0
  s_or_b64 vcc, vcc, s[56:57]
  s_sub_u32 s29, s29, 1
  s_nop 1
  s_cbranch_scc1 L_ok_20
  s_cbranch_vccnz L_rt_21
L_ok_20:
  ds_write_b32 v38, v30 offset:0
  ds_write_b32 v38, v32 offset:144
  ds_write_b32 v39, v34 offset:2304
  s_waitcnt lgkmcnt(0)
  s_barrier
  s_cmp_lg_u32 s58, 0
  s_cbranch_scc1 L_red_skip_22
  ds_read_b128 v[30:33], v46 offset:0
  ds_read_b128 v[34:37], v46 offset:16
  ds_read_b128 v[38:41], v46 offset:32
  ds_read_b128 v[42:45], v46 offset:48
  s_waitcnt lgkmcnt(3)
  v_add_f32 v30, v30, v31
  v_add_f32 v32, v32, v33
  v_add_f32 v30, v30, v32
  s_waitcnt lgkmcnt(2)
  v_add_f32 v34, v34, v35
  v_add_f32 v36, v36, v37
  v_add_f32 v34, v34, v36
  s_waitcnt lgkmcnt(1)
  v_add_f32 v38, v38, v39
  v_add_f32 v40, v40, v41
  v_add_f32 v38, v38, v40
  s_waitcnt lgkmcnt(0)
  v_add_f32 v42, v42, v43
  v_add_f32 v44, v44, v45
  v_add_f32 v42, v42, v44
  v_add_f32 v30, v30, v34
  v_add_f32 v38, v38, v42
  v_add_f32 v30, v30, v38
  s_nop 1
  v_add_f32_dpp v31, v30, v30 quad_perm:[1,0,3,2] row_mask:0xf bank_mask:0xf
  v_cvt_pk_bf16_f32 v31, v31, v31
  v_and_b32 v31, 0xffff0000, v31
  v_add_f32 v5, v5, v31
  v_cvt_pk_bf16_f32 v5, v5, v5
  v_and_b32 v5, 0xffff0000, v5
  v_mul_f32 v31, v5, v5
  v_cndmask_b32_e64 v30, v5, v31, s[32:33]
  v_cndmask_b32_e64 v30, 0, v30, s[34:35]
  v_mov_b32 v33, s97
  s_nop 0
  v_add_f32_dpp v30, v30, v30 row_ror:2 row_mask:0xf bank_mask:0xf
  s_nop 1
  v_add_f32_dpp v30, v30, v30 row_ror:4 row_mask:0xf bank_mask:0xf
  s_nop 1
  v_add_f32_dpp v30, v30, v30 row_ror:8 row_mask:0xf bank_mask:0xf
  v_mov_b32 v31, v30
  s_nop 1
  v_permlane16_swap_b32 v30, v31
  v_add_f32 v30, v30, v31
  v_mov_b32 v31, v30
  s_nop 1
  v_permlane32_swap_b32 v30, v31
  v_add_f32 v30, v30, v31
  v_cndmask_b32_e64 v32, v30, v5, s[34:35]
  s_cmp_eq_u32 s28, 1
  s_cbranch_scc0 L_slow_23
  buffer_store_dwordx2 v[32:33], v4, s[4:7], s23 offen
  s_branch L_sdone_24
L_slow_23:
  buffer_store_dwordx2 v[32:33], v4, s[4:7], s23 offen sc1
L_sdone_24:
L_red_skip_22:
  s_barrier
  s_mul_i32 s40, s17, 1152
  s_add_u32 s40, s40, s23
  s_add_u32 s41, s23, 4608
  v_lshlrev_b32 v46, 3, v0
  buffer_load_dwordx2 v[40:41], v46, s[4:7], s41 offen sc1
  buffer_load_dwordx2 v[30:31], v2, s[4:7], s40 offen offset:0 sc1
  buffer_load_dwordx2 v[32:33], v2, s[4:7], s40 offen offset:256 sc1
  buffer_load_dwordx2 v[34:35], v2, s[4:7], s40 offen offset:512 sc1
  buffer_load_dwordx2 v[36:37], v2, s[4:7], s40 offen offset:768 sc1
  buffer_load_dwordx2 v[38:39], v2, s[4:7], s40 offen offset:1024 sc1
  s_waitcnt vmcnt(0)
  v_mov_b32 v47, s97
  v_cndmask_b32_e64 v43, v47, v39, s[36:37]
  v_min3_u32 v47, v31, v33, v35
  v_max3_u32 v42, v31, v33, v35
  v_min3_u32 v47, v47, v37, v43
  v_max3_u32 v42, v42, v37, v43
  v_min_u32 v47, v47, v41
  v_max_u32 v42, v42, v41
  v_cmp_ne_u32 vcc, s97, v47
  v_cmp_ne_u32 s[56:57], s97, v42
  s_nop 0
  s_or_b64 vcc, vcc, s[56:57]
  s_nop 2
  s_cbranch_vccz L_ok_25
  s_mov_b32 s29, 0x2000
L_rt_26:
  buffer_load_dwordx2 v[40:41], v46, s[4:7], s41 offen sc1
  buffer_load_dwordx2 v[30:31], v2, s[4:7], s40 offen offset:0 sc1
  buffer_load_dwordx2 v[32:33], v2, s[4:7], s40 offen offset:256 sc1
  buffer_load_dwordx2 v[34:35], v2, s[4:7], s40 offen offset:512 sc1
  buffer_load_dwordx2 v[36:37], v2, s[4:7], s40 offen offset:768 sc1
  buffer_load_dwordx2 v[38:39], v2, s[4:7], s40 offen offset:1024 sc1
  s_waitcnt vmcnt(0)
  v_mov_b32 v47, s97
  v_cndmask_b32_e64 v43, v47, v39, s[36:37]
  v_min3_u32 v47, v31, v33, v35
  v_max3_u32 v42, v31, v33, v35
  v_min3_u32 v47, v47, v37, v43
  v_max3_u32 v42, v42, v37, v43
  v_min_u32 v47, v47, v41
  v_max_u32 v42, v42, v41
  v_cmp_ne_u32 vcc, s97, v47
  v_cmp_ne_u32 s[56:57], s97, v42
  s_nop 0
  s_or_b64 vcc, vcc, s[56:57]
  s_sub_u32 s29, s29, 1
  s_nop 1
  s_cbranch_scc1 L_ok_25
  s_cbranch_vccnz L_rt_26
L_ok_25:
  v_add_f32_dpp v40, v40, v40 row_ror:2 row_mask:0xf bank_mask:0xf
  s_nop 1
  v_add_f32_dpp v40, v40, v40 row_ror:4 row_mask:0xf bank_mask:0xf
  s_nop 1
  v_add_f32_dpp v40, v40, v40 row_ror:8 row_mask:0xf bank_mask:0xf
  v_mov_b32 v47, v40
  s_nop 1
  v_permlane16_swap_b32 v40, v47
  v_add_f32 v40, v40, v47
  v_mov_b32 v47, v40
  s_nop 1
  v_permlane32_swap_b32 v40, v47
  v_add_f32 v40, v40, v47
  s_nop 1
  v_mov_b32_dpp v47, v40 quad_perm:[0,0,2,2] row_mask:0xf bank_mask:0xf
  v_mov_b32_dpp v41, v40 quad_perm:[1,1,3,3] row_mask:0xf bank_mask:0xf
  v_mul_f32 v47, 0x3ae38e39, v47
  v_mul_f32 v41, 0x3ae38e39, v41
  v_fma_f32 v41, -v47, v47, v41
  v_max_f32 v41, 0, v41
  v_cvt_pk_bf16_f32 v47, v47, v47
  v_and_b32 v47, 0xffff0000, v47
  v_cvt_pk_bf16_f32 v41, v41, v41
  v_sub_f32 v30, v30, v47
  v_sub_f32 v32, v32, v47
  v_and_b32 v41, 0xffff0000, v41
  v_sub_f32 v34, v34, v47
  v_sub_f32 v36, v36, v47
  v_add_f32 v41, 0x3727c5ac, v41
  v_sub_f32 v38, v38, v47
  v_cvt_pk_bf16_f32 v30, v30, v30
  v_cvt_pk_bf16_f32 v41, v41, v41
  v_cvt_pk_bf16_f32 v32, v32, v32
  v_cvt_pk_bf16_f32 v34, v34, v34
  v_and_b32 v41, 0xffff0000, v41
  v_cvt_pk_bf16_f32 v36, v36, v36
  v_cvt_pk_bf16_f32 v38, v38, v38
  v_sqrt_f32 v41, v41
  v_and_b32 v30, 0xffff0000, v30
  v_and_b32 v32, 0xffff0000, v32
  v_cvt_pk_bf16_f32 v41, v41, v41
  v_and_b32 v34, 0xffff0000, v34
  v_and_b32 v36, 0xffff0000, v36
  v_and_b32 v41, 0xffff0000, v41
  v_and_b32 v38, 0xffff0000, v38
  v_rcp_f32 v41, v41
  s_nop 0
  v_mul_f32 v30, v30, v41
  v_mul_f32 v32, v32, v41
  v_mul_f32 v34, v34, v41
  v_mul_f32 v36, v36, v41
  v_mul_f32 v38, v38, v41
  v_cvt_pk_bf16_f32 v30, v30, v30
  v_cvt_pk_bf16_f32 v32, v32, v32
  v_cvt_pk_bf16_f32 v34, v34, v34
  v_cvt_pk_bf16_f32 v36, v36, v36
  v_cvt_pk_bf16_f32 v38, v38, v38
  v_and_b32 v42, v30, v1
  v_and_b32 v43, v32, v1
  v_and_b32 v44, v34, v1
  v_and_b32 v45, v36, v1
  v_and_b32 v46, v38, v1
  s_mul_i32 s40, s17, 5120
  s_add_u32 s40, s40, 124928
  v_lshlrev_b32 v47, 4, v0
  v_add_u32 v47, s40, v47
  ds_read_b128 v[18:21], v47 offset:0
  ds_read_b128 v[22:25], v47 offset:1024
  v_mov_b32_dpp v10, v42 quad_perm:[0,1,2,3] row_mask:0xf bank_mask:0x1
  v_mov_b32_dpp v11, v42 row_ror:4 row_mask:0xf bank_mask:0x2
  v_mov_b32_dpp v12, v42 row_ror:8 row_mask:0xf bank_mask:0x4
  v_mov_b32_dpp v13, v42 row_ror:12 row_mask:0xf bank_mask:0x8
  s_nop 1
  v_mfma_f32_16x16x32_bf16 v[30:33], v[224:227], v[10:13], 0
  v_mov_b32_dpp v14, v43 quad_perm:[0,1,2,3] row_mask:0xf bank_mask:0x1
  v_mov_b32_dpp v15, v43 row_ror:4 row_mask:0xf bank_mask:0x2
  v_mfma_f32_16x16x32_bf16 v[34:37], v[228:231], v[10:13], 0
  v_mov_b32_dpp v16, v43 row_ror:8 row_mask:0xf bank_mask:0x4
  v_mov_b32_dpp v17, v43 row_ror:12 row_mask:0xf bank_mask:0x8
  s_waitcnt lgkmcnt(1)
  v_mfma_f32_16x16x32_bf16 v[38:41], v[18:21], v[10:13], 0
  ds_read_b128 v[18:21], v47 offset:2048
  v_mfma_f32_16x16x32_bf16 v[30:33], a[0:3], v[14:17], v[30:33]
  v_mov_b32_dpp v10, v44 quad_perm:[0,1,2,3] row_mask:0xf bank_mask:0x1
  v_mov_b32_dpp v11, v44 row_ror:4 row_mask:0xf bank_mask:0x2
  v_mfma_f32_16x16x32_bf16 v[34:37], a[4:7], v[14:17], v[34:37]
  v_mov_b32_dpp v12, v44 row_ror:8 row_mask:0xf bank_mask:0x4
  v_mov_b32_dpp v13, v44 row_ror:12 row_mask:0xf bank_mask:0x8
  s_waitcnt lgkmcnt(1)
  v_mfma_f32_16x16x32_bf16 v[38:41], v[22:25], v[14:17], v[38:41]
  ds_read_b128 v[22:25], v47 offset:3072
  v_mfma_f32_16x16x32_bf16 v[30:33], a[32:35], v[10:13], v[30:33]
  v_mov_b32_dpp v14, v45 quad_perm:[0,1,2,3] row_mask:0xf bank_mask:0x1
  v_mov_b32_dpp v15, v45 row_ror:4 row_mask:0xf bank_mask:0x2
  v_mfma_f32_16x16x32_bf16 v[34:37], a[36:39], v[10:13], v[34:37]
  v_mov_b32_dpp v16, v45 row_ror:8 row_mask:0xf bank_mask:0x4
  v_mov_b32_dpp v17, v45 row_ror:12 row_mask:0xf bank_mask:0x8
  s_waitcnt lgkmcnt(1)
  v_mfma_f32_16x16x32_bf16 v[38:41], v[18:21], v[10:13], v[38:41]
  ds_read_b128 v[18:21], v47 offset:4096
  v_mfma_f32_16x16x32_bf16 v[30:33], a[64:67], v[14:17], v[30:33]
  v_mov_b32_dpp v10, v46 quad_perm:[0,1,2,3] row_mask:0xf bank_mask:0x1
  v_mov_b32_dpp v11, v46 row_ror:4 row_mask:0xf bank_mask:0x2
  v_mfma_f32_16x16x32_bf16 v[34:37], a[68:71], v[14:17], v[34:37]
  v_mov_b32_dpp v12, v46 row_ror:8 row_mask:0xf bank_mask:0x4
  v_mov_b32_dpp v13, v46 row_ror:12 row_mask:0xf bank_mask:0x8
  s_waitcnt lgkmcnt(1)
  v_mfma_f32_16x16x32_bf16 v[38:41], v[22:25], v[14:17], v[38:41]
  ds_read_b128 v[22:25], v47 offset:0
  v_mfma_f32_16x16x32_bf16 v[30:33], a[96:99], v[10:13], v[30:33]
  v_mov_b32_dpp v14, v42 row_ror:12 row_mask:0xf bank_mask:0x1
  v_mov_b32_dpp v15, v42 quad_perm:[0,1,2,3] row_mask:0xf bank_mask:0x2
  v_mfma_f32_16x16x32_bf16 v[34:37], a[100:103], v[10:13], v[34:37]
  v_mov_b32_dpp v16, v42 row_ror:4 row_mask:0xf bank_mask:0x4
  v_mov_b32_dpp v17, v42 row_ror:8 row_mask:0xf bank_mask:0x8
  s_waitcnt lgkmcnt(1)
  v_mfma_f32_16x16x32_bf16 v[38:41], v[18:21], v[10:13], v[38:41]
  ds_read_b128 v[18:21], v47 offset:1024
  v_mfma_f32_16x16x32_bf16 v[30:33], v[232:235], v[14:17], v[30:33]
  v_mov_b32_dpp v10, v43 row_ror:12 row_mask:0xf bank_mask:0x1
  v_mov_b32_dpp v11, v43 quad_perm:[0,1,2,3] row_mask:0xf bank_mask:0x2
  v_mfma_f32_16x16x32_bf16 v[34:37], v[236:239], v[14:17], v[34:37]
  v_mov_b32_dpp v12, v43 row_ror:4 row_mask:0xf bank_mask:0x4
  v_mov_b32_dpp v13, v43 row_ror:8 row_mask:0xf bank_mask:0x8
  s_nop 0
  v_add_f32_dpp v27, v40, v38 quad_perm:[2,3,2,3] row_mask:0xf bank_mask:0xf
  v_add_f32_dpp v28, v39, v41 quad_perm:[0,1,0,1] row_mask:0xf bank_mask:0xf
  v_cndmask_b32_e64 v27, v27, v28, s[30:31]
  s_nop 1
  v_mov_b32_dpp v26, v27 quad_perm:[0,1,2,3] row_mask:0x1 bank_mask:0xf
  s_waitcnt lgkmcnt(1)
  v_mfma_f32_16x16x32_bf16 v[38:41], v[22:25], v[14:17], 0
  ds_read_b128 v[22:25], v47 offset:2048
  v_mfma_f32_16x16x32_bf16 v[30:33], a[8:11], v[10:13], v[30:33]
  v_mov_b32_dpp v14, v44 row_ror:12 row_mask:0xf bank_mask:0x1
  v_mov_b32_dpp v15, v44 quad_perm:[0,1,2,3] row_mask:0xf bank_mask:0x2
  v_mfma_f32_16x16x32_bf16 v[34:37], a[12:15], v[10:13], v[34:37]
  v_mov_b32_dpp v16, v44 row_ror:4 row_mask:0xf bank_mask:0x4
  v_mov_b32_dpp v17, v44 row_ror:8 row_mask:0xf bank_mask:0x8
  s_waitcnt lgkmcnt(1)
  v_mfma_f32_16x16x32_bf16 v[38:41], v[18:21], v[10:13], v[38:41]
  ds_read_b128 v[18:21], v47 offset:3072
  v_mfma_f32_16x16x32_bf16 v[30:33], a[40:43], v[14:17], v[30:33]
  v_mov_b32_dpp v10, v45 row_ror:12 row_mask:0xf bank_mask:0x1
  v_mov_b32_dpp v11, v45 quad_perm:[0,1,2,3] row_mask:0xf bank_mask:0x2
  v_mfma_f32_16x16x32_bf16 v[34:37], a[44:47], v[14:17], v[34:37]
  v_mov_b32_dpp v12, v45 row_ror:4 row_mask:0xf bank_mask:0x4
  v_mov_b32_dpp v13, v45 row_ror:8 row_mask:0xf bank_mask:0x8
  s_waitcnt lgkmcnt(1)
  v_mfma_f32_16x16x32_bf16 v[38:41], v[22:25], v[14:17], v[38:41]
  ds_read_b128 v[22:25], v47 offset:4096
  v_mfma_f32_16x16x32_bf16 v[30:33], a[72:75], v[10:13], v[30:33]
  v_mov_b32_dpp v14, v46 row_ror:12 row_mask:0xf bank_mask:0x1
  v_mov_b32_dpp v15, v46 quad_perm:[0,1,2,3] row_mask:0xf bank_mask:0x2
  v_mfma_f32_16x16x32_bf16 v[34:37], a[76:79], v[10:13], v[34:37]
  v_mov_b32_dpp v16, v46 row_ror:4 row_mask:0xf bank_mask:0x4
  v_mov_b32_dpp v17, v46 row_ror:8 row_mask:0xf bank_mask:0x8
  s_waitcnt lgkmcnt(1)
  v_mfma_f32_16x16x32_bf16 v[38:41], v[18:21], v[10:13], v[38:41]
  ds_read_b128 v[18:21], v47 offset:0
  v_mfma_f32_16x16x32_bf16 v[30:33], a[104:107], v[14:17], v[30:33]
  v_mov_b32_dpp v10, v42 row_ror:8 row_mask:0xf bank_mask:0x1
  v_mov_b32_dpp v11, v42 row_ror:12 row_mask:0xf bank_mask:0x2
  v_mfma_f32_16x16x32_bf16 v[34:37], a[108:111], v[14:17], v[34:37]
  v_mov_b32_dpp v12, v42 quad_perm:[0,1,2,3] row_mask:0xf bank_mask:0x4
  v_mov_b32_dpp v13, v42 row_ror:4 row_mask:0xf bank_mask:0x8
  s_waitcnt lgkmcnt(1)
  v_mfma_f32_16x16x32_bf16 v[38:41], v[22:25], v[14:17], v[38:41]
  ds_read_b128 v[22:25], v47 offset:1024
  v_mfma_f32_16x16x32_bf16 v[30:33], v[240:243], v[10:13], v[30:33]
  v_mov_b32_dpp v14, v43 row_ror:8 row_mask:0xf bank_mask:0x1
  v_mov_b32_dpp v15, v43 row_ror:12 row_mask:0xf bank_mask:0x2
  v_mfma_f32_16x16x32_bf16 v[34:37], v[244:247], v[10:13], v[34:37]
  v_mov_b32_dpp v16, v43 quad_perm:[0,1,2,3] row_mask:0xf bank_mask:0x4
  v_mov_b32_dpp v17, v43 row_ror:4 row_mask:0xf bank_mask:0x8
  s_nop 0
  v_add_f32_dpp v27, v40, v38 quad_perm:[2,3,2,3] row_mask:0xf bank_mask:0xf
  v_add_f32_dpp v28, v39, v41 quad_perm:[0,1,0,1] row_mask:0xf bank_mask:0xf
  v_cndmask_b32_e64 v27, v27, v28, s[30:31]
  s_nop 1
  v_mov_b32_dpp v26, v27 quad_perm:[0,1,2,3] row_mask:0x2 bank_mask:0xf
  s_waitcnt lgkmcnt(1)
  v_mfma_f32_16x16x32_bf16 v[38:41], v[18:21], v[10:13], 0
  ds_read_b128 v[18:21], v47 offset:2048
  v_mfma_f32_16x16x32_bf16 v[30:33], a[16:19], v[14:17], v[30:33]
  v_mov_b32_dpp v10, v44 row_ror:8 row_mask:0xf bank_mask:0x1
  v_mov_b32_dpp v11, v44 row_ror:12 row_mask:0xf bank_mask:0x2
  v_mfma_f32_16x16x32_bf16 v[34:37], a[20:23], v[14:17], v[34:37]
  v_mov_b32_dpp v12, v44 quad_perm:[0,1,2,3] row_mask:0xf bank_mask:0x4
  v_mov_b32_dpp v13, v44 row_ror:4 row_mask:0xf bank_mask:0x8
  s_waitcnt lgkmcnt(1)
  v_mfma_f32_16x16x32_bf16 v[38:41], v[22:25], v[14:17], v[38:41]
  ds_read_b128 v[22:25], v47 offset:3072
  v_mfma_f32_16x16x32_bf16 v[30:33], a[48:51], v[10:13], v[30:33]
  v_mov_b32_dpp v14, v45 row_ror:8 row_mask:0xf bank_mask:0x1
  v_mov_b32_dpp v15, v45 row_ror:12 row_mask:0xf bank_mask:0x2
  v_mfma_f32_16x16x32_bf16 v[34:37], a[52:55], v[10:13], v[34:37]
  v_mov_b32_dpp v16, v45 quad_perm:[0,1,2,3] row_mask:0xf bank_mask:0x4
  v_mov_b32_dpp v17, v45 row_ror:4 row_mask:0xf bank_mask:0x8
  s_waitcnt lgkmcnt(1)
  v_mfma_f32_16x16x32_bf16 v[38:41], v[18:21], v[10:13], v[38:41]
  ds_read_b128 v[18:21], v47 offset:0
  v_mfma_f32_16x16x32_bf16 v[30:33], a[80:83], v[14:17], v[30:33]
  v_mov_b32_dpp v10, v42 row_ror:4 row_mask:0xf bank_mask:0x1
  v_mov_b32_dpp v11, v42 row_ror:8 row_mask:0xf bank_mask:0x2
  v_mfma_f32_16x16x32_bf16 v[34:37], a[84:87], v[14:17], v[34:37]
  v_mov_b32_dpp v12, v42 row_ror:12 row_mask:0xf bank_mask:0x4
  v_mov_b32_dpp v13, v42 quad_perm:[0,1,2,3] row_mask:0xf bank_mask:0x8
  s_waitcnt lgkmcnt(1)
  v_mfma_f32_16x16x32_bf16 v[38:41], v[22:25], v[14:17], v[38:41]
  ds_read_b128 v[22:25], v47 offset:1024
  v_mfma_f32_16x16x32_bf16 v[30:33], v[248:251], v[10:13], v[30:33]
  v_mov_b32_dpp v14, v43 row_ror:4 row_mask:0xf bank_mask:0x1
  v_mov_b32_dpp v15, v43 row_ror:8 row_mask:0xf bank_mask:0x2
  v_mfma_f32_16x16x32_bf16 v[34:37], v[252:255], v[10:13], v[34:37]
  v_mov_b32_dpp v16, v43 row_ror:12 row_mask:0xf bank_mask:0x4
  v_mov_b32_dpp v17, v43 quad_perm:[0,1,2,3] row_mask:0xf bank_mask:0x8
  s_nop 0
  v_add_f32_dpp v27, v40, v38 quad_perm:[2,3,2,3] row_mask:0xf bank_mask:0xf
  v_add_f32_dpp v28, v39, v41 quad_perm:[0,1,0,1] row_mask:0xf bank_mask:0xf
  v_cndmask_b32_e64 v27, v27, v28, s[30:31]
  s_nop 1
  v_mov_b32_dpp v26, v27 quad_perm:[0,1,2,3] row_mask:0x4 bank_mask:0xf
  s_waitcnt lgkmcnt(1)
  v_mfma_f32_16x16x32_bf16 v[38:41], v[18:21], v[10:13], 0
  ds_read_b128 v[18:21], v47 offset:2048
  v_mfma_f32_16x16x32_bf16 v[30:33], a[24:27], v[14:17], v[30:33]
  v_mov_b32_dpp v10, v44 row_ror:4 row_mask:0xf bank_mask:0x1
  v_mov_b32_dpp v11, v44 row_ror:8 row_mask:0xf bank_mask:0x2
  v_mfma_f32_16x16x32_bf16 v[34:37], a[28:31], v[14:17], v[34:37]
  v_mov_b32_dpp v12, v44 row_ror:12 row_mask:0xf bank_mask:0x4
  v_mov_b32_dpp v13, v44 quad_perm:[0,1,2,3] row_mask:0xf bank_mask:0x8
  s_waitcnt lgkmcnt(1)
  v_mfma_f32_16x16x32_bf16 v[38:41], v[22:25], v[14:17], v[38:41]
  ds_read_b128 v[22:25], v47 offset:3072
  v_mfma_f32_16x16x32_bf16 v[30:33], a[56:59], v[10:13], v[30:33]
  v_mov_b32_dpp v14, v45 row_ror:4 row_mask:0xf bank_mask:0x1
  v_mov_b32_dpp v15, v45 row_ror:8 row_mask:0xf bank_mask:0x2
  v_mfma_f32_16x16x32_bf16 v[34:37], a[60:63], v[10:13], v[34:37]
  v_mov_b32_dpp v16, v45 row_ror:12 row_mask:0xf bank_mask:0x4
  v_mov_b32_dpp v17, v45 quad_perm:[0,1,2,3] row_mask:0xf bank_mask:0x8
  s_waitcnt lgkmcnt(1)
  v_mfma_f32_16x16x32_bf16 v[38:41], v[18:21], v[10:13], v[38:41]
  v_mfma_f32_16x16x32_bf16 v[30:33], a[88:91], v[14:17], v[30:33]
  v_mfma_f32_16x16x32_bf16 v[34:37], a[92:95], v[14:17], v[34:37]
  s_waitcnt lgkmcnt(0)
  v_mfma_f32_16x16x32_bf16 v[38:41], v[22:25], v[14:17], v[38:41]
  v_lshrrev_b32 v47, 1, v3
  s_mul_i32 s40, s17, 576
  v_add_u32 v47, s40, v47
  s_nop 1
  v_permlane32_swap_b32 v30, v31
  v_permlane32_swap_b32 v34, v35
  v_permlane32_swap_b32 v32, v33
  v_permlane32_swap_b32 v36, v37
  v_add_f32_dpp v30, v31, v30 quad_perm:[2,3,2,3] row_mask:0xf bank_mask:0xf
  v_add_f32_dpp v34, v35, v34 quad_perm:[2,3,2,3] row_mask:0xf bank_mask:0xf
  v_add_f32_dpp v33, v32, v33 quad_perm:[0,1,0,1] row_mask:0xf bank_mask:0xf
  v_add_f32_dpp v37, v36, v37 quad_perm:[0,1,0,1] row_mask:0xf bank_mask:0xf
  v_cndmask_b32_e64 v30, v30, v33, s[30:31]
  v_cndmask_b32_e64 v34, v34, v37, s[30:31]
  ds_write_b32 v47, v30 offset:0
  ds_write_b32 v47, v34 offset:256
  v_bfe_u32 v46, v0, 1, 1
  v_lshlrev_b32 v46, 5, v46
  v_bfe_u32 v45, v0, 2, 2
  v_lshl_add_u32 v46, v45, 3, v46
  v_and_b32 v45, 1, v0
  v_lshl_add_u32 v46, v45, 2, v46
  v_add_u32 v46, s40, v46
  v_add_f32_dpp v27, v40, v38 quad_perm:[2,3,2,3] row_mask:0xf bank_mask:0xf
  v_add_f32_dpp v28, v39, v41 quad_perm:[0,1,0,1] row_mask:0xf bank_mask:0xf
  v_cndmask_b32_e64 v27, v27, v28, s[30:31]
  s_nop 1
  v_mov_b32_dpp v26, v27 quad_perm:[0,1,2,3] row_mask:0x8 bank_mask:0xf
  v_mov_b32 v27, v26
  s_nop 1
  v_permlane16_swap_b32 v26, v27
  v_add_f32 v26, v26, v27
  v_mov_b32 v27, v26
  s_nop 1
  v_permlane32_swap_b32 v26, v27
  v_add_f32 v26, v26, v27
  ds_write_b32 v46, v26 offset:512
  v_lshrrev_b32 v45, 1, v2
  s_lshl_b32 s40, s17, 7
  v_add_u32 v47, s40, v45
  s_lshr_b32 s40, s17, 1
  s_lshl_b32 s40, s40, 5
  v_add_u32 v46, s40, v45
  s_waitcnt lgkmcnt(0)
  s_barrier
  ds_read_b32 v30, v47 offset:0
  ds_read_b32 v31, v47 offset:576
  ds_read_b32 v32, v47 offset:1152
  ds_read_b32 v33, v47 offset:1728
  ds_read_b32 v34, v46 offset:512
  ds_read_b32 v35, v46 offset:1088
  ds_read_b32 v36, v46 offset:1664
  ds_read_b32 v37, v46 offset:2240
  s_lshr_b32 s41, s17, 1
  s_mul_i32 s41, s41, 9216
  s_add_u32 s41, s41, 145408
  v_lshlrev_b32 v42, 4, v0
  v_add_u32 v42, s41, v42
  ds_read_b128 v[44:47], v42
  v_mov_b32 v18, 0
  v_mov_b32 v19, 0
  v_mov_b32 v20, 0
  v_mov_b32 v21, 0
  v_mov_b32 v22, 0
  v_mov_b32 v23, 0
  v_mov_b32 v24, 0
  v_mov_b32 v25, 0
  v_mov_b32 v26, 0
  v_mov_b32 v27, 0
  v_mov_b32 v28, 0
  v_mov_b32 v29, 0
  s_waitcnt lgkmcnt(1)
  s_barrier
  v_add_f32 v30, v30, v31
  v_add_f32 v34, v34, v35
  v_add_f32 v32, v32, v33
  v_add_f32 v36, v36, v37
  v_add_f32 v30, v30, v32
  v_add_f32 v34, v34, v36
  v_cvt_pk_bf16_f32 v30, v30, v30
  v_cvt_pk_bf16_f32 v34, v34, v34
  v_and_b32 v30, 0xffff0000, v30
  v_and_b32 v34, 0xffff0000, v34
  v_add_f32 v30, v30, v7
  v_add_f32 v34, v34, v9
  v_cvt_pk_bf16_f32 v30, v30, v30
  v_cvt_pk_bf16_f32 v34, v34, v34
  v_and_b32 v30, 0xffff0000, v30
  v_and_b32 v34, 0xffff0000, v34
  v_mul_f32 v38, v30, v30
  v_mul_f32 v40, v34, v34
  v_mov_b32 v39, 0xc0135761
  v_mov_b32 v41, 0xc0135761
  v_fmac_f32 v39, 0xbdd2d3e8, v38
  v_fmac_f32 v41, 0xbdd2d3e8, v40
  v_mul_f32 v39, v39, v30
  v_mul_f32 v41, v41, v34
  v_exp_f32 v39, v39
  v_exp_f32 v41, v41
  v_add_f32 v39, 1.0, v39
  v_add_f32 v41, 1.0, v41
  v_rcp_f32 v39, v39
  v_rcp_f32 v41, v41
  v_mul_f32 v30, v30, v39
  v_mul_f32 v34, v34, v41
  v_cvt_pk_bf16_f32 v30, v30, v30
  v_cvt_pk_bf16_f32 v34, v34, v34
  v_and_b32 v30, v30, v1
  v_and_b32 v34, v34, v1
  v_cndmask_b32_e64 v34, 0, v34, s[38:39]
  s_nop 1
  v_mov_b32_dpp v26, v34 quad_perm:[0,1,2,3] row_mask:0xf bank_mask:0x1
  v_mov_b32_dpp v27, v34 row_ror:4 row_mask:0xf bank_mask:0x2
  v_mov_b32_dpp v28, v34 row_ror:8 row_mask:0xf bank_mask:0x4
  v_mov_b32_dpp v29, v34 row_ror:12 row_mask:0xf bank_mask:0x8
  v_mov_b32 v43, v30
  v_mov_b32_dpp v10, v30 quad_perm:[0,1,2,3] row_mask:0xf bank_mask:0x1
  v_mov_b32_dpp v11, v30 row_ror:4 row_mask:0xf bank_mask:0x2
  v_mov_b32_dpp v12, v30 row_ror:8 row_mask:0xf bank_mask:0x4
  v_mov_b32_dpp v13, v30 row_ror:12 row_mask:0xf bank_mask:0x8
  s_lshl_b32 s40, s17, 8
  s_add_u32 m0, s40, 0
  s_waitcnt lgkmcnt(0)
  v_mfma_f32_16x16x32_bf16 v[30:33], v[44:47], v[26:29], 0
  ds_read_b128 v[44:47], v42 offset:1024
  v_mfma_f32_16x16x32_bf16 v[30:33], a[112:115], v[10:13], v[30:33]
  v_mov_b32_dpp v14, v43 row_ror:12 row_mask:0xf bank_mask:0x1
  v_mov_b32_dpp v15, v43 quad_perm:[0,1,2,3] row_mask:0xf bank_mask:0x2
  v_mov_b32_dpp v16, v43 row_ror:4 row_mask:0xf bank_mask:0x4
  v_mov_b32_dpp v17, v43 row_ror:8 row_mask:0xf bank_mask:0x8
  s_nop 1
  v_mfma_f32_16x16x32_bf16 v[30:33], a[148:151], v[14:17], v[30:33]
  v_mov_b32_dpp v18, v43 row_ror:8 row_mask:0xf bank_mask:0x1
  v_mov_b32_dpp v19, v43 row_ror:12 row_mask:0xf bank_mask:0x2
  v_mov_b32_dpp v20, v43 quad_perm:[0,1,2,3] row_mask:0xf bank_mask:0x4
  v_mov_b32_dpp v21, v43 row_ror:4 row_mask:0xf bank_mask:0x8
  s_nop 1
  v_mfma_f32_16x16x32_bf16 v[30:33], a[184:187], v[18:21], v[30:33]
  v_mov_b32_dpp v22, v43 row_ror:4 row_mask:0xf bank_mask:0x1
  v_mov_b32_dpp v23, v43 row_ror:8 row_mask:0xf bank_mask:0x2
  v_mov_b32_dpp v24, v43 row_ror:12 row_mask:0xf bank_mask:0x4
  v_mov_b32_dpp v25, v43 quad_perm:[0,1,2,3] row_mask:0xf bank_mask:0x8
  s_nop 1
  v_mfma_f32_16x16x32_bf16 v[30:33], a[220:223], v[22:25], v[30:33]
  s_waitcnt lgkmcnt(0)
  v_mfma_f32_16x16x32_bf16 v[34:37], v[44:47], v[26:29], 0
  ds_read_b128 v[44:47], v42 offset:2048
  v_mfma_f32_16x16x32_bf16 v[34:37], a[116:119], v[10:13], v[34:37]
  v_mfma_f32_16x16x32_bf16 v[34:37], a[152:155], v[14:17], v[34:37]
  v_mfma_f32_16x16x32_bf16 v[34:37], a[188:191], v[18:21], v[34:37]
  v_mfma_f32_16x16x32_bf16 v[34:37], a[224:227], v[22:25], v[34:37]
  s_waitcnt lgkmcnt(0)
  v_mfma_f32_16x16x32_bf16 v[38:41], v[44:47], v[26:29], 0
  ds_read_b128 v[44:47], v42 offset:3072
  v_mfma_f32_16x16x32_bf16 v[38:41], a[120:123], v[10:13], v[38:41]
  v_permlane32_swap_b32 v30, v31
  v_permlane32_swap_b32 v32, v33
  v_mfma_f32_16x16x32_bf16 v[38:41], a[156:159], v[14:17], v[38:41]
  v_add_f32_dpp v30, v31, v30 quad_perm:[2,3,2,3] row_mask:0xf bank_mask:0xf
  v_add_f32_dpp v33, v32, v33 quad_perm:[0,1,0,1] row_mask:0xf bank_mask:0xf
  v_mfma_f32_16x16x32_bf16 v[38:41], a[192:195], v[18:21], v[38:41]
  v_cndmask_b32_e64 v30, v30, v33, s[30:31]
  v_mfma_f32_16x16x32_bf16 v[38:41], a[228:231], v[22:25], v[38:41]
  ds_write_addtid_b32 v30 offset:0
  s_waitcnt lgkmcnt(1)
  v_mfma_f32_16x16x32_bf16 v[30:33], v[44:47], v[26:29], 0
  ds_read_b128 v[44:47], v42 offset:4096
  v_mfma_f32_16x16x32_bf16 v[30:33], a[124:127], v[10:13], v[30:33]
  v_permlane32_swap_b32 v34, v35
  v_permlane32_swap_b32 v36, v37
  v_mfma_f32_16x16x32_bf16 v[30:33], a[160:163], v[14:17], v[30:33]
  v_add_f32_dpp v34, v35, v34 quad_perm:[2,3,2,3] row_mask:0xf bank_mask:0xf
  v_add_f32_dpp v37, v36, v37 quad_perm:[0,1,0,1] row_mask:0xf bank_mask:0xf
  v_mfma_f32_16x16x32_bf16 v[30:33], a[196:199], v[18:21], v[30:33]
  v_cndmask_b32_e64 v34, v34, v37, s[30:31]
  v_mfma_f32_16x16x32_bf16 v[30:33], a[232:235], v[22:25], v[30:33]
  ds_write_addtid_b32 v34 offset:1024
  s_waitcnt lgkmcnt(1)
  v_mfma_f32_16x16x32_bf16 v[34:37], v[44:47], v[26:29], 0
  ds_read_b128 v[44:47], v42 offset:5120
  v_mfma_f32_16x16x32_bf16 v[34:37], a[128:131], v[10:13], v[34:37]
  v_permlane32_swap_b32 v38, v39
  v_permlane32_swap_b32 v40, v41
  v_mfma_f32_16x16x32_bf16 v[34:37], a[164:167], v[14:17], v[34:37]
  v_add_f32_dpp v38, v39, v38 quad_perm:[2,3,2,3] row_mask:0xf bank_mask:0xf
  v_add_f32_dpp v41, v40, v41 quad_perm:[0,1,0,1] row_mask:0xf bank_mask:0xf
  v_mfma_f32_16x16x32_bf16 v[34:37], a[200:203], v[18:21], v[34:37]
  v_cndmask_b32_e64 v38, v38, v41, s[30:31]
  v_mfma_f32_16x16x32_bf16 v[34:37], a[236:239], v[22:25], v[34:37]
  ds_write_addtid_b32 v38 offset:2048
  s_waitcnt lgkmcnt(1)
  v_mfma_f32_16x16x32_bf16 v[38:41], v[44:47], v[26:29], 0
  ds_read_b128 v[44:47], v42 offset:6144
  v_mfma_f32_16x16x32_bf16 v[38:41], a[132:135], v[10:13], v[38:41]
  v_permlane32_swap_b32 v30, v31
  v_permlane32_swap_b32 v32, v33
  v_mfma_f32_16x16x32_bf16 v[38:41], a[168:171], v[14:17], v[38:41]
  v_add_f32_dpp v30, v31, v30 quad_perm:[2,3,2,3] row_mask:0xf bank_mask:0xf
  v_add_f32_dpp v33, v32, v33 quad_perm:[0,1,0,1] row_mask:0xf bank_mask:0xf
  v_mfma_f32_16x16x32_bf16 v[38:41], a[204:207], v[18:21], v[38:41]
  v_cndmask_b32_e64 v30, v30, v33, s[30:31]
  v_mfma_f32_16x16x32_bf16 v[38:41], a[240:243], v[22:25], v[38:41]
  ds_write_addtid_b32 v30 offset:3072
  s_waitcnt lgkmcnt(1)
  v_mfma_f32_16x16x32_bf16 v[30:33], v[44:47], v[26:29], 0
  ds_read_b128 v[44:47], v42 offset:7168
  v_mfma_f32_16x16x32_bf16 v[30:33], a[136:139], v[10:13], v[30:33]
  v_permlane32_swap_b32 v34, v35
  v_permlane32_swap_b32 v36, v37
  v_mfma_f32_16x16x32_bf16 v[30:33], a[172:175], v[14:17], v[30:33]
  v_add_f32_dpp v34, v35, v34 quad_perm:[2,3,2,3] row_mask:0xf bank_mask:0xf
  v_add_f32_dpp v37, v36, v37 quad_perm:[0,1,0,1] row_mask:0xf bank_mask:0xf
  v_mfma_f32_16x16x32_bf16 v[30:33], a[208:211], v[18:21], v[30:33]
  v_cndmask_b32_e64 v34, v34, v37, s[30:31]
  v_mfma_f32_16x16x32_bf16 v[30:33], a[244:247], v[22:25], v[30:33]
  ds_write_addtid_b32 v34 offset:4096
  s_waitcnt lgkmcnt(1)
  v_mfma_f32_16x16x32_bf16 v[34:37], v[44:47], v[26:29], 0
  ds_read_b128 v[44:47], v42 offset:8192
  v_mfma_f32_16x16x32_bf16 v[34:37], a[140:143], v[10:13], v[34:37]
  v_permlane32_swap_b32 v38, v39
  v_permlane32_swap_b32 v40, v41
  v_mfma_f32_16x16x32_bf16 v[34:37], a[176:179], v[14:17], v[34:37]
  v_add_f32_dpp v38, v39, v38 quad_perm:[2,3,2,3] row_mask:0xf bank_mask:0xf
  v_add_f32_dpp v41, v40, v41 quad_perm:[0,1,0,1] row_mask:0xf bank_mask:0xf
  v_mfma_f32_16x16x32_bf16 v[34:37], a[212:215], v[18:21], v[34:37]
  v_cndmask_b32_e64 v38, v38, v41, s[30:31]
  v_mfma_f32_16x16x32_bf16 v[34:37], a[248:251], v[22:25], v[34:37]
  ds_write_addtid_b32 v38 offset:5120
  s_waitcnt lgkmcnt(1)
  v_mfma_f32_16x16x32_bf16 v[38:41], v[44:47], v[26:29], 0
  v_mfma_f32_16x16x32_bf16 v[38:41], a[144:147], v[10:13], v[38:41]
  v_permlane32_swap_b32 v30, v31
  v_permlane32_swap_b32 v32, v33
  v_mfma_f32_16x16x32_bf16 v[38:41], a[180:183], v[14:17], v[38:41]
  v_add_f32_dpp v30, v31, v30 quad_perm:[2,3,2,3] row_mask:0xf bank_mask:0xf
  v_add_f32_dpp v33, v32, v33 quad_perm:[0,1,0,1] row_mask:0xf bank_mask:0xf
  v_mfma_f32_16x16x32_bf16 v[38:41], a[216:219], v[18:21], v[38:41]
  v_cndmask_b32_e64 v30, v30, v33, s[30:31]
  v_mfma_f32_16x16x32_bf16 v[38:41], a[252:255], v[22:25], v[38:41]
  ds_write_addtid_b32 v30 offset:6144
  v_permlane32_swap_b32 v34, v35
  v_permlane32_swap_b32 v36, v37
  s_nop 0
  v_add_f32_dpp v34, v35, v34 quad_perm:[2,3,2,3] row_mask:0xf bank_mask:0xf
  v_add_f32_dpp v37, v36, v37 quad_perm:[0,1,0,1] row_mask:0xf bank_mask:0xf
  v_cndmask_b32_e64 v34, v34, v37, s[30:31]
  ds_write_addtid_b32 v34 offset:7168
  v_permlane32_swap_b32 v38, v39
  v_permlane32_swap_b32 v40, v41
  s_nop 0
  v_add_f32_dpp v38, v39, v38 quad_perm:[2,3,2,3] row_mask:0xf bank_mask:0xf
  v_add_f32_dpp v41, v40, v41 quad_perm:[0,1,0,1] row_mask:0xf bank_mask:0xf
  v_cndmask_b32_e64 v38, v38, v41, s[30:31]
  ds_write_addtid_b32 v38 offset:8192
  s_mul_i32 s41, s18, 4608
  s_add_u32 s41, s41, s22
  s_lshl_b32 s42, s17, 9
  s_add_u32 s41, s41, s42
  s_add_u32 s42, s41, 4096
  s_cmp_eq_u32 s17, 0
  s_cselect_b32 s42, s42, 0x7f000000
  s_lshl_b32 s40, s17, 10
  s_waitcnt lgkmcnt(0)
  s_barrier
  s_add_u32 m0, s40, 0
  s_nop 0
  ds_read_addtid_b32 v30 offset:0
  ds_read_addtid_b32 v31 offset:256
  ds_read_addtid_b32 v32 offset:512
  ds_read_addtid_b32 v33 offset:768
  ds_read_addtid_b32 v34 offset:4096
  ds_read_addtid_b32 v35 offset:4352
  ds_read_addtid_b32 v36 offset:4608
  ds_read_addtid_b32 v37 offset:4864
  ds_read_addtid_b32 v38 offset:8192
  ds_read_addtid_b32 v39 offset:8448
  ds_read_addtid_b32 v40 offset:8704
  ds_read_addtid_b32 v41 offset:8960
  s_waitcnt lgkmcnt(8)
  v_add_f32 v30, v30, v31
  v_add_f32 v32, v32, v33
  v_mov_b32 v31, s97
  v_add_f32 v30, v30, v32
  s_waitcnt lgkmcnt(4)
  v_add_f32 v34, v34, v35
  v_add_f32 v36, v36, v37
  v_mov_b32 v35, s97
  v_add_f32 v34, v34, v36
  s_waitcnt lgkmcnt(0)
  v_add_f32 v38, v38, v39
  v_add_f32 v40, v40, v41
  v_mov_b32 v39, s97
  v_add_f32 v38, v38, v40
  s_cmp_eq_u32 s28, 1
  s_cbranch_scc0 L_slow_27
  buffer_store_dwordx2 v[30:31], v3, s[4:7], s41 offen
  buffer_store_dwordx2 v[34:35], v3, s[4:7], s41 offen offset:2048
  buffer_store_dwordx2 v[38:39], v3, s[4:7], s42 offen
  s_branch L_sdone_28
L_slow_27:
  buffer_store_dwordx2 v[30:31], v3, s[4:7], s41 offen sc1
  buffer_store_dwordx2 v[34:35], v3, s[4:7], s41 offen offset:2048 sc1
  buffer_store_dwordx2 v[38:39], v3, s[4:7], s42 offen sc1
L_sdone_28:
  s_mul_i32 s40, s17, 36864
  s_add_u32 s40, s40, s22
  s_mul_i32 s41, s18, 144
  s_add_u32 s40, s40, s41
  v_lshrrev_b32 v40, 3, v0
  v_mul_u32_u24 v37, 4608, v40
  v_and_b32 v41, 7, v0
  v_lshl_add_u32 v36, v41, 4, v37
  v_and_b32 v47, 1, v0
  v_lshl_add_u32 v37, v47, 3, v37
  buffer_load_dwordx4 v[30:33], v36, s[4:7], s40 offen sc1
  buffer_load_dwordx2 v[34:35], v37, s[4:7], s40 offen offset:128 sc1
  s_lshl_b32 s41, s17, 5
  v_lshlrev_b32 v40, 2, v40
  v_add_u32 v40, s41, v40
  v_mul_u32_u24 v38, 288, v41
  v_add_u32 v38, v38, v40
  v_mul_u32_u24 v39, 144, v47
  v_add_u32 v39, v39, v40
  v_lshrrev_b32 v46, 1, v0
  v_mul_u32_u24 v46, 144, v46
  v_lshl_add_u32 v46, v47, 6, v46
  s_barrier
  s_waitcnt vmcnt(0)
  v_min3_u32 v42, v31, v33, v35
  v_max3_u32 v43, v31, v33, v35
  v_cmp_ne_u32 vcc, s97, v42
  v_cmp_ne_u32 s[56:57], s97, v43
  s_nop 0
  s_or_b64 vcc, vcc, s[56:57]
  s_nop 2
  s_cbranch_vccz L_ok_29
  s_mov_b32 s29, 0x2000
L_rt_30:
  buffer_load_dwordx4 v[30:33], v36, s[4:7], s40 offen sc1
  buffer_load_dwordx2 v[34:35], v37, s[4:7], s40 offen offset:128 sc1
  s_waitcnt vmcnt(0)
  v_min3_u32 v42, v31, v33, v35
  v_max3_u32 v43, v31, v33, v35
  v_cmp_ne_u32 vcc, s97, v42
  v_cmp_ne_u32 s[56:57], s97, v43
  s_nop 0
  s_or_b64 vcc, vcc, s[56:57]
  s_sub_u32 s29, s29, 1
  s_nop 1
  s_cbranch_scc1 L_ok_29
  s_cbranch_vccnz L_rt_30
L_ok_29:
  ds_write_b32 v38, v30 offset:0
  ds_write_b32 v38, v32 offset:144
  ds_write_b32 v39, v34 offset:2304
  s_waitcnt lgkmcnt(0)
  s_barrier
  s_cmp_lg_u32 s58, 0
  s_cbranch_scc1 L_red_skip_31
  ds_read_b128 v[30:33], v46 offset:0
  ds_read_b128 v[34:37], v46 offset:16
  ds_read_b128 v[38:41], v46 offset:32
  ds_read_b128 v[42:45], v46 offset:48
  s_waitcnt lgkmcnt(3)
  v_add_f32 v30, v30, v31
  v_add_f32 v32, v32, v33
  v_add_f32 v30, v30, v32
  s_waitcnt lgkmcnt(2)
  v_add_f32 v34, v34, v35
  v_add_f32 v36, v36, v37
  v_add_f32 v34, v34, v36
  s_waitcnt lgkmcnt(1)
  v_add_f32 v38, v38, v39
  v_add_f32 v40, v40, v41
  v_add_f32 v38, v38, v40
  s_waitcnt lgkmcnt(0)
  v_add_f32 v42, v42, v43
  v_add_f32 v44, v44, v45
  v_add_f32 v42, v42, v44
  v_add_f32 v30, v30, v34
  v_add_f32 v38, v38, v42
  v_add_f32 v30, v30, v38
  s_nop 1
  v_add_f32_dpp v31, v30, v30 quad_perm:[1,0,3,2] row_mask:0xf bank_mask:0xf
  v_cvt_pk_bf16_f32 v31, v31, v31
  v_and_b32 v31, 0xffff0000, v31
  v_add_f32 v31, v31, v8
  v_cvt_pk_bf16_f32 v31, v31, v31
  v_and_b32 v31, 0xffff0000, v31
  v_add_f32 v5, v5, v31
  v_cvt_pk_bf16_f32 v5, v5, v5
  v_and_b32 v5, 0xffff0000, v5
  s_cmp_eq_u32 s27, 1
  s_nop 0
  s_cbranch_scc1 L_t2out_32
  v_mul_f32 v31, v5, v5
  v_cndmask_b32_e64 v30, v5, v31, s[32:33]
  v_cndmask_b32_e64 v30, 0, v30, s[34:35]
  v_mov_b32 v33, s97
  s_nop 0
  v_add_f32_dpp v30, v30, v30 row_ror:2 row_mask:0xf bank_mask:0xf
  s_nop 1
  v_add_f32_dpp v30, v30, v30 row_ror:4 row_mask:0xf bank_mask:0xf
  s_nop 1
  v_add_f32_dpp v30, v30, v30 row_ror:8 row_mask:0xf bank_mask:0xf
  v_mov_b32 v31, v30
  s_nop 1
  v_permlane16_swap_b32 v30, v31
  v_add_f32 v30, v30, v31
  v_mov_b32 v31, v30
  s_nop 1
  v_permlane32_swap_b32 v30, v31
  v_add_f32 v30, v30, v31
  v_cndmask_b32_e64 v32, v30, v5, s[34:35]
  s_cmp_eq_u32 s28, 1
  s_cbranch_scc0 L_slow_34
  buffer_store_dwordx2 v[32:33], v4, s[4:7], s24 offen
  s_branch L_sdone_35
L_slow_34:
  buffer_store_dwordx2 v[32:33], v4, s[4:7], s24 offen sc1
L_sdone_35:
  s_branch L_t2done_33
L_t2out_32:
  v_lshrrev_b32 v30, 16, v5
  v_lshrrev_b32 v31, 2, v4
  s_mul_i32 s40, s26, 1152
  s_mov_b32 s56, 0x55555555
  s_mov_b32 s57, 0x5
  s_mov_b64 exec, s[56:57]
  buffer_store_short v30, v31, s[12:15], s40 offen
  s_mov_b64 exec, -1
L_t2done_33:
L_red_skip_31:
  s_cmp_eq_u32 s27, 1
  s_cbranch_scc1 L_ch_next
  s_barrier
  s_mul_i32 s40, s17, 1152
  s_add_u32 s40, s40, s24
  s_add_u32 s41, s24, 4608
  v_lshlrev_b32 v46, 3, v0
  buffer_load_dwordx2 v[40:41], v46, s[4:7], s41 offen sc1
  buffer_load_dwordx2 v[30:31], v2, s[4:7], s40 offen offset:0 sc1
  buffer_load_dwordx2 v[32:33], v2, s[4:7], s40 offen offset:256 sc1
  buffer_load_dwordx2 v[34:35], v2, s[4:7], s40 offen offset:512 sc1
  buffer_load_dwordx2 v[36:37], v2, s[4:7], s40 offen offset:768 sc1
  buffer_load_dwordx2 v[38:39], v2, s[4:7], s40 offen offset:1024 sc1
  s_waitcnt vmcnt(0)
  v_mov_b32 v47, s97
  v_cndmask_b32_e64 v43, v47, v39, s[36:37]
  v_min3_u32 v47, v31, v33, v35
  v_max3_u32 v42, v31, v33, v35
  v_min3_u32 v47, v47, v37, v43
  v_max3_u32 v42, v42, v37, v43
  v_min_u32 v47, v47, v41
  v_max_u32 v42, v42, v41
  v_cmp_ne_u32 vcc, s97, v47
  v_cmp_ne_u32 s[56:57], s97, v42
  s_nop 0
  s_or_b64 vcc, vcc, s[56:57]
  s_nop 2
  s_cbranch_vccz L_ok_36
  s_mov_b32 s29, 0x2000
L_rt_37:
  buffer_load_dwordx2 v[40:41], v46, s[4:7], s41 offen sc1
  buffer_load_dwordx2 v[30:31], v2, s[4:7], s40 offen offset:0 sc1
  buffer_load_dwordx2 v[32:33], v2, s[4:7], s40 offen offset:256 sc1
  buffer_load_dwordx2 v[34:35], v2, s[4:7], s40 offen offset:512 sc1
  buffer_load_dwordx2 v[36:37], v2, s[4:7], s40 offen offset:768 sc1
  buffer_load_dwordx2 v[38:39], v2, s[4:7], s40 offen offset:1024 sc1
  s_waitcnt vmcnt(0)
  v_mov_b32 v47, s97
  v_cndmask_b32_e64 v43, v47, v39, s[36:37]
  v_min3_u32 v47, v31, v33, v35
  v_max3_u32 v42, v31, v33, v35
  v_min3_u32 v47, v47, v37, v43
  v_max3_u32 v42, v42, v37, v43
  v_min_u32 v47, v47, v41
  v_max_u32 v42, v42, v41
  v_cmp_ne_u32 vcc, s97, v47
  v_cmp_ne_u32 s[56:57], s97, v42
  s_nop 0
  s_or_b64 vcc, vcc, s[56:57]
  s_sub_u32 s29, s29, 1
  s_nop 1
  s_cbranch_scc1 L_ok_36
  s_cbranch_vccnz L_rt_37
L_ok_36:
  v_add_f32_dpp v40, v40, v40 row_ror:2 row_mask:0xf bank_mask:0xf
  s_nop 1
  v_add_f32_dpp v40, v40, v40 row_ror:4 row_mask:0xf bank_mask:0xf
  s_nop 1
  v_add_f32_dpp v40, v40, v40 row_ror:8 row_mask:0xf bank_mask:0xf
  v_mov_b32 v47, v40
  s_nop 1
  v_permlane16_swap_b32 v40, v47
  v_add_f32 v40, v40, v47
  v_mov_b32 v47, v40
  s_nop 1
  v_permlane32_swap_b32 v40, v47
  v_add_f32 v40, v40, v47
  s_nop 1
  v_mov_b32_dpp v47, v40 quad_perm:[0,0,2,2] row_mask:0xf bank_mask:0xf
  v_mov_b32_dpp v41, v40 quad_perm:[1,1,3,3] row_mask:0xf bank_mask:0xf
  v_mul_f32 v47, 0x3ae38e39, v47
  v_mul_f32 v41, 0x3ae38e39, v41
  v_fma_f32 v41, -v47, v47, v41
  v_max_f32 v41, 0, v41
  v_cvt_pk_bf16_f32 v47, v47, v47
  v_and_b32 v47, 0xffff0000, v47
  v_cvt_pk_bf16_f32 v41, v41, v41
  v_sub_f32 v30, v30, v47
  v_sub_f32 v32, v32, v47
  v_and_b32 v41, 0xffff0000, v41
  v_sub_f32 v34, v34, v47
  v_sub_f32 v36, v36, v47
  v_add_f32 v41, 0x3727c5ac, v41
  v_sub_f32 v38, v38, v47
  v_cvt_pk_bf16_f32 v30, v30, v30
  v_cvt_pk_bf16_f32 v41, v41, v41
  v_cvt_pk_bf16_f32 v32, v32, v32
  v_cvt_pk_bf16_f32 v34, v34, v34
  v_and_b32 v41, 0xffff0000, v41
  v_cvt_pk_bf16_f32 v36, v36, v36
  v_cvt_pk_bf16_f32 v38, v38, v38
  v_sqrt_f32 v41, v41
  v_and_b32 v30, 0xffff0000, v30
  v_and_b32 v32, 0xffff0000, v32
  v_cvt_pk_bf16_f32 v41, v41, v41
  v_and_b32 v34, 0xffff0000, v34
  v_and_b32 v36, 0xffff0000, v36
  v_and_b32 v41, 0xffff0000, v41
  v_and_b32 v38, 0xffff0000, v38
  v_rcp_f32 v41, v41
  s_nop 0
  v_mul_f32 v30, v30, v41
  v_mul_f32 v32, v32, v41
  v_mul_f32 v34, v34, v41
  v_mul_f32 v36, v36, v41
  v_mul_f32 v38, v38, v41
  v_cvt_pk_bf16_f32 v30, v30, v30
  v_cvt_pk_bf16_f32 v32, v32, v32
  v_cvt_pk_bf16_f32 v34, v34, v34
  v_cvt_pk_bf16_f32 v36, v36, v36
  v_cvt_pk_bf16_f32 v38, v38, v38
  v_and_b32 v42, v30, v1
  v_and_b32 v43, v32, v1
  v_and_b32 v44, v34, v1
  v_and_b32 v45, v36, v1
  v_and_b32 v46, v38, v1
  s_mul_i32 s40, s17, 28672
  s_add_u32 s40, s40, 10240
  v_lshlrev_b32 v47, 4, v0
  v_add_u32 v47, s40, v47
  ds_read_b128 v[18:21], v47 offset:0
  ds_read_b128 v[22:25], v47 offset:1024
  ds_read_b128 v[26:29], v47 offset:2048
  v_mov_b32_dpp v10, v42 quad_perm:[0,1,2,3] row_mask:0xf bank_mask:0x1
  v_mov_b32_dpp v11, v42 row_ror:4 row_mask:0xf bank_mask:0x2
  v_mov_b32_dpp v12, v42 row_ror:8 row_mask:0xf bank_mask:0x4
  v_mov_b32_dpp v13, v42 row_ror:12 row_mask:0xf bank_mask:0x8
  s_waitcnt lgkmcnt(2)
  s_nop 0
  v_mfma_f32_16x16x32_bf16 v[30:33], v[18:21], v[10:13], 0
  ds_read_b128 v[18:21], v47 offset:3072
  v_mov_b32_dpp v14, v42 row_ror:12 row_mask:0xf bank_mask:0x1
  v_mov_b32_dpp v15, v42 quad_perm:[0,1,2,3] row_mask:0xf bank_mask:0x2
  s_waitcnt lgkmcnt(2)
  v_mfma_f32_16x16x32_bf16 v[34:37], v[22:25], v[10:13], 0
  ds_read_b128 v[22:25], v47 offset:4096
  v_mov_b32_dpp v16, v42 row_ror:4 row_mask:0xf bank_mask:0x4
  v_mov_b32_dpp v17, v42 row_ror:8 row_mask:0xf bank_mask:0x8
  s_waitcnt lgkmcnt(2)
  s_nop 0
  v_mfma_f32_16x16x32_bf16 v[30:33], v[26:29], v[14:17], v[30:33]
  ds_read_b128 v[26:29], v47 offset:5120
  v_mov_b32_dpp v10, v42 row_ror:8 row_mask:0xf bank_mask:0x1
  v_mov_b32_dpp v11, v42 row_ror:12 row_mask:0xf bank_mask:0x2
  s_waitcnt lgkmcnt(2)
  v_mfma_f32_16x16x32_bf16 v[34:37], v[18:21], v[14:17], v[34:37]
  ds_read_b128 v[18:21], v47 offset:6144
  v_mov_b32_dpp v12, v42 quad_perm:[0,1,2,3] row_mask:0xf bank_mask:0x4
  v_mov_b32_dpp v13, v42 row_ror:4 row_mask:0xf bank_mask:0x8
  s_waitcnt lgkmcnt(2)
  s_nop 0
  v_mfma_f32_16x16x32_bf16 v[30:33], v[22:25], v[10:13], v[30:33]
  ds_read_b128 v[22:25], v47 offset:7168
  v_mov_b32_dpp v14, v42 row_ror:4 row_mask:0xf bank_mask:0x1
  v_mov_b32_dpp v15, v42 row_ror:8 row_mask:0xf bank_mask:0x2
  s_waitcnt lgkmcnt(2)
  v_mfma_f32_16x16x32_bf16 v[34:37], v[26:29], v[10:13], v[34:37]
  ds_read_b128 v[26:29], v47 offset:8192
  v_mov_b32_dpp v16, v42 row_ror:12 row_mask:0xf bank_mask:0x4
  v_mov_b32_dpp v17, v42 quad_perm:[0,1,2,3] row_mask:0xf bank_mask:0x8
  s_waitcnt lgkmcnt(2)
  s_nop 0
  v_mfma_f32_16x16x32_bf16 v[30:33], v[18:21], v[14:17], v[30:33]
  ds_read_b128 v[18:21], v47 offset:9216
  v_mov_b32_dpp v10, v43 quad_perm:[0,1,2,3] row_mask:0xf bank_mask:0x1
  v_mov_b32_dpp v11, v43 row_ror:4 row_mask:0xf bank_mask:0x2
  s_waitcnt lgkmcnt(2)
  v_mfma_f32_16x16x32_bf16 v[34:37], v[22:25], v[14:17], v[34:37]
  ds_read_b128 v[22:25], v47 offset:10240
  v_mov_b32_dpp v12, v43 row_ror:8 row_mask:0xf bank_mask:0x4
  v_mov_b32_dpp v13, v43 row_ror:12 row_mask:0xf bank_mask:0x8
  s_waitcnt lgkmcnt(2)
  s_nop 0
  v_mfma_f32_16x16x32_bf16 v[30:33], v[26:29], v[10:13], v[30:33]
  ds_read_b128 v[26:29], v47 offset:11264
  v_mov_b32_dpp v14, v43 row_ror:12 row_mask:0xf bank_mask:0x1
  v_mov_b32_dpp v15, v43 quad_perm:[0,1,2,3] row_mask:0xf bank_mask:0x2
  s_waitcnt lgkmcnt(2)
  v_mfma_f32_16x16x32_bf16 v[34:37], v[18:21], v[10:13], v[34:37]
  ds_read_b128 v[18:21], v47 offset:12288
  v_mov_b32_dpp v16, v43 row_ror:4 row_mask:0xf bank_mask:0x4
  v_mov_b32_dpp v17, v43 row_ror:8 row_mask:0xf bank_mask:0x8
  s_waitcnt lgkmcnt(2)
  s_nop 0
  v_mfma_f32_16x16x32_bf16 v[30:33], v[22:25], v[14:17], v[30:33]
  ds_read_b128 v[22:25], v47 offset:13312
  v_mov_b32_dpp v10, v43 row_ror:8 row_mask:0xf bank_mask:0x1
  v_mov_b32_dpp v11, v43 row_ror:12 row_mask:0xf bank_mask:0x2
  s_waitcnt lgkmcnt(2)
  v_mfma_f32_16x16x32_bf16 v[34:37], v[26:29], v[14:17], v[34:37]
  ds_read_b128 v[26:29], v47 offset:14336
  v_mov_b32_dpp v12, v43 quad_perm:[0,1,2,3] row_mask:0xf bank_mask:0x4
  v_mov_b32_dpp v13, v43 row_ror:4 row_mask:0xf bank_mask:0x8
  s_waitcnt lgkmcnt(2)
  s_nop 0
  v_mfma_f32_16x16x32_bf16 v[30:33], v[18:21], v[10:13], v[30:33]
  ds_read_b128 v[18:21], v47 offset:15360
  v_mov_b32_dpp v14, v43 row_ror:4 row_mask:0xf bank_mask:0x1
  v_mov_b32_dpp v15, v43 row_ror:8 row_mask:0xf bank_mask:0x2
  s_waitcnt lgkmcnt(2)
  v_mfma_f32_16x16x32_bf16 v[34:37], v[22:25], v[10:13], v[34:37]
  ds_read_b128 v[22:25], v47 offset:16384
  v_mov_b32_dpp v16, v43 row_ror:12 row_mask:0xf bank_mask:0x4
  v_mov_b32_dpp v17, v43 quad_perm:[0,1,2,3] row_mask:0xf bank_mask:0x8
  s_waitcnt lgkmcnt(2)
  s_nop 0
  v_mfma_f32_16x16x32_bf16 v[30:33], v[26:29], v[14:17], v[30:33]
  ds_read_b128 v[26:29], v47 offset:17408
  v_mov_b32_dpp v10, v44 quad_perm:[0,1,2,3] row_mask:0xf bank_mask:0x1
  v_mov_b32_dpp v11, v44 row_ror:4 row_mask:0xf bank_mask:0x2
  s_waitcnt lgkmcnt(2)
  v_mfma_f32_16x16x32_bf16 v[34:37], v[18:21], v[14:17], v[34:37]
  ds_read_b128 v[18:21], v47 offset:18432
  v_mov_b32_dpp v12, v44 row_ror:8 row_mask:0xf bank_mask:0x4
  v_mov_b32_dpp v13, v44 row_ror:12 row_mask:0xf bank_mask:0x8
  s_waitcnt lgkmcnt(2)
  s_nop 0
  v_mfma_f32_16x16x32_bf16 v[30:33], v[22:25], v[10:13], v[30:33]
  ds_read_b128 v[22:25], v47 offset:19456
  v_mov_b32_dpp v14, v44 row_ror:12 row_mask:0xf bank_mask:0x1
  v_mov_b32_dpp v15, v44 quad_perm:[0,1,2,3] row_mask:0xf bank_mask:0x2
  s_waitcnt lgkmcnt(2)
  v_mfma_f32_16x16x32_bf16 v[34:37], v[26:29], v[10:13], v[34:37]
  ds_read_b128 v[26:29], v47 offset:20480
  v_mov_b32_dpp v16, v44 row_ror:4 row_mask:0xf bank_mask:0x4
  v_mov_b32_dpp v17, v44 row_ror:8 row_mask:0xf bank_mask:0x8
  s_waitcnt lgkmcnt(2)
  s_nop 0
  v_mfma_f32_16x16x32_bf16 v[30:33], v[18:21], v[14:17], v[30:33]
  ds_read_b128 v[18:21], v47 offset:21504
  v_mov_b32_dpp v10, v44 row_ror:8 row_mask:0xf bank_mask:0x1
  v_mov_b32_dpp v11, v44 row_ror:12 row_mask:0xf bank_mask:0x2
  s_waitcnt lgkmcnt(2)
  v_mfma_f32_16x16x32_bf16 v[34:37], v[22:25], v[14:17], v[34:37]
  ds_read_b128 v[22:25], v47 offset:22528
  v_mov_b32_dpp v12, v44 quad_perm:[0,1,2,3] row_mask:0xf bank_mask:0x4
  v_mov_b32_dpp v13, v44 row_ror:4 row_mask:0xf bank_mask:0x8
  s_waitcnt lgkmcnt(2)
  s_nop 0
  v_mfma_f32_16x16x32_bf16 v[30:33], v[26:29], v[10:13], v[30:33]
  ds_read_b128 v[26:29], v47 offset:23552
  v_mov_b32_dpp v14, v44 row_ror:4 row_mask:0xf bank_mask:0x1
  v_mov_b32_dpp v15, v44 row_ror:8 row_mask:0xf bank_mask:0x2
  s_waitcnt lgkmcnt(2)
  v_mfma_f32_16x16x32_bf16 v[34:37], v[18:21], v[10:13], v[34:37]
  ds_read_b128 v[18:21], v47 offset:24576
  v_mov_b32_dpp v16, v44 row_ror:12 row_mask:0xf bank_mask:0x4
  v_mov_b32_dpp v17, v44 quad_perm:[0,1,2,3] row_mask:0xf bank_mask:0x8
  s_waitcnt lgkmcnt(2)
  s_nop 0
  v_mfma_f32_16x16x32_bf16 v[30:33], v[22:25], v[14:17], v[30:33]
  ds_read_b128 v[22:25], v47 offset:25600
  v_mov_b32_dpp v10, v45 quad_perm:[0,1,2,3] row_mask:0xf bank_mask:0x1
  v_mov_b32_dpp v11, v45 row_ror:4 row_mask:0xf bank_mask:0x2
  s_waitcnt lgkmcnt(2)
  v_mfma_f32_16x16x32_bf16 v[34:37], v[26:29], v[14:17], v[34:37]
  ds_read_b128 v[26:29], v47 offset:26624
  v_mov_b32_dpp v12, v45 row_ror:8 row_mask:0xf bank_mask:0x4
  v_mov_b32_dpp v13, v45 row_ror:12 row_mask:0xf bank_mask:0x8
  s_waitcnt lgkmcnt(2)
  s_nop 0
  v_mfma_f32_16x16x32_bf16 v[30:33], v[18:21], v[10:13], v[30:33]
  ds_read_b128 v[18:21], v47 offset:27648
  v_mov_b32_dpp v14, v45 row_ror:12 row_mask:0xf bank_mask:0x1
  v_mov_b32_dpp v15, v45 quad_perm:[0,1,2,3] row_mask:0xf bank_mask:0x2
  s_waitcnt lgkmcnt(2)
  v_mfma_f32_16x16x32_bf16 v[34:37], v[22:25], v[10:13], v[34:37]
  v_mov_b32_dpp v16, v45 row_ror:4 row_mask:0xf bank_mask:0x4
  v_mov_b32_dpp v17, v45 row_ror:8 row_mask:0xf bank_mask:0x8
  s_waitcnt lgkmcnt(1)
  s_nop 0
  v_mfma_f32_16x16x32_bf16 v[30:33], v[26:29], v[14:17], v[30:33]
  v_mov_b32_dpp v10, v45 row_ror:8 row_mask:0xf bank_mask:0x1
  v_mov_b32_dpp v11, v45 row_ror:12 row_mask:0xf bank_mask:0x2
  s_waitcnt lgkmcnt(0)
  v_mfma_f32_16x16x32_bf16 v[34:37], v[18:21], v[14:17], v[34:37]
  v_mov_b32_dpp v12, v45 quad_perm:[0,1,2,3] row_mask:0xf bank_mask:0x4
  v_mov_b32_dpp v13, v45 row_ror:4 row_mask:0xf bank_mask:0x8
  s_nop 1
  v_mfma_f32_16x16x32_bf16 v[30:33], v[48:51], v[10:13], v[30:33]
  v_mov_b32_dpp v14, v45 row_ror:4 row_mask:0xf bank_mask:0x1
  v_mov_b32_dpp v15, v45 row_ror:8 row_mask:0xf bank_mask:0x2
  v_mfma_f32_16x16x32_bf16 v[34:37], v[52:55], v[10:13], v[34:37]
  v_mov_b32_dpp v16, v45 row_ror:12 row_mask:0xf bank_mask:0x4
  v_mov_b32_dpp v17, v45 quad_perm:[0,1,2,3] row_mask:0xf bank_mask:0x8
  s_nop 1
  v_mfma_f32_16x16x32_bf16 v[30:33], v[56:59], v[14:17], v[30:33]
  v_mov_b32_dpp v10, v46 quad_perm:[0,1,2,3] row_mask:0xf bank_mask:0x1
  v_mov_b32_dpp v11, v46 row_ror:4 row_mask:0xf bank_mask:0x2
  v_mfma_f32_16x16x32_bf16 v[34:37], v[60:63], v[14:17], v[34:37]
  v_mov_b32_dpp v12, v46 row_ror:8 row_mask:0xf bank_mask:0x4
  v_mov_b32_dpp v13, v46 row_ror:12 row_mask:0xf bank_mask:0x8
  s_nop 1
  v_mfma_f32_16x16x32_bf16 v[30:33], v[64:67], v[10:13], v[30:33]
  v_mov_b32_dpp v14, v46 row_ror:12 row_mask:0xf bank_mask:0x1
  v_mov_b32_dpp v15, v46 quad_perm:[0,1,2,3] row_mask:0xf bank_mask:0x2
  v_mfma_f32_16x16x32_bf16 v[34:37], v[68:71], v[10:13], v[34:37]
  v_mov_b32_dpp v16, v46 row_ror:4 row_mask:0xf bank_mask:0x4
  v_mov_b32_dpp v17, v46 row_ror:8 row_mask:0xf bank_mask:0x8
  s_nop 1
  v_mfma_f32_16x16x32_bf16 v[30:33], v[72:75], v[14:17], v[30:33]
  v_mfma_f32_16x16x32_bf16 v[34:37], v[76:79], v[14:17], v[34:37]
  v_lshrrev_b32 v47, 1, v3
  s_lshl_b32 s40, s17, 9
  v_add_u32 v47, s40, v47
  s_nop 3
  v_permlane32_swap_b32 v30, v31
  v_permlane32_swap_b32 v34, v35
  v_permlane32_swap_b32 v32, v33
  v_permlane32_swap_b32 v36, v37
  v_add_f32_dpp v30, v31, v30 quad_perm:[2,3,2,3] row_mask:0xf bank_mask:0xf
  v_add_f32_dpp v34, v35, v34 quad_perm:[2,3,2,3] row_mask:0xf bank_mask:0xf
  v_add_f32_dpp v33, v32, v33 quad_perm:[0,1,0,1] row_mask:0xf bank_mask:0xf
  v_add_f32_dpp v37, v36, v37 quad_perm:[0,1,0,1] row_mask:0xf bank_mask:0xf
  v_cndmask_b32_e64 v30, v30, v33, s[30:31]
  v_cndmask_b32_e64 v34, v34, v37, s[30:31]
  ds_write_b32 v47, v30 offset:0
  ds_write_b32 v47, v34 offset:256
  v_lshlrev_b32 v47, 3, v0
  v_mov_b32 v39, s16
  s_waitcnt lgkmcnt(0)
  s_barrier
  s_cmp_lg_u32 s58, 0
  s_cbranch_scc1 L_q_skip_38
  ds_read_b64 v[30:31], v47 offset:0
  ds_read_b64 v[32:33], v47 offset:512
  ds_read_b64 v[34:35], v47 offset:1024
  ds_read_b64 v[36:37], v47 offset:1536
  s_waitcnt lgkmcnt(2)
  v_add_f32 v30, v30, v32
  v_add_f32 v31, v31, v33
  s_waitcnt lgkmcnt(0)
  v_add_f32 v34, v34, v36
  v_add_f32 v35, v35, v37
  v_add_f32 v30, v30, v34
  v_add_f32 v31, v31, v35
  v_cvt_pk_bf16_f32 v38, v30, v31
  buffer_store_dwordx2 v[38:39], v47, s[4:7], s25 offen sc1
  s_nop 0
L_q_skip_38:
L_ch_next:
  s_cmp_eq_u32 s19, 3
  s_cbranch_scc0 L_ch_noswap
  v_swap_b32 v5, v6
  s_or_b32 s40, s18, s17
  s_cmp_lg_u32 s40, 0
  s_cbranch_scc1 L_ch_noswap
  s_add_u32 s40, s99, 1
  v_mov_b32 v30, s40
  v_mov_b32 v31, 0
  s_mov_b64 exec, 1
  buffer_store_dword v30, v31, s[4:7], 0 offen
  s_mov_b64 exec, -1
L_ch_noswap:
  s_add_u32 s19, s19, 1
  s_cmp_lt_u32 s19, 6
  s_cbranch_scc1 L_ch_loop
  s_or_b32 s40, s18, s17
  s_cmp_lg_u32 s40, 0
  s_cbranch_scc1 L_end
  s_branch L_end
L_end:
  s_endpgm
.section .rodata,"a"
.p2align 6
.amdhsa_kernel interleave_layers__mha_block_cached__dense_activation_gelu__decode_kernel
  .amdhsa_next_free_vgpr 512
  .amdhsa_next_free_sgpr 102
  .amdhsa_accum_offset 256
  .amdhsa_group_segment_fixed_size 0
  .amdhsa_kernarg_size 104
  .amdhsa_user_sgpr_count 2
  .amdhsa_user_sgpr_kernarg_segment_ptr 1
  .amdhsa_system_sgpr_workgroup_id_x 1
.end_amdhsa_kernel
```
